```python
import torch

def _softmax(x, axis=-1):
    return torch.softmax(x, dim=axis)
def _gelu(x):
    return torch.nn.functional.gelu(x, approximate="tanh")
def _silu(x):
    return torch.nn.functional.silu(x)
def _sigmoid(x):
    return torch.sigmoid(x)
def _layernorm(x, axis=-1, eps=1e-5):
    m = x.mean(dim=axis, keepdim=True)
    v = x.var(dim=axis, keepdim=True, unbiased=False)
    return (x - m) / torch.sqrt(v + eps)
def _scatter_add(tgt, idx, src, axis=0):
    return tgt.clone().index_add_(axis, idx, src)
def _segment_sum(src, seg, n):
    out = torch.zeros((n,) + src.shape[1:], dtype=src.dtype)
    return out.index_add_(0, seg, src)
def _pad(x, pw):
    flat = tuple(v for pair in reversed(pw) for v in pair)
    return torch.nn.functional.pad(x, flat)

kernel_name = 'parallel_sum__ssm_conv_s5__dense_activation_silu__prompt'

def setup_inputs():

    _w = (lambda a: (lambda t: t.to(torch.bfloat16) if t.is_floating_point() else t)(torch.as_tensor(a)))
    def _A_setup():
        B, S, D = 1, 2048, 512
        P = D
        Lambda_re = -0.5 * (lambda _x: torch.exp(torch.as_tensor(_x)))((lambda *s: torch.randn(*s, dtype=torch.bfloat16) * 0.2)(P))
        Lambda_im = (lambda *s: torch.randn(*s, dtype=torch.bfloat16) * 0.8)(P) * 1.0
        B_re = (lambda *s: torch.randn(*s, dtype=torch.bfloat16) * 0.2)(P, D) * (D ** -0.5)
        B_im = (lambda *s: torch.randn(*s, dtype=torch.bfloat16) * 0.2)(P, D) * (D ** -0.5)
        C_re = (lambda *s: torch.randn(*s, dtype=torch.bfloat16) * 0.2)(D, P) * (P ** -0.5)
        C_im = (lambda *s: torch.randn(*s, dtype=torch.bfloat16) * 0.2)(D, P) * (P ** -0.5)
        log_dt = (lambda *s: torch.randn(*s, dtype=torch.bfloat16) * 0.2)(P) * 0.3 - 2.0
        Dskip = (lambda *s: torch.randn(*s, dtype=torch.bfloat16) * 0.05)(D)
        return {
            "x": _w((lambda *s: torch.randn(*s, dtype=torch.bfloat16) * 0.05)(B, S, D)),
            "Lambda_re": _w(Lambda_re),
            "Lambda_im": _w(Lambda_im),
            "B_re": _w(B_re),
            "B_im": _w(B_im),
            "C_re": _w(C_re),
            "C_im": _w(C_im),
            "log_dt": _w(log_dt),
            "Dskip": _w(Dskip),
        }
    _A_in = _A_setup()

    def _B_setup():
        B, S, D, F = 1, 2048, 512, 1792
        return {
            "x": _w((lambda *s: torch.randn(*s, dtype=torch.bfloat16) * 0.05)(B, S, D)),
            "w1": _w((lambda *s: torch.randn(*s, dtype=torch.bfloat16) * 0.8)(D, F) * (D ** -0.5)),
            "w2": _w((lambda *s: torch.randn(*s, dtype=torch.bfloat16) * 0.2)(F, D) * (F ** -0.5)),
        }
    _B_in = _B_setup()

    return {
        "A_x": _A_in["x"],
        "A_Lambda_re": _A_in["Lambda_re"],
        "A_Lambda_im": _A_in["Lambda_im"],
        "A_B_re": _A_in["B_re"],
        "A_B_im": _A_in["B_im"],
        "A_C_re": _A_in["C_re"],
        "A_C_im": _A_in["C_im"],
        "A_log_dt": _A_in["log_dt"],
        "A_Dskip": _A_in["Dskip"],
        "B_x": _B_in["x"],
        "B_w1": _B_in["w1"],
        "B_w2": _B_in["w2"],
    }

def reference(A_x, A_Lambda_re, A_Lambda_im, A_B_re, A_B_im, A_C_re, A_C_im, A_log_dt, A_Dskip, B_x, B_w1, B_w2):
    def _A_ref(x, Lambda_re, Lambda_im, B_re, B_im, C_re, C_im, log_dt, Dskip):
        Bsz, L, H = x.shape
        Lam = Lambda_re + 1j * Lambda_im
        Bmat = B_re + 1j * B_im
        Cmat = C_re + 1j * C_im
        dt = torch.exp(log_dt)
        Lam_bar = torch.exp(dt * Lam)
        B_bar = ((Lam_bar - 1.0) / Lam)[:, None] * Bmat
        Bu = torch.einsum("bld,pd->blp", x + 0j, B_bar)
        h = torch.zeros_like(Bu[:, 0, :])
        hs = []
        for t in range(L):
            h = Lam_bar[None, :] * h + Bu[:, t, :]
            hs.append(h)
        hseq = torch.stack(hs, 1)
        y = 2.0 * torch.einsum("blp,dp->bld", hseq, Cmat).real + x * Dskip[None, None, :]
        return y

    def _B_ref(x, w1, w2):
        h = torch.einsum("bsd,df->bsf", x, w1)
        h = _silu(h)
        out = torch.einsum("bsf,fd->bsd", h, w2)
        return out

    x = A_x
    xn = _layernorm(x, axis=-1)
    return x + _A_ref(xn, A_Lambda_re, A_Lambda_im, A_B_re, A_B_im, A_C_re, A_C_im, A_log_dt, A_Dskip) + _B_ref(xn, B_w1, B_w2)
```

```asm
; @launch grid=(256,1,1) block=(512,1,1) lds=163840
.amdgcn_target "amdgcn-amd-amdhsa--gfx950"
.text
.globl parallel_sum__ssm_conv_s5__dense_activation_silu__prompt_kernel
.p2align 8
.type parallel_sum__ssm_conv_s5__dense_activation_silu__prompt_kernel,@function
parallel_sum__ssm_conv_s5__dense_activation_silu__prompt_kernel:
  s_cmp_ge_u32 s2, 256
  s_cbranch_scc1 L_end
  v_lshrrev_b32 v1, 6, v0
  v_and_b32 v0, 63, v0
  s_load_dwordx2 s[16:17], s[0:1], 0
  s_load_dwordx2 s[24:25], s[0:1], 80
  s_load_dwordx2 s[28:29], s[0:1], 112
  v_readfirstlane_b32 s3, v1
  s_nop 0
  s_lshr_b32 s14, s3, 2
  s_lshl_b32 s14, s14, 3
  s_add_u32 s14, s14, 24
  s_load_dwordx2 s[20:21], s[0:1], s14
  s_load_dwordx2 s[48:49], s[0:1], 8
  s_load_dwordx2 s[52:53], s[0:1], 16
  s_load_dwordx2 s[56:57], s[0:1], 56
  s_load_dwordx2 s[32:33], s[0:1], 88
  s_load_dwordx2 s[36:37], s[0:1], 40
  s_load_dwordx2 s[40:41], s[0:1], 48
  s_load_dwordx2 s[44:45], s[0:1], 96
  s_load_dwordx2 s[60:61], s[0:1], 64
  s_load_dwordx2 s[64:65], s[0:1], 112
  s_mov_b32 s18, 0x200000
  s_mov_b32 s19, 0x20000
  s_mov_b32 s26, 0x1c0000
  s_mov_b32 s27, 0x20000
  s_mov_b32 s22, 0x80000
  s_mov_b32 s23, 0x20000
  s_mov_b32 s30, 0x10000000
  s_mov_b32 s31, 0x20000
  s_and_b32 s7, s2, 1
  s_bfe_u32 s6, s2, 0x30003
  s_bfe_u32 s5, s2, 0x20001
  s_lshl_b32 s5, s5, 2
  s_lshr_b32 s14, s2, 6
  s_add_u32 s5, s5, s14
  s_lshl_b32 s10, s7, 3
  s_add_u32 s10, s10, s6
  s_lshl_b32 s14, s14, 1
  s_and_b32 s11, s2, 7
  s_lshr_b32 s8, s10, 2
  s_and_b32 s9, s10, 3
  s_and_b32 s4, s3, 3
  s_mul_i32 s86, s8, 896
  s_lshl_b32 s15, s9, 8
  s_add_u32 s74, s86, s15
  s_lshl_b32 s76, s3, 11
  s_lshl_b32 s78, s3, 10
  s_add_u32 s77, s78, 16384
  v_lshrrev_b32 v6, 3, v0
  v_lshrrev_b32 v7, 4, v0
  v_and_b32 v8, 7, v0
  s_lshl_b32 s14, s5, 7
  s_lshl_b32 s15, s3, 4
  s_add_u32 s14, s14, s15
  v_add_u32 v2, s14, v6
  v_xor_b32 v9, v8, v7
  v_lshlrev_b32 v9, 4, v9
  v_lshl_add_u32 v2, v2, 10, v9
  v_xor_b32 v3, 64, v2
  v_add_u32 v3, 0x2000, v3
  s_lshl_b32 s14, s10, 5
  s_lshl_b32 s15, s4, 3
  s_add_u32 s14, s14, s15
  s_and_b32 s15, s4, 1
  s_lshl_b32 s15, s15, 6
  v_add_u32 v4, s14, v6
  v_xor_b32 v10, s15, v9
  v_lshl_add_u32 v4, v4, 10, v10
  s_lshl_b32 s14, s3, 3
  v_add_u32 v5, s14, v6
  v_mul_u32_u24 v5, 3584, v5
  v_and_b32 v10, 1, v7
  v_lshlrev_b32 v10, 2, v10
  v_xor_b32 v10, v10, v8
  v_lshl_add_u32 v5, v10, 4, v5
  v_add_u32 v5, s74, v5
  v_lshlrev_b32 v1, 4, v0
  s_waitcnt lgkmcnt(0)
  s_add_u32 m0, s76, 0
  s_lshl_b32 s72, s11, 7
  buffer_load_dwordx4 v2, s[16:19], s72 offen lds
  s_add_u32 m0, s76, 1024
  s_mul_i32 s73, s72, 1792
  buffer_load_dwordx4 v3, s[16:19], s72 offen lds
  s_add_u32 m0, s77, 0
  s_nop 0
  buffer_load_dwordx4 v4, s[20:23], s72 offen lds
  s_add_u32 m0, s78, 24576
  s_nop 0
  buffer_load_dwordx4 v5, s[24:27], s73 offen lds
  s_mov_b32 s50, 0x400
  s_mov_b32 s51, 0x20000
  s_mov_b32 s54, 0x400
  s_mov_b32 s55, 0x20000
  s_mov_b32 s58, 0x400
  s_mov_b32 s59, 0x20000
  s_mov_b32 s34, 0x1c0000
  s_mov_b32 s35, 0x20000
  s_mov_b32 s38, 0x80000
  s_mov_b32 s39, 0x20000
  s_mov_b32 s42, 0x80000
  s_mov_b32 s43, 0x20000
  s_mov_b32 s46, 0x400000
  s_mov_b32 s47, 0x20000
  s_mov_b32 s62, 0x400
  s_mov_b32 s63, 0x20000
  s_mov_b32 s67, 0x20000
  s_add_u32 s75, s74, 128
  s_add_u32 s86, s86, 640
  s_cmp_ge_u32 s9, 2
  s_cselect_b32 s75, s86, s75
  s_cselect_b32 s66, 0, 0x10000000
  s_mov_b32 s13, 400000
  s_getreg_b32 s69, hwreg(HW_REG_XCC_ID, 0, 3)
  v_bfe_u32 v24, v0, 2, 1
  v_lshlrev_b32 v24, 4, v24
  v_bfe_u32 v240, v0, 3, 2
  v_lshl_add_u32 v24, v240, 2, v24
  v_and_b32 v240, 3, v0
  v_add_u32 v24, v24, v240
  s_lshl_b32 s14, s4, 12
  v_lshlrev_b32 v240, 7, v24
  v_add_u32 v240, s14, v240
  v_bfe_u32 v241, v24, 1, 3
  v_lshrrev_b32 v6, 5, v0
  v_xor_b32 v241, v241, v6
  v_lshl_add_u32 v240, v241, 4, v240
  s_add_u32 s14, s4, 0
  s_and_b32 s14, s14, 3
  s_lshl_b32 s14, s14, 5
  v_xor_b32 v6, s14, v240
  s_add_u32 s14, s4, 1
  s_and_b32 s14, s14, 3
  s_lshl_b32 s14, s14, 5
  v_xor_b32 v7, s14, v240
  s_add_u32 s14, s4, 2
  s_and_b32 s14, s14, 3
  s_lshl_b32 s14, s14, 5
  v_xor_b32 v8, s14, v240
  s_add_u32 s14, s4, 3
  s_and_b32 s14, s14, 3
  s_lshl_b32 s14, s14, 5
  v_xor_b32 v9, s14, v240
  v_lshrrev_b32 v240, 4, v0
  v_lshrrev_b32 v241, 2, v0
  v_xor_b32 v240, v240, v241
  v_and_b32 v240, 1, v240
  v_cmp_eq_u32 vcc, 0, v240
  v_mov_b32 v241, 0x3f803f80
  s_nop 0
  v_cndmask_b32 v112, 0, v241, vcc
  v_mov_b32 v113, v112
  v_mov_b32 v114, v112
  v_mov_b32 v115, v112
  v_cmp_eq_u32 vcc, 0, v0
  v_mov_b32 v19, 0x40000000
  s_nop 0
  v_cndmask_b32 v19, v19, 0, vcc
  v_mov_b32 v20, 0x27e00
  v_cmp_eq_u32 vcc, 0, v0
  v_mov_b32 v21, 0x100000
  s_add_u32 s14, s4, 0x27e00
  v_mov_b32 v20, s14
  v_cndmask_b32 v21, v21, v20, vcc
  v_mov_b32 v20, 0x27e00
  s_lshl_b32 s101, s4, 3
  v_mov_b32 v240, 0
  v_and_b32 v241, 31, v0
  v_lshl_add_u32 v241, v241, 2, v20
  ds_write_b32 v241, v240
  s_lshl_b32 s14, s5, 2
  s_add_u32 s14, s14, s8
  s_lshl_b32 s14, s14, 2
  s_add_u32 s14, s14, s4
  s_lshl_b32 s83, s14, 7
  s_add_u32 s83, s83, 0x40000
  s_lshl_b32 s15, s9, 2
  s_add_u32 s84, s83, s15
  s_lshl_b32 s79, s14, 15
  s_add_u32 s79, s79, 0x1000000
  s_lshl_b32 s15, s9, 13
  s_add_u32 s80, s79, s15
  s_add_u32 s81, s80, 4096
  s_lshl_b32 s85, 1, s9
  s_xor_b32 s85, s85, 15
  s_lshl_b32 s71, s4, 10
  s_mul_i32 s70, s8, 458752
  v_cmp_eq_u32 vcc, 63, v0
  v_mov_b32 v238, 0x40000000
  s_nop 0
  v_cndmask_b32 v238, v238, 0, vcc
  s_cmp_ge_u32 s3, 4
  s_cbranch_scc1 L_Y
  v_lshlrev_b32 v24, 4, v24
  v_bfe_u32 v241, v0, 2, 2
  v_lshrrev_b32 v242, 5, v0
  v_lshl_add_u32 v240, v242, 3, v241
  v_lshlrev_b32 v240, 7, v240
  v_lshrrev_b32 v241, 1, v241
  v_lshl_add_u32 v240, v241, 6, v240
  v_bfe_u32 v241, v0, 4, 1
  v_lshl_add_u32 v240, v241, 5, v240
  v_and_b32 v241, 3, v0
  v_lshl_add_u32 v240, v241, 3, v240
  s_add_u32 s14, s4, 0
  s_and_b32 s14, s14, 3
  s_lshl_b32 s14, s14, 11
  v_add_u32 v10, s14, v240
  v_xor_b32 v11, 64, v10
  s_add_u32 s14, s4, 1
  s_and_b32 s14, s14, 3
  s_lshl_b32 s14, s14, 11
  v_add_u32 v12, s14, v240
  v_xor_b32 v13, 64, v12
  s_add_u32 s14, s4, 2
  s_and_b32 s14, s14, 3
  s_lshl_b32 s14, s14, 11
  v_add_u32 v14, s14, v240
  v_xor_b32 v15, 64, v14
  s_add_u32 s14, s4, 3
  s_and_b32 s14, s14, 3
  s_lshl_b32 s14, s14, 11
  v_add_u32 v16, s14, v240
  v_xor_b32 v17, 64, v16
  s_mov_b32 s48, s73
  s_add_u32 s14, s11, 1
  s_and_b32 s14, s14, 7
  s_mul_i32 s49, s14, 229376
  s_add_u32 s14, s11, 2
  s_and_b32 s14, s14, 7
  s_mul_i32 s50, s14, 229376
  s_add_u32 s14, s11, 3
  s_and_b32 s14, s14, 7
  s_mul_i32 s51, s14, 229376
  s_add_u32 s14, s11, 4
  s_and_b32 s14, s14, 7
  s_mul_i32 s52, s14, 229376
  s_add_u32 s14, s11, 5
  s_and_b32 s14, s14, 7
  s_mul_i32 s53, s14, 229376
  s_add_u32 s14, s11, 6
  s_and_b32 s14, s14, 7
  s_mul_i32 s54, s14, 229376
  s_add_u32 s14, s11, 7
  s_and_b32 s14, s14, 7
  s_mul_i32 s55, s14, 229376
  s_sub_u32 s14, s75, s74
  v_add_u32 v71, s14, v5
  s_add_u32 m0, s76, 32768
  s_add_u32 s72, s72, 128
  s_and_b32 s72, s72, 0x3ff
  buffer_load_dwordx4 v2, s[16:19], s72 offen lds
  s_add_u32 m0, s76, 33792
  s_nop 0
  buffer_load_dwordx4 v3, s[16:19], s72 offen lds
  s_add_u32 m0, s77, 32768
  s_nop 0
  buffer_load_dwordx4 v4, s[20:23], s72 offen lds
  s_add_u32 m0, s78, 57344
  s_nop 0
  buffer_load_dwordx4 v5, s[24:27], s49 offen lds
  s_waitcnt lgkmcnt(0)
  s_waitcnt vmcnt(4)
  s_barrier
  ds_read_b128 v[128:131], v6 offset:0
  ds_read_b64_tr_b16 v[72:73], v10 offset:24576
  ds_read_b64_tr_b16 v[74:75], v10 offset:25088
  ds_read_b64_tr_b16 v[76:77], v11 offset:24576
  ds_read_b64_tr_b16 v[78:79], v11 offset:25088
  s_lshl_b32 s14, s5, 7
  s_lshl_b32 s15, s10, 3
  s_add_u32 s14, s14, s15
  s_add_u32 s87, s14, s3
  s_lshl_b32 s14, s87, 10
  v_mov_b32 v237, 0
  buffer_load_dword v236, v237, s[28:31], 0 offen sc1
  buffer_load_dwordx4 v[232:235], v1, s[16:19], s14 offen
  s_add_u32 m0, s76, 65536
  s_add_u32 s72, s72, 128
  s_and_b32 s72, s72, 0x3ff
  buffer_load_dwordx4 v2, s[16:19], s72 offen lds
  ds_read_b128 v[132:135], v7 offset:0
  ds_read_b64_tr_b16 v[80:81], v12 offset:24576
  ds_read_b64_tr_b16 v[82:83], v12 offset:25088
  ds_read_b64_tr_b16 v[84:85], v13 offset:24576
  ds_read_b64_tr_b16 v[86:87], v13 offset:25088
  v_cmp_gt_u32 vcc, 32, v0
  v_lshlrev_b32 v252, 2, v0
  v_mov_b32 v25, 0x40000000
  v_cndmask_b32 v25, v25, v252, vcc
  buffer_load_dword v27, v25, s[28:31], s83 offen sc1
  v_bfe_u32 v252, v0, 2, 2
  v_lshrrev_b32 v253, 5, v0
  ds_read_b128 v[136:139], v8 offset:0
  ds_read_b64_tr_b16 v[88:89], v14 offset:24576
  ds_read_b64_tr_b16 v[90:91], v14 offset:25088
  ds_read_b64_tr_b16 v[92:93], v15 offset:24576
  ds_read_b64_tr_b16 v[94:95], v15 offset:25088
  v_lshl_add_u32 v254, v253, 2, v252
  v_lshlrev_b32 v254, 8, v254
  v_lshl_add_u32 v254, v252, 6, v254
  s_add_u32 m0, s76, 66560
  s_nop 0
  buffer_load_dwordx4 v3, s[16:19], s72 offen lds
  v_bfe_u32 v252, v0, 4, 1
  v_lshl_add_u32 v254, v252, 5, v254
  v_and_b32 v252, 3, v0
  s_waitcnt lgkmcnt(12)
  v_mfma_f32_32x32x16_bf16 v[32:47], v[72:75], v[128:131], 0
  ds_read_b128 v[140:143], v9 offset:0
  ds_read_b64_tr_b16 v[96:97], v16 offset:24576
  ds_read_b64_tr_b16 v[98:99], v16 offset:25088
  ds_read_b64_tr_b16 v[100:101], v17 offset:24576
  ds_read_b64_tr_b16 v[102:103], v17 offset:25088
  v_lshl_add_u32 v254, v252, 3, v254
  v_add_u32 v254, 0x18000, v254
  s_xor_b32 s14, s8, 3
  s_lshl_b32 s15, s14, 6
  v_xor_b32 v116, s15, v254
  s_xor_b32 s14, s8, 2
  s_lshl_b32 s15, s14, 6
  v_xor_b32 v117, s15, v254
  s_add_u32 m0, s77, 65536
  s_waitcnt lgkmcnt(15)
  v_mfma_f32_32x32x16_bf16 v[48:63], v[76:79], v[128:131], 0
  buffer_load_dwordx4 v4, s[20:23], s72 offen lds
  v_mfma_f32_16x16x32_bf16 v[104:107], v[112:115], v[72:75], 0
  v_mfma_f32_16x16x32_bf16 v[108:111], v[112:115], v[76:79], 0
  s_xor_b32 s14, s8, 1
  s_lshl_b32 s15, s14, 6
  v_xor_b32 v118, s15, v254
  s_xor_b32 s14, s8, 0
  s_lshl_b32 s15, s14, 6
  v_xor_b32 v119, s15, v254
  v_lshrrev_b32 v252, 4, v0
  v_and_b32 v253, 15, v0
  v_lshlrev_b32 v254, 2, v252
  v_xor_b32 v253, v253, v254
  s_lshl_b32 s14, s4, 12
  s_lshl_b32 s15, s9, 8
  s_add_u32 s14, s14, s15
  v_lshlrev_b32 v253, 4, v253
  v_lshl_add_u32 v28, v252, 10, v253
  v_add_u32 v28, s14, v28
  s_waitcnt lgkmcnt(12)
  v_mfma_f32_32x32x16_bf16 v[32:47], v[80:83], v[132:135], v[32:47]
  s_xor_b32 s14, s9, 1
  s_lshl_b32 s14, s14, 13
  s_add_u32 s88, s79, s14
  s_xor_b32 s14, s9, 2
  s_lshl_b32 s14, s14, 13
  s_add_u32 s89, s79, s14
  s_xor_b32 s14, s9, 3
  s_lshl_b32 s14, s14, 13
  s_add_u32 s90, s79, s14
  s_add_u32 m0, s78, 90112
  s_waitcnt lgkmcnt(10)
  v_mfma_f32_32x32x16_bf16 v[48:63], v[84:87], v[132:135], v[48:63]
  buffer_load_dwordx4 v5, s[24:27], s50 offen lds
  s_lshl_b32 s14, s5, 2
  s_add_u32 s14, s14, s4
  s_lshl_b32 s14, s14, 16
  s_lshl_b32 s15, s9, 9
  s_add_u32 s14, s14, s15
  s_lshl_b32 s15, s8, 7
  s_add_u32 s56, s14, s15
  s_xor_b32 s57, s56, 512
  s_xor_b32 s58, s56, 1024
  s_xor_b32 s59, s56, 1536
  s_add_u32 s91, s79, 8192
  v_add_u32 v26, 4096, v1
  s_waitcnt lgkmcnt(0)
  s_waitcnt vmcnt(7)
  s_barrier
  v_mfma_f32_32x32x16_bf16 v[32:47], v[88:91], v[136:139], v[32:47]
  ds_read_b128 v[144:147], v6 offset:32768
  ds_read_b64_tr_b16 v[72:73], v10 offset:57344
  ds_read_b64_tr_b16 v[74:75], v10 offset:57856
  ds_read_b64_tr_b16 v[76:77], v11 offset:57344
  ds_read_b64_tr_b16 v[78:79], v11 offset:57856
  s_add_u32 m0, s76, 0
  s_add_u32 s72, s72, 128
  s_and_b32 s72, s72, 0x3ff
  v_mfma_f32_32x32x16_bf16 v[48:63], v[92:95], v[136:139], v[48:63]
  buffer_load_dwordx4 v2, s[16:19], s72 offen lds
  ds_read_b128 v[148:151], v7 offset:32768
  ds_read_b64_tr_b16 v[80:81], v12 offset:57344
  ds_read_b64_tr_b16 v[82:83], v12 offset:57856
  ds_read_b64_tr_b16 v[84:85], v13 offset:57344
  ds_read_b64_tr_b16 v[86:87], v13 offset:57856
  v_mfma_f32_32x32x16_bf16 v[32:47], v[96:99], v[140:143], v[32:47]
  ds_read_b128 v[152:155], v8 offset:32768
  ds_read_b64_tr_b16 v[88:89], v14 offset:57344
  ds_read_b64_tr_b16 v[90:91], v14 offset:57856
  ds_read_b64_tr_b16 v[92:93], v15 offset:57344
  ds_read_b64_tr_b16 v[94:95], v15 offset:57856
  s_add_u32 m0, s76, 1024
  v_mfma_f32_32x32x16_bf16 v[48:63], v[100:103], v[140:143], v[48:63]
  buffer_load_dwordx4 v3, s[16:19], s72 offen lds
  s_waitcnt lgkmcnt(12)
  v_mfma_f32_32x32x16_bf16 v[32:47], v[72:75], v[144:147], v[32:47]
  ds_read_b128 v[156:159], v9 offset:32768
  ds_read_b64_tr_b16 v[96:97], v16 offset:57344
  ds_read_b64_tr_b16 v[98:99], v16 offset:57856
  ds_read_b64_tr_b16 v[100:101], v17 offset:57344
  ds_read_b64_tr_b16 v[102:103], v17 offset:57856
  s_add_u32 m0, s77, 0
  s_waitcnt lgkmcnt(15)
  v_mfma_f32_32x32x16_bf16 v[48:63], v[76:79], v[144:147], v[48:63]
  buffer_load_dwordx4 v4, s[20:23], s72 offen lds
  v_mfma_f32_16x16x32_bf16 v[104:107], v[112:115], v[72:75], v[104:107]
  v_mfma_f32_16x16x32_bf16 v[108:111], v[112:115], v[76:79], v[108:111]
  s_waitcnt lgkmcnt(12)
  v_mfma_f32_32x32x16_bf16 v[32:47], v[80:83], v[148:151], v[32:47]
  s_add_u32 m0, s78, 24576
  s_waitcnt lgkmcnt(10)
  v_mfma_f32_32x32x16_bf16 v[48:63], v[84:87], v[148:151], v[48:63]
  buffer_load_dwordx4 v5, s[24:27], s51 offen lds
  s_waitcnt lgkmcnt(0)
  s_waitcnt vmcnt(4)
  s_barrier
  v_mfma_f32_32x32x16_bf16 v[32:47], v[88:91], v[152:155], v[32:47]
  v_add_u32 v6, 0x10000, v6
  v_add_u32 v7, 0x10000, v7
  v_add_u32 v8, 0x10000, v8
  v_add_u32 v9, 0x10000, v9
  v_add_u32 v10, 0x16000, v10
  v_add_u32 v11, 0x16000, v11
  v_add_u32 v12, 0x16000, v12
  v_add_u32 v13, 0x16000, v13
  v_add_u32 v14, 0x16000, v14
  v_add_u32 v15, 0x16000, v15
  v_add_u32 v16, 0x16000, v16
  v_add_u32 v17, 0x16000, v17
  ds_read_b128 v[160:163], v6 offset:0
  ds_read_b64_tr_b16 v[72:73], v10 offset:0
  ds_read_b64_tr_b16 v[74:75], v10 offset:512
  ds_read_b64_tr_b16 v[76:77], v11 offset:0
  ds_read_b64_tr_b16 v[78:79], v11 offset:512
  s_add_u32 m0, s76, 32768
  s_add_u32 s72, s72, 128
  s_and_b32 s72, s72, 0x3ff
  v_mfma_f32_32x32x16_bf16 v[48:63], v[92:95], v[152:155], v[48:63]
  buffer_load_dwordx4 v2, s[16:19], s72 offen lds
  ds_read_b128 v[164:167], v7 offset:0
  ds_read_b64_tr_b16 v[80:81], v12 offset:0
  ds_read_b64_tr_b16 v[82:83], v12 offset:512
  ds_read_b64_tr_b16 v[84:85], v13 offset:0
  ds_read_b64_tr_b16 v[86:87], v13 offset:512
  s_add_u32 m0, s78, 98304
  v_mfma_f32_32x32x16_bf16 v[32:47], v[96:99], v[156:159], v[32:47]
  ds_read_b128 v[168:171], v8 offset:0
  ds_read_b64_tr_b16 v[88:89], v14 offset:0
  ds_read_b64_tr_b16 v[90:91], v14 offset:512
  ds_read_b64_tr_b16 v[92:93], v15 offset:0
  ds_read_b64_tr_b16 v[94:95], v15 offset:512
  buffer_load_dwordx4 v71, s[24:27], s52 offen lds
  s_add_u32 m0, s76, 33792
  v_mfma_f32_32x32x16_bf16 v[48:63], v[100:103], v[156:159], v[48:63]
  buffer_load_dwordx4 v3, s[16:19], s72 offen lds
  v_readfirstlane_b32 s100, v236
  s_mov_b32 s98, 0x3f803f80
  v_dot2_f32_bf16 v248, v232, v232, 0
  v_dot2_f32_bf16 v246, s98, v232, 0
  s_mul_i32 s12, s100, 0x9E3779B1
  s_add_u32 s12, s12, 0x7F4A7C15
  s_or_b32 s12, s12, 8
  v_dot2_f32_bf16 v248, v233, v233, v248
  s_waitcnt lgkmcnt(12)
  v_mfma_f32_32x32x16_bf16 v[32:47], v[72:75], v[160:163], v[32:47]
  ds_read_b128 v[172:175], v9 offset:0
  ds_read_b64_tr_b16 v[96:97], v16 offset:0
  ds_read_b64_tr_b16 v[98:99], v16 offset:512
  ds_read_b64_tr_b16 v[100:101], v17 offset:0
  ds_read_b64_tr_b16 v[102:103], v17 offset:512
  v_dot2_f32_bf16 v246, s98, v233, v246
  v_dot2_f32_bf16 v248, v234, v234, v248
  v_dot2_f32_bf16 v246, s98, v234, v246
  v_dot2_f32_bf16 v248, v235, v235, v248
  v_dot2_f32_bf16 v246, s98, v235, v246
  v_mov_b32 v18, s12
  s_nop 0
  v_add_f32_dpp v248, v248, v248 quad_perm:[1,0,3,2] row_mask:0xf bank_mask:0xf
  v_add_f32_dpp v246, v246, v246 quad_perm:[1,0,3,2] row_mask:0xf bank_mask:0xf
  s_add_u32 m0, s77, 32768
  s_waitcnt lgkmcnt(15)
  v_mfma_f32_32x32x16_bf16 v[48:63], v[76:79], v[160:163], v[48:63]
  buffer_load_dwordx4 v4, s[20:23], s72 offen lds
  v_mfma_f32_16x16x32_bf16 v[104:107], v[112:115], v[72:75], v[104:107]
  v_mfma_f32_16x16x32_bf16 v[108:111], v[112:115], v[76:79], v[108:111]
  v_mov_b32 v247, s12
  v_add_f32_dpp v248, v248, v248 quad_perm:[2,3,0,1] row_mask:0xf bank_mask:0xf
  v_add_f32_dpp v246, v246, v246 quad_perm:[2,3,0,1] row_mask:0xf bank_mask:0xf
  s_xor_b32 s99, s12, s69
  v_add_f32_dpp v248, v248, v248 row_half_mirror row_mask:0xf bank_mask:0xf
  v_add_f32_dpp v246, v246, v246 row_half_mirror row_mask:0xf bank_mask:0xf
  v_mov_b32 v249, s99
  v_add_f32_dpp v248, v248, v248 row_mirror row_mask:0xf bank_mask:0xf
  s_waitcnt lgkmcnt(12)
  v_mfma_f32_32x32x16_bf16 v[32:47], v[80:83], v[164:167], v[32:47]
  v_add_f32_dpp v246, v246, v246 row_mirror row_mask:0xf bank_mask:0xf
  s_lshl_b32 s87, s87, 4
  v_add_f32_dpp v248, v248, v248 row_bcast:15 row_mask:0xa bank_mask:0xf
  v_add_f32_dpp v246, v246, v246 row_bcast:15 row_mask:0xa bank_mask:0xf
  s_add_u32 s87, s87, 0x1000
  v_add_f32_dpp v248, v248, v248 row_bcast:31 row_mask:0xc bank_mask:0xf
  v_add_f32_dpp v246, v246, v246 row_bcast:31 row_mask:0xc bank_mask:0xf
  v_mul_f32 v248, 0x3b000000, v248
  s_add_u32 m0, s78, 57344
  s_waitcnt lgkmcnt(10)
  v_mfma_f32_32x32x16_bf16 v[48:63], v[84:87], v[164:167], v[48:63]
  buffer_load_dwordx4 v5, s[24:27], s52 offen lds
  v_mul_f32 v246, 0x3b000000, v246
  v_fma_f32 v248, -v246, v246, v248
  v_max_f32 v248, 0, v248
  v_add_f32 v248, 0x3727c5ac, v248
  v_rsq_f32 v248, v248
  s_nop 0
  buffer_store_dwordx4 v[246:249], v238, s[28:31], s87 offen sc1
  s_waitcnt lgkmcnt(0)
  s_waitcnt vmcnt(6)
  s_barrier
  v_mfma_f32_32x32x16_bf16 v[32:47], v[88:91], v[168:171], v[32:47]
  v_add_u32 v6, 0xffff0000, v6
  v_add_u32 v7, 0xffff0000, v7
  v_add_u32 v8, 0xffff0000, v8
  v_add_u32 v9, 0xffff0000, v9
  v_add_u32 v10, 0xffff0000, v10
  v_add_u32 v11, 0xffff0000, v11
  v_add_u32 v12, 0xffff0000, v12
  v_add_u32 v13, 0xffff0000, v13
  v_add_u32 v14, 0xffff0000, v14
  v_add_u32 v15, 0xffff0000, v15
  v_add_u32 v16, 0xffff0000, v16
  v_add_u32 v17, 0xffff0000, v17
  ds_read_b128 v[176:179], v6 offset:0
  ds_read_b64_tr_b16 v[72:73], v10 offset:0
  ds_read_b64_tr_b16 v[74:75], v10 offset:512
  ds_read_b64_tr_b16 v[76:77], v11 offset:0
  ds_read_b64_tr_b16 v[78:79], v11 offset:512
  s_add_u32 m0, s76, 65536
  s_add_u32 s72, s72, 128
  s_and_b32 s72, s72, 0x3ff
  v_mfma_f32_32x32x16_bf16 v[48:63], v[92:95], v[168:171], v[48:63]
  buffer_load_dwordx4 v2, s[16:19], s72 offen lds
  ds_read_b128 v[180:183], v7 offset:0
  ds_read_b64_tr_b16 v[80:81], v12 offset:0
  ds_read_b64_tr_b16 v[82:83], v12 offset:512
  ds_read_b64_tr_b16 v[84:85], v13 offset:0
  ds_read_b64_tr_b16 v[86:87], v13 offset:512
  s_add_u32 m0, s78, 106496
  v_mfma_f32_32x32x16_bf16 v[32:47], v[96:99], v[172:175], v[32:47]
  ds_read_b128 v[184:187], v8 offset:0
  ds_read_b64_tr_b16 v[88:89], v14 offset:0
  ds_read_b64_tr_b16 v[90:91], v14 offset:512
  ds_read_b64_tr_b16 v[92:93], v15 offset:0
  ds_read_b64_tr_b16 v[94:95], v15 offset:512
  buffer_load_dwordx4 v71, s[24:27], s53 offen lds
  s_add_u32 m0, s76, 66560
  v_mfma_f32_32x32x16_bf16 v[48:63], v[100:103], v[172:175], v[48:63]
  buffer_load_dwordx4 v3, s[16:19], s72 offen lds
  s_waitcnt lgkmcnt(12)
  v_mfma_f32_32x32x16_bf16 v[32:47], v[72:75], v[176:179], v[32:47]
  ds_read_b128 v[188:191], v9 offset:0
  ds_read_b64_tr_b16 v[96:97], v16 offset:0
  ds_read_b64_tr_b16 v[98:99], v16 offset:512
  ds_read_b64_tr_b16 v[100:101], v17 offset:0
  ds_read_b64_tr_b16 v[102:103], v17 offset:512
  s_add_u32 m0, s77, 65536
  s_waitcnt lgkmcnt(15)
  v_mfma_f32_32x32x16_bf16 v[48:63], v[76:79], v[176:179], v[48:63]
  buffer_load_dwordx4 v4, s[20:23], s72 offen lds
  v_mfma_f32_16x16x32_bf16 v[104:107], v[112:115], v[72:75], v[104:107]
  v_mfma_f32_16x16x32_bf16 v[108:111], v[112:115], v[76:79], v[108:111]
  s_waitcnt lgkmcnt(12)
  v_mfma_f32_32x32x16_bf16 v[32:47], v[80:83], v[180:183], v[32:47]
  s_add_u32 m0, s78, 90112
  s_waitcnt lgkmcnt(10)
  v_mfma_f32_32x32x16_bf16 v[48:63], v[84:87], v[180:183], v[48:63]
  buffer_load_dwordx4 v5, s[24:27], s53 offen lds
  s_waitcnt lgkmcnt(0)
  s_waitcnt vmcnt(6)
  s_barrier
  v_mfma_f32_32x32x16_bf16 v[32:47], v[88:91], v[184:187], v[32:47]
  ds_read_b128 v[192:195], v6 offset:32768
  ds_read_b64_tr_b16 v[72:73], v10 offset:32768
  ds_read_b64_tr_b16 v[74:75], v10 offset:33280
  ds_read_b64_tr_b16 v[76:77], v11 offset:32768
  ds_read_b64_tr_b16 v[78:79], v11 offset:33280
  s_add_u32 m0, s76, 0
  s_add_u32 s72, s72, 128
  s_and_b32 s72, s72, 0x3ff
  v_mfma_f32_32x32x16_bf16 v[48:63], v[92:95], v[184:187], v[48:63]
  buffer_load_dwordx4 v2, s[16:19], s72 offen lds
  ds_read_b128 v[196:199], v7 offset:32768
  ds_read_b64_tr_b16 v[80:81], v12 offset:32768
  ds_read_b64_tr_b16 v[82:83], v12 offset:33280
  ds_read_b64_tr_b16 v[84:85], v13 offset:32768
  ds_read_b64_tr_b16 v[86:87], v13 offset:33280
  s_add_u32 m0, s78, 114688
  v_mfma_f32_32x32x16_bf16 v[32:47], v[96:99], v[188:191], v[32:47]
  ds_read_b128 v[200:203], v8 offset:32768
  ds_read_b64_tr_b16 v[88:89], v14 offset:32768
  ds_read_b64_tr_b16 v[90:91], v14 offset:33280
  ds_read_b64_tr_b16 v[92:93], v15 offset:32768
  ds_read_b64_tr_b16 v[94:95], v15 offset:33280
  buffer_load_dwordx4 v71, s[24:27], s54 offen lds
  s_add_u32 m0, s76, 1024
  v_mfma_f32_32x32x16_bf16 v[48:63], v[100:103], v[188:191], v[48:63]
  buffer_load_dwordx4 v3, s[16:19], s72 offen lds
  s_waitcnt lgkmcnt(12)
  v_mfma_f32_32x32x16_bf16 v[32:47], v[72:75], v[192:195], v[32:47]
  ds_read_b128 v[204:207], v9 offset:32768
  ds_read_b64_tr_b16 v[96:97], v16 offset:32768
  ds_read_b64_tr_b16 v[98:99], v16 offset:33280
  ds_read_b64_tr_b16 v[100:101], v17 offset:32768
  ds_read_b64_tr_b16 v[102:103], v17 offset:33280
  s_add_u32 m0, s77, 0
  s_waitcnt lgkmcnt(15)
  v_mfma_f32_32x32x16_bf16 v[48:63], v[76:79], v[192:195], v[48:63]
  buffer_load_dwordx4 v4, s[20:23], s72 offen lds
  v_mfma_f32_16x16x32_bf16 v[104:107], v[112:115], v[72:75], v[104:107]
  v_mfma_f32_16x16x32_bf16 v[108:111], v[112:115], v[76:79], v[108:111]
  s_waitcnt lgkmcnt(12)
  v_mfma_f32_32x32x16_bf16 v[32:47], v[80:83], v[196:199], v[32:47]
  s_add_u32 m0, s78, 24576
  s_waitcnt lgkmcnt(10)
  v_mfma_f32_32x32x16_bf16 v[48:63], v[84:87], v[196:199], v[48:63]
  buffer_load_dwordx4 v5, s[24:27], s54 offen lds
  s_waitcnt lgkmcnt(0)
  s_waitcnt vmcnt(5)
  s_barrier
  v_mfma_f32_32x32x16_bf16 v[32:47], v[88:91], v[200:203], v[32:47]
  v_add_u32 v6, 0x10000, v6
  v_add_u32 v7, 0x10000, v7
  v_add_u32 v8, 0x10000, v8
  v_add_u32 v9, 0x10000, v9
  v_add_u32 v10, 0x10000, v10
  v_add_u32 v11, 0x10000, v11
  v_add_u32 v12, 0x10000, v12
  v_add_u32 v13, 0x10000, v13
  v_add_u32 v14, 0x10000, v14
  v_add_u32 v15, 0x10000, v15
  v_add_u32 v16, 0x10000, v16
  v_add_u32 v17, 0x10000, v17
  ds_read_b128 v[208:211], v6 offset:0
  ds_read_b64_tr_b16 v[72:73], v10 offset:0
  ds_read_b64_tr_b16 v[74:75], v10 offset:512
  ds_read_b64_tr_b16 v[76:77], v11 offset:0
  ds_read_b64_tr_b16 v[78:79], v11 offset:512
  s_add_u32 m0, s76, 32768
  s_add_u32 s72, s72, 128
  s_and_b32 s72, s72, 0x3ff
  v_mfma_f32_32x32x16_bf16 v[48:63], v[92:95], v[200:203], v[48:63]
  buffer_load_dwordx4 v2, s[16:19], s72 offen lds
  ds_read_b128 v[212:215], v7 offset:0
  ds_read_b64_tr_b16 v[80:81], v12 offset:0
  ds_read_b64_tr_b16 v[82:83], v12 offset:512
  ds_read_b64_tr_b16 v[84:85], v13 offset:0
  ds_read_b64_tr_b16 v[86:87], v13 offset:512
  s_add_u32 m0, s78, 122880
  v_mfma_f32_32x32x16_bf16 v[32:47], v[96:99], v[204:207], v[32:47]
  ds_read_b128 v[216:219], v8 offset:0
  ds_read_b64_tr_b16 v[88:89], v14 offset:0
  ds_read_b64_tr_b16 v[90:91], v14 offset:512
  ds_read_b64_tr_b16 v[92:93], v15 offset:0
  ds_read_b64_tr_b16 v[94:95], v15 offset:512
  buffer_load_dwordx4 v71, s[24:27], s55 offen lds
  s_add_u32 m0, s76, 33792
  v_mfma_f32_32x32x16_bf16 v[48:63], v[100:103], v[204:207], v[48:63]
  buffer_load_dwordx4 v3, s[16:19], s72 offen lds
  s_waitcnt lgkmcnt(12)
  v_mfma_f32_32x32x16_bf16 v[32:47], v[72:75], v[208:211], v[32:47]
  ds_read_b128 v[220:223], v9 offset:0
  ds_read_b64_tr_b16 v[96:97], v16 offset:0
  ds_read_b64_tr_b16 v[98:99], v16 offset:512
  ds_read_b64_tr_b16 v[100:101], v17 offset:0
  ds_read_b64_tr_b16 v[102:103], v17 offset:512
  s_add_u32 m0, s77, 32768
  s_waitcnt lgkmcnt(15)
  v_mfma_f32_32x32x16_bf16 v[48:63], v[76:79], v[208:211], v[48:63]
  buffer_load_dwordx4 v4, s[20:23], s72 offen lds
  v_mfma_f32_16x16x32_bf16 v[104:107], v[112:115], v[72:75], v[104:107]
  v_mfma_f32_16x16x32_bf16 v[108:111], v[112:115], v[76:79], v[108:111]
  s_waitcnt lgkmcnt(12)
  v_mfma_f32_32x32x16_bf16 v[32:47], v[80:83], v[212:215], v[32:47]
  s_add_u32 m0, s78, 57344
  s_waitcnt lgkmcnt(10)
  v_mfma_f32_32x32x16_bf16 v[48:63], v[84:87], v[212:215], v[48:63]
  buffer_load_dwordx4 v5, s[24:27], s55 offen lds
  s_waitcnt lgkmcnt(0)
  s_waitcnt vmcnt(5)
  s_barrier
  v_mfma_f32_32x32x16_bf16 v[32:47], v[88:91], v[216:219], v[32:47]
  v_add_u32 v6, 0xffff0000, v6
  v_add_u32 v7, 0xffff0000, v7
  v_add_u32 v8, 0xffff0000, v8
  v_add_u32 v9, 0xffff0000, v9
  v_add_u32 v10, 0xffff0000, v10
  v_add_u32 v11, 0xffff0000, v11
  v_add_u32 v12, 0xffff0000, v12
  v_add_u32 v13, 0xffff0000, v13
  v_add_u32 v14, 0xffff0000, v14
  v_add_u32 v15, 0xffff0000, v15
  v_add_u32 v16, 0xffff0000, v16
  v_add_u32 v17, 0xffff0000, v17
  ds_read_b128 v[224:227], v6 offset:0
  ds_read_b64_tr_b16 v[72:73], v10 offset:0
  ds_read_b64_tr_b16 v[74:75], v10 offset:512
  ds_read_b64_tr_b16 v[76:77], v11 offset:0
  ds_read_b64_tr_b16 v[78:79], v11 offset:512
  s_lshl_b32 s14, s5, 11
  s_lshl_b32 s15, s4, 9
  s_add_u32 s14, s14, s15
  s_add_u32 s82, s14, 0x1000
  buffer_load_dwordx4 v[64:67], v24, s[28:31], s82 offen sc1
  s_add_u32 m0, s78, 65536
  v_mfma_f32_32x32x16_bf16 v[48:63], v[92:95], v[216:219], v[48:63]
  buffer_load_dwordx4 v71, s[24:27], s48 offen lds
  ds_read_b128 v[228:231], v7 offset:0
  ds_read_b64_tr_b16 v[80:81], v12 offset:0
  ds_read_b64_tr_b16 v[82:83], v12 offset:512
  ds_read_b64_tr_b16 v[84:85], v13 offset:0
  ds_read_b64_tr_b16 v[86:87], v13 offset:512
  v_mfma_f32_32x32x16_bf16 v[32:47], v[96:99], v[220:223], v[32:47]
  ds_read_b128 v[232:235], v8 offset:0
  ds_read_b64_tr_b16 v[88:89], v14 offset:0
  ds_read_b64_tr_b16 v[90:91], v14 offset:512
  ds_read_b64_tr_b16 v[92:93], v15 offset:0
  ds_read_b64_tr_b16 v[94:95], v15 offset:512
  s_add_u32 m0, s78, 73728
  v_mfma_f32_32x32x16_bf16 v[48:63], v[100:103], v[220:223], v[48:63]
  buffer_load_dwordx4 v71, s[24:27], s49 offen lds
  s_waitcnt lgkmcnt(12)
  v_mfma_f32_32x32x16_bf16 v[32:47], v[72:75], v[224:227], v[32:47]
  ds_read_b128 v[236:239], v9 offset:0
  ds_read_b64_tr_b16 v[96:97], v16 offset:0
  ds_read_b64_tr_b16 v[98:99], v16 offset:512
  ds_read_b64_tr_b16 v[100:101], v17 offset:0
  ds_read_b64_tr_b16 v[102:103], v17 offset:512
  s_add_u32 m0, s78, 81920
  s_waitcnt lgkmcnt(15)
  v_mfma_f32_32x32x16_bf16 v[48:63], v[76:79], v[224:227], v[48:63]
  buffer_load_dwordx4 v71, s[24:27], s50 offen lds
  v_mfma_f32_16x16x32_bf16 v[104:107], v[112:115], v[72:75], v[104:107]
  v_mfma_f32_16x16x32_bf16 v[108:111], v[112:115], v[76:79], v[108:111]
  s_waitcnt lgkmcnt(12)
  v_mfma_f32_32x32x16_bf16 v[32:47], v[80:83], v[228:231], v[32:47]
  s_add_u32 m0, s78, 90112
  s_waitcnt lgkmcnt(10)
  v_mfma_f32_32x32x16_bf16 v[48:63], v[84:87], v[228:231], v[48:63]
  buffer_load_dwordx4 v71, s[24:27], s51 offen lds
  s_waitcnt lgkmcnt(0)
  s_waitcnt vmcnt(5)
  s_barrier
  v_mfma_f32_32x32x16_bf16 v[32:47], v[88:91], v[232:235], v[32:47]
  ds_read_b128 v[240:243], v6 offset:32768
  ds_read_b64_tr_b16 v[72:73], v10 offset:32768
  ds_read_b64_tr_b16 v[74:75], v10 offset:33280
  ds_read_b64_tr_b16 v[76:77], v11 offset:32768
  ds_read_b64_tr_b16 v[78:79], v11 offset:33280
  s_add_u32 m0, s71, 131072
  s_lshl_b32 s87, s9, 17
  s_add_u32 s87, s87, s70
  v_mfma_f32_32x32x16_bf16 v[48:63], v[92:95], v[232:235], v[48:63]
  buffer_load_dwordx4 v28, s[32:35], s87 offen lds
  ds_read_b128 v[244:247], v7 offset:32768
  ds_read_b64_tr_b16 v[80:81], v12 offset:32768
  ds_read_b64_tr_b16 v[82:83], v12 offset:33280
  ds_read_b64_tr_b16 v[84:85], v13 offset:32768
  ds_read_b64_tr_b16 v[86:87], v13 offset:33280
  v_mfma_f32_32x32x16_bf16 v[32:47], v[96:99], v[236:239], v[32:47]
  ds_read_b128 v[248:251], v8 offset:32768
  ds_read_b64_tr_b16 v[88:89], v14 offset:32768
  ds_read_b64_tr_b16 v[90:91], v14 offset:33280
  ds_read_b64_tr_b16 v[92:93], v15 offset:32768
  ds_read_b64_tr_b16 v[94:95], v15 offset:33280
  s_add_u32 m0, s71, 135168
  s_add_u32 s87, s87, 0x4000
  v_mfma_f32_32x32x16_bf16 v[48:63], v[100:103], v[236:239], v[48:63]
  buffer_load_dwordx4 v28, s[32:35], s87 offen lds
  s_waitcnt vmcnt(6)
  v_cmp_ne_u32 vcc, s12, v65
  v_xor_b32 v65, s12, v67
  v_cmp_lt_u32 s[98:99], 7, v65
  s_nop 0
  s_or_b64 vcc, vcc, s[98:99]
  s_cbranch_vccz L_bk113
L_in112:
  s_sub_u32 s13, s13, 1
  s_cbranch_scc1 L_sl114
  buffer_load_dwordx4 v[64:67], v24, s[28:31], s82 offen sc1
  s_waitcnt vmcnt(0)
  v_cmp_ne_u32 vcc, s12, v65
  s_nop 1
  v_xor_b32 v65, s12, v67
  s_nop 1
  v_cmp_lt_u32 s[98:99], 7, v65
  s_nop 1
  s_or_b64 vcc, vcc, s[98:99]
  s_cbranch_vccnz L_in112
L_bk113:
  v_sub_f32 v22, 0, v64
  v_mul_f32 v23, 0xbfb8aa3b, v66
  v_mov_b32 v24, 1
  s_waitcnt lgkmcnt(12)
  v_mfma_f32_32x32x16_bf16 v[32:47], v[72:75], v[240:243], v[32:47]
  ds_read_b128 v[252:255], v9 offset:32768
  ds_read_b64_tr_b16 v[96:97], v16 offset:32768
  ds_read_b64_tr_b16 v[98:99], v16 offset:33280
  ds_read_b64_tr_b16 v[100:101], v17 offset:32768
  ds_read_b64_tr_b16 v[102:103], v17 offset:33280
  v_cmp_gt_u32 vcc, 32, v0
  v_mov_b32 v4, 0
  v_mov_b32 v5, 0
  v_cndmask_b32 v3, 0, v22, vcc
  v_cvt_pk_bf16_f32 v2, v3, v3
  s_add_u32 m0, s71, 0
  s_add_u32 s87, s87, 0x4000
  s_waitcnt lgkmcnt(15)
  v_mfma_f32_32x32x16_bf16 v[48:63], v[76:79], v[240:243], v[48:63]
  buffer_load_dwordx4 v28, s[32:35], s87 offen lds
  v_mfma_f32_16x16x32_bf16 v[104:107], v[112:115], v[72:75], v[104:107]
  v_mfma_f32_16x16x32_bf16 v[108:111], v[112:115], v[76:79], v[108:111]
  v_and_b32 v4, 0xffff0000, v2
  v_sub_f32 v3, v3, v4
  s_waitcnt lgkmcnt(12)
  v_mfma_f32_32x32x16_bf16 v[32:47], v[80:83], v[244:247], v[32:47]
  s_cmp_eq_u32 s9, 3
  s_cselect_b32 s86, 64, 0
  v_xor_b32 v10, s86, v10
  v_xor_b32 v11, s86, v12
  v_xor_b32 v12, s86, v14
  v_xor_b32 v13, s86, v16
  v_lshrrev_b32 v16, 3, v0
  v_and_b32 v17, 0x70, v1
  v_lshl_add_u32 v16, v16, 13, v17
  v_add_u32 v17, 0x1000, v16
  v_mov_b32 v4, 0
  v_cvt_pk_bf16_f32 v3, v3, 0
  s_add_u32 m0, s71, 4096
  s_add_u32 s87, s87, 0x4000
  s_waitcnt lgkmcnt(10)
  v_mfma_f32_32x32x16_bf16 v[48:63], v[84:87], v[244:247], v[48:63]
  buffer_load_dwordx4 v28, s[32:35], s87 offen lds
  v_lshrrev_b32 v14, 1, v0
  v_and_b32 v15, 1, v0
  v_lshlrev_b32 v14, 11, v14
  v_lshl_add_u32 v14, v15, 6, v14
  buffer_load_dword v15, v14, s[44:47], s56 offen
  v_cmp_gt_u32 vcc, 32, v0
  s_nop 1
  v_cndmask_b32 v125, v108, v104, vcc
  s_lshl_b32 s86, s4, 2
  s_add_u32 s86, s86, 0x22000
  v_add_u32 v124, s86, v1
  ds_write_b32 v124, v125
  s_waitcnt lgkmcnt(0)
  s_barrier
  s_setprio 1
  v_mfma_f32_32x32x16_bf16 v[32:47], v[88:91], v[248:251], v[32:47]
  v_and_b32 v124, 0x1f0, v1
  v_add_u32 v124, 0x22000, v124
  ds_read_b128 v[6:9], v124
  ds_read_b128 v[28:31], v124 offset:512
  ds_read_b32 v27, v20 offset:16
  v_add_u32 v10, 0xa000, v10
  v_add_u32 v11, 0xa000, v11
  v_add_u32 v12, 0xa000, v12
  v_add_u32 v13, 0xa000, v13
  ds_read_b64_tr_b16 v[80:81], v10 offset:32768
  ds_read_b64_tr_b16 v[82:83], v10 offset:33280
  v_mfma_f32_32x32x16_bf16 v[48:63], v[92:95], v[248:251], v[48:63]
  ds_read_b64_tr_b16 v[84:85], v11 offset:32768
  ds_read_b64_tr_b16 v[86:87], v11 offset:33280
  v_mfma_f32_32x32x16_bf16 v[32:47], v[96:99], v[252:255], v[32:47]
  ds_read_b64_tr_b16 v[108:109], v12 offset:32768
  ds_read_b64_tr_b16 v[110:111], v12 offset:33280
  s_waitcnt lgkmcnt(8)
  v_add_f32 v6, v6, v7
  v_add_f32 v8, v8, v9
  v_mov_b32 v9, 0
  v_add_f32 v6, v6, v8
  v_cvt_pk_bf16_f32 v7, v6, 0
  v_lshlrev_b32 v8, 16, v7
  v_sub_f32 v6, v6, v8
  v_cvt_pk_bf16_f32 v6, v8, v6
  v_mfma_f32_32x32x16_bf16 v[48:63], v[100:103], v[252:255], v[48:63]
  s_waitcnt lgkmcnt(7)
  v_add_f32 v28, v28, v29
  v_add_f32 v30, v30, v31
  v_mov_b32 v31, 0
  v_add_f32 v28, v28, v30
  v_cvt_pk_bf16_f32 v29, v28, 0
  v_lshlrev_b32 v30, 16, v29
  v_sub_f32 v28, v28, v30
  v_cvt_pk_bf16_f32 v28, v30, v28
  v_mfma_f32_32x32x16_bf16 v[32:47], v[6:9], v[2:5], v[32:47]
  ds_read_b64_tr_b16 v[88:89], v13 offset:32768
  ds_read_b64_tr_b16 v[90:91], v13 offset:33280
  s_waitcnt lgkmcnt(8)
  v_readfirstlane_b32 s14, v27
  s_lshr_b32 s15, s8, 1
  s_lshl_b32 s15, s15, 4
  s_lshr_b32 s14, s14, s15
  s_and_b32 s14, s14, 0xffff
  s_cmp_eq_u32 s14, 0x101
  s_cbranch_scc0 L_Xslow
  v_mfma_f32_32x32x16_bf16 v[48:63], v[28:31], v[2:5], v[48:63]
  s_waitcnt lgkmcnt(4)
  v_mfma_f32_32x32x16_bf16 v[64:79], v[80:83], v[192:195], 0
  ds_read_b64_tr_b16 v[92:93], v10 offset:40960
  ds_read_b64_tr_b16 v[94:95], v10 offset:41472
  v_mfma_f32_16x16x32_bf16 v[104:107], v[112:115], v[80:83], 0
  v_mfma_f32_32x32x16_bf16 v[64:79], v[84:87], v[196:199], v[64:79]
  ds_read_b64_tr_b16 v[96:97], v11 offset:40960
  ds_read_b64_tr_b16 v[98:99], v11 offset:41472
  v_mul_f32 v32, v23, v32
  v_mul_f32 v33, v23, v33
  v_mul_f32 v34, v23, v34
  v_mul_f32 v35, v23, v35
  v_exp_f32 v28, v32
  v_exp_f32 v29, v33
  v_exp_f32 v30, v34
  s_waitcnt lgkmcnt(4)
  v_mfma_f32_32x32x16_bf16 v[64:79], v[108:111], v[200:203], v[64:79]
  ds_read_b64_tr_b16 v[100:101], v12 offset:40960
  ds_read_b64_tr_b16 v[102:103], v12 offset:41472
  v_exp_f32 v31, v35
  v_add_f32 v28, 1.0, v28
  v_add_f32 v29, 1.0, v29
  v_add_f32 v30, 1.0, v30
  v_add_f32 v31, 1.0, v31
  v_rcp_f32 v28, v28
  v_mfma_f32_32x32x16_bf16 v[64:79], v[88:91], v[204:207], v[64:79]
  ds_read_b64_tr_b16 v[80:81], v13 offset:40960
  ds_read_b64_tr_b16 v[82:83], v13 offset:41472
  v_rcp_f32 v29, v29
  v_rcp_f32 v30, v30
  v_rcp_f32 v31, v31
  v_mul_f32 v32, v32, v28
  v_mul_f32 v33, v33, v29
  v_mul_f32 v34, v34, v30
  s_waitcnt lgkmcnt(4)
  v_mfma_f32_32x32x16_bf16 v[64:79], v[92:95], v[208:211], v[64:79]
  ds_read_b64_tr_b16 v[84:85], v10 offset:49152
  ds_read_b64_tr_b16 v[86:87], v10 offset:49664
  v_mfma_f32_16x16x32_bf16 v[104:107], v[112:115], v[92:95], v[104:107]
  s_waitcnt vmcnt(5)
  ds_write_b8 v21, v24 offset:88
  v_mul_f32 v35, v35, v31
  v_mul_f32 v36, v23, v36
  v_mul_f32 v37, v23, v37
  v_mul_f32 v38, v23, v38
  v_mul_f32 v39, v23, v39
  v_exp_f32 v28, v36
  v_mfma_f32_32x32x16_bf16 v[64:79], v[96:99], v[212:215], v[64:79]
  ds_read_b64_tr_b16 v[108:109], v11 offset:49152
  ds_read_b64_tr_b16 v[110:111], v11 offset:49664
  v_exp_f32 v29, v37
  v_exp_f32 v30, v38
  v_exp_f32 v31, v39
  v_add_f32 v28, 1.0, v28
  v_add_f32 v29, 1.0, v29
  v_add_f32 v30, 1.0, v30
  s_waitcnt lgkmcnt(5)
  v_mfma_f32_32x32x16_bf16 v[64:79], v[100:103], v[216:219], v[64:79]
  ds_read_b64_tr_b16 v[88:89], v12 offset:49152
  ds_read_b64_tr_b16 v[90:91], v12 offset:49664
  v_add_f32 v31, 1.0, v31
  v_rcp_f32 v28, v28
  v_rcp_f32 v29, v29
  v_rcp_f32 v30, v30
  v_rcp_f32 v31, v31
  v_mul_f32 v36, v36, v28
  v_mfma_f32_32x32x16_bf16 v[64:79], v[80:83], v[220:223], v[64:79]
  ds_read_b64_tr_b16 v[92:93], v13 offset:49152
  ds_read_b64_tr_b16 v[94:95], v13 offset:49664
  v_mul_f32 v37, v37, v29
  v_mul_f32 v38, v38, v30
  v_mul_f32 v39, v39, v31
  v_cvt_pk_bf16_f32 v32, v32, v33
  v_cvt_pk_bf16_f32 v33, v34, v35
  v_cvt_pk_bf16_f32 v34, v36, v37
  s_waitcnt lgkmcnt(4)
  v_mfma_f32_32x32x16_bf16 v[64:79], v[84:87], v[224:227], v[64:79]
  ds_read_b64_tr_b16 v[96:97], v10 offset:57344
  ds_read_b64_tr_b16 v[98:99], v10 offset:57856
  v_mfma_f32_16x16x32_bf16 v[104:107], v[112:115], v[84:87], v[104:107]
  v_cvt_pk_bf16_f32 v35, v38, v39
  buffer_store_dwordx4 v[32:35], v16, s[44:47], s56 offen offset:0
  v_mul_f32 v40, v23, v40
  v_mul_f32 v41, v23, v41
  v_mul_f32 v42, v23, v42
  v_mul_f32 v43, v23, v43
  v_mfma_f32_32x32x16_bf16 v[64:79], v[108:111], v[228:231], v[64:79]
  ds_read_b64_tr_b16 v[100:101], v11 offset:57344
  ds_read_b64_tr_b16 v[102:103], v11 offset:57856
  ds_read_b64 v[124:125], v20 offset:88
  v_exp_f32 v28, v40
  v_exp_f32 v29, v41
  v_exp_f32 v30, v42
  v_exp_f32 v31, v43
  v_add_f32 v28, 1.0, v28
  v_add_f32 v29, 1.0, v29
  s_waitcnt lgkmcnt(5)
  v_mfma_f32_32x32x16_bf16 v[64:79], v[88:91], v[232:235], v[64:79]
  ds_read_b64_tr_b16 v[80:81], v12 offset:57344
  ds_read_b64_tr_b16 v[82:83], v12 offset:57856
  v_add_f32 v30, 1.0, v30
  v_add_f32 v31, 1.0, v31
  v_rcp_f32 v28, v28
  v_rcp_f32 v29, v29
  v_rcp_f32 v30, v30
  v_rcp_f32 v31, v31
  v_mfma_f32_32x32x16_bf16 v[64:79], v[92:95], v[236:239], v[64:79]
  ds_read_b64_tr_b16 v[84:85], v13 offset:57344
  ds_read_b64_tr_b16 v[86:87], v13 offset:57856
  s_waitcnt lgkmcnt(4)
  v_readfirstlane_b32 s14, v124
  v_readfirstlane_b32 s15, v125
  s_nop 0
  s_and_b32 s14, s14, s15
  s_cmp_eq_u32 s14, 0x01010101
  s_cbranch_scc1 L_bk116
L_in115:
  s_sub_u32 s13, s13, 1
  s_cbranch_scc1 L_sl117
  ds_read_b64 v[124:125], v20 offset:88
  s_waitcnt lgkmcnt(0)
  v_readfirstlane_b32 s14, v124
  s_nop 1
  v_readfirstlane_b32 s15, v125
  s_nop 1
  s_and_b32 s14, s14, s15
  s_cmp_eq_u32 s14, 0x01010101
  s_cbranch_scc0 L_in115
L_bk116:
  v_mul_f32 v40, v40, v28
  v_mul_f32 v41, v41, v29
  v_mul_f32 v42, v42, v30
  v_mul_f32 v43, v43, v31
  v_mul_f32 v44, v23, v44
  v_mul_f32 v45, v23, v45
  v_mfma_f32_32x32x16_bf16 v[64:79], v[96:99], v[240:243], v[64:79]
  ds_read_b64_tr_b16 v[108:109], v10 offset:0
  ds_read_b64_tr_b16 v[110:111], v10 offset:512
  v_mfma_f32_16x16x32_bf16 v[104:107], v[112:115], v[96:99], v[104:107]
  v_mul_f32 v46, v23, v46
  v_mul_f32 v47, v23, v47
  v_exp_f32 v28, v44
  v_exp_f32 v29, v45
  v_exp_f32 v30, v46
  v_exp_f32 v31, v47
  v_mfma_f32_32x32x16_bf16 v[64:79], v[100:103], v[244:247], v[64:79]
  ds_read_b64_tr_b16 v[88:89], v11 offset:0
  ds_read_b64_tr_b16 v[90:91], v11 offset:512
  v_add_f32 v28, 1.0, v28
  v_add_f32 v29, 1.0, v29
  v_add_f32 v30, 1.0, v30
  v_add_f32 v31, 1.0, v31
  v_rcp_f32 v28, v28
  v_rcp_f32 v29, v29
  s_waitcnt lgkmcnt(4)
  v_mfma_f32_32x32x16_bf16 v[64:79], v[80:83], v[248:251], v[64:79]
  ds_read_b64_tr_b16 v[92:93], v12 offset:0
  ds_read_b64_tr_b16 v[94:95], v12 offset:512
  v_rcp_f32 v30, v30
  v_rcp_f32 v31, v31
  v_mul_f32 v44, v44, v28
  v_mul_f32 v45, v45, v29
  v_mul_f32 v46, v46, v30
  v_mul_f32 v47, v47, v31
  v_mfma_f32_32x32x16_bf16 v[64:79], v[84:87], v[252:255], v[64:79]
  ds_read_b64_tr_b16 v[96:97], v13 offset:0
  ds_read_b64_tr_b16 v[98:99], v13 offset:512
  v_cvt_pk_bf16_f32 v36, v40, v41
  v_cvt_pk_bf16_f32 v37, v42, v43
  v_cvt_pk_bf16_f32 v38, v44, v45
  v_cvt_pk_bf16_f32 v39, v46, v47
  buffer_store_dwordx4 v[36:39], v16, s[44:47], s56 offen offset:2048
  v_mul_f32 v48, v23, v48
  s_waitcnt lgkmcnt(4)
  v_mfma_f32_32x32x16_bf16 v[64:79], v[108:111], v[128:131], v[64:79]
  ds_read_b64_tr_b16 v[100:101], v10 offset:8192
  ds_read_b64_tr_b16 v[102:103], v10 offset:8704
  v_mfma_f32_16x16x32_bf16 v[104:107], v[112:115], v[108:111], v[104:107]
  s_waitcnt vmcnt(3)
  ds_write_b8 v21, v24 offset:4
  v_mul_f32 v49, v23, v49
  v_mul_f32 v50, v23, v50
  v_mul_f32 v51, v23, v51
  v_exp_f32 v28, v48
  v_exp_f32 v29, v49
  v_exp_f32 v30, v50
  v_mfma_f32_32x32x16_bf16 v[64:79], v[88:91], v[132:135], v[64:79]
  ds_read_b64_tr_b16 v[80:81], v11 offset:8192
  ds_read_b64_tr_b16 v[82:83], v11 offset:8704
  v_exp_f32 v31, v51
  v_add_f32 v28, 1.0, v28
  v_add_f32 v29, 1.0, v29
  v_add_f32 v30, 1.0, v30
  v_add_f32 v31, 1.0, v31
  v_rcp_f32 v28, v28
  s_waitcnt lgkmcnt(5)
  v_mfma_f32_32x32x16_bf16 v[64:79], v[92:95], v[136:139], v[64:79]
  ds_read_b64_tr_b16 v[84:85], v12 offset:8192
  ds_read_b64_tr_b16 v[86:87], v12 offset:8704
  v_rcp_f32 v29, v29
  v_rcp_f32 v30, v30
  v_rcp_f32 v31, v31
  v_mul_f32 v48, v48, v28
  v_mul_f32 v49, v49, v29
  v_mul_f32 v50, v50, v30
  v_mfma_f32_32x32x16_bf16 v[64:79], v[96:99], v[140:143], v[64:79]
  ds_read_b64_tr_b16 v[108:109], v13 offset:8192
  ds_read_b64_tr_b16 v[110:111], v13 offset:8704
  v_mul_f32 v51, v51, v31
  v_mul_f32 v52, v23, v52
  v_mul_f32 v53, v23, v53
  v_mul_f32 v54, v23, v54
  v_mul_f32 v55, v23, v55
  v_exp_f32 v28, v52
  s_waitcnt lgkmcnt(4)
  v_mfma_f32_32x32x16_bf16 v[64:79], v[100:103], v[144:147], v[64:79]
  ds_read_b64_tr_b16 v[88:89], v10 offset:16384
  ds_read_b64_tr_b16 v[90:91], v10 offset:16896
  v_mfma_f32_16x16x32_bf16 v[104:107], v[112:115], v[100:103], v[104:107]
  v_exp_f32 v29, v53
  v_exp_f32 v30, v54
  v_exp_f32 v31, v55
  v_add_f32 v28, 1.0, v28
  v_add_f32 v29, 1.0, v29
  v_add_f32 v30, 1.0, v30
  v_mfma_f32_32x32x16_bf16 v[64:79], v[80:83], v[148:151], v[64:79]
  ds_read_b64_tr_b16 v[92:93], v11 offset:16384
  ds_read_b64_tr_b16 v[94:95], v11 offset:16896
  v_add_f32 v31, 1.0, v31
  v_rcp_f32 v28, v28
  v_rcp_f32 v29, v29
  v_rcp_f32 v30, v30
  v_rcp_f32 v31, v31
  v_mul_f32 v52, v52, v28
  s_waitcnt lgkmcnt(4)
  v_mfma_f32_32x32x16_bf16 v[64:79], v[84:87], v[152:155], v[64:79]
  ds_read_b64_tr_b16 v[96:97], v12 offset:16384
  ds_read_b64_tr_b16 v[98:99], v12 offset:16896
  v_mul_f32 v53, v53, v29
  v_mul_f32 v54, v54, v30
  v_mul_f32 v55, v55, v31
  s_waitcnt vmcnt(0)
  buffer_store_dword v18, v19, s[28:31], s84 offen offset:0
  v_cvt_pk_bf16_f32 v40, v48, v49
  v_cvt_pk_bf16_f32 v41, v50, v51
  v_mfma_f32_32x32x16_bf16 v[64:79], v[108:111], v[156:159], v[64:79]
  ds_read_b64_tr_b16 v[100:101], v13 offset:16384
  ds_read_b64_tr_b16 v[102:103], v13 offset:16896
  v_cvt_pk_bf16_f32 v42, v52, v53
  v_cvt_pk_bf16_f32 v43, v54, v55
  buffer_store_dwordx4 v[40:43], v17, s[44:47], s56 offen offset:0
  v_mul_f32 v56, v23, v56
  v_mul_f32 v57, v23, v57
  v_mul_f32 v58, v23, v58
  s_waitcnt lgkmcnt(4)
  v_mfma_f32_32x32x16_bf16 v[64:79], v[88:91], v[160:163], v[64:79]
  ds_read_b64_tr_b16 v[80:81], v10 offset:24576
  ds_read_b64_tr_b16 v[82:83], v10 offset:25088
  v_mfma_f32_16x16x32_bf16 v[104:107], v[112:115], v[88:91], v[104:107]
  v_mul_f32 v59, v23, v59
  v_exp_f32 v28, v56
  v_exp_f32 v29, v57
  v_exp_f32 v30, v58
  v_exp_f32 v31, v59
  v_add_f32 v28, 1.0, v28
  v_mfma_f32_32x32x16_bf16 v[64:79], v[92:95], v[164:167], v[64:79]
  ds_read_b64_tr_b16 v[84:85], v11 offset:24576
  ds_read_b64_tr_b16 v[86:87], v11 offset:25088
  v_add_f32 v29, 1.0, v29
  v_add_f32 v30, 1.0, v30
  v_add_f32 v31, 1.0, v31
  v_rcp_f32 v28, v28
  v_rcp_f32 v29, v29
  v_rcp_f32 v30, v30
  s_waitcnt lgkmcnt(4)
  v_mfma_f32_32x32x16_bf16 v[64:79], v[96:99], v[168:171], v[64:79]
  ds_read_b64_tr_b16 v[108:109], v12 offset:24576
  ds_read_b64_tr_b16 v[110:111], v12 offset:25088
  v_rcp_f32 v31, v31
  v_mul_f32 v56, v56, v28
  v_mul_f32 v57, v57, v29
  v_mul_f32 v58, v58, v30
  v_mul_f32 v59, v59, v31
  v_mul_f32 v60, v23, v60
  v_mfma_f32_32x32x16_bf16 v[64:79], v[100:103], v[172:175], v[64:79]
  ds_read_b64_tr_b16 v[88:89], v13 offset:24576
  ds_read_b64_tr_b16 v[90:91], v13 offset:25088
  v_mul_f32 v61, v23, v61
  v_mul_f32 v62, v23, v62
  v_mul_f32 v63, v23, v63
  v_exp_f32 v28, v60
  v_exp_f32 v29, v61
  v_exp_f32 v30, v62
  s_waitcnt lgkmcnt(4)
  v_mfma_f32_32x32x16_bf16 v[64:79], v[80:83], v[176:179], v[64:79]
  v_xor_b32 v10, 64, v10
  ds_read_b64_tr_b16 v[92:93], v10 offset:32768
  ds_read_b64_tr_b16 v[94:95], v10 offset:33280
  v_mfma_f32_16x16x32_bf16 v[104:107], v[112:115], v[80:83], v[104:107]
  v_exp_f32 v31, v63
  v_add_f32 v28, 1.0, v28
  v_add_f32 v29, 1.0, v29
  v_add_f32 v30, 1.0, v30
  v_add_f32 v31, 1.0, v31
  v_rcp_f32 v28, v28
  v_mfma_f32_32x32x16_bf16 v[64:79], v[84:87], v[180:183], v[64:79]
  v_xor_b32 v11, 64, v11
  ds_read_b64_tr_b16 v[96:97], v11 offset:32768
  ds_read_b64_tr_b16 v[98:99], v11 offset:33280
  v_rcp_f32 v29, v29
  v_rcp_f32 v30, v30
  v_rcp_f32 v31, v31
  v_mul_f32 v60, v60, v28
  v_mul_f32 v61, v61, v29
  v_mul_f32 v62, v62, v30
  s_waitcnt lgkmcnt(4)
  v_mfma_f32_32x32x16_bf16 v[64:79], v[108:111], v[184:187], v[64:79]
  v_xor_b32 v12, 64, v12
  ds_read_b64_tr_b16 v[100:101], v12 offset:32768
  ds_read_b64_tr_b16 v[102:103], v12 offset:33280
  s_lshl_b32 s86, s4, 2
  s_add_u32 s86, s86, 0x26600
  v_and_b32 v124, 0x1f0, v1
  v_add_u32 v124, s86, v124
  ds_write_b32 v124, v104
  ds_write_b8 v21, v24 offset:12
  v_mul_f32 v63, v63, v31
  v_cvt_pk_bf16_f32 v44, v56, v57
  v_cvt_pk_bf16_f32 v45, v58, v59
  v_cvt_pk_bf16_f32 v46, v60, v61
  v_cvt_pk_bf16_f32 v47, v62, v63
  buffer_store_dwordx4 v[44:47], v17, s[44:47], s56 offen offset:2048
  v_mfma_f32_32x32x16_bf16 v[64:79], v[88:91], v[188:191], v[64:79]
  v_xor_b32 v13, 64, v13
  ds_read_b64_tr_b16 v[80:81], v13 offset:32768
  ds_read_b64_tr_b16 v[82:83], v13 offset:33280
  s_waitcnt lgkmcnt(6)
  v_mfma_f32_32x32x16_bf16 v[48:63], v[92:95], v[192:195], 0
  ds_read_b64_tr_b16 v[84:85], v10 offset:40960
  ds_read_b64_tr_b16 v[86:87], v10 offset:41472
  v_mfma_f32_16x16x32_bf16 v[120:123], v[112:115], v[92:95], 0
  ds_read_b32 v126, v20 offset:12
  buffer_load_dword v27, v25, s[28:31], s83 offen sc1
  v_mfma_f32_32x32x16_bf16 v[48:63], v[96:99], v[196:199], v[48:63]
  ds_read_b64_tr_b16 v[108:109], v11 offset:40960
  ds_read_b64_tr_b16 v[110:111], v11 offset:41472
  s_waitcnt lgkmcnt(5)
  v_mfma_f32_32x32x16_bf16 v[48:63], v[100:103], v[200:203], v[48:63]
  ds_read_b64_tr_b16 v[88:89], v12 offset:40960
  ds_read_b64_tr_b16 v[90:91], v12 offset:41472
  v_mfma_f32_32x32x16_bf16 v[48:63], v[80:83], v[204:207], v[48:63]
  ds_read_b64_tr_b16 v[92:93], v13 offset:40960
  ds_read_b64_tr_b16 v[94:95], v13 offset:41472
  s_waitcnt lgkmcnt(6)
  v_readfirstlane_b32 s14, v126
  s_nop 0
  s_cmp_eq_u32 s14, 0x01010101
  s_cbranch_scc1 L_bk119
L_in118:
  s_sub_u32 s13, s13, 1
  s_cbranch_scc1 L_sl120
  ds_read_b32 v126, v20 offset:12
  s_waitcnt lgkmcnt(0)
  v_readfirstlane_b32 s14, v126
  s_nop 1
  s_cmp_eq_u32 s14, 0x01010101
  s_cbranch_scc0 L_in118
L_bk119:
  v_and_b32 v124, 0x1f0, v1
  v_add_u32 v124, 0x26600, v124
  ds_read_b128 v[6:9], v124
  s_waitcnt lgkmcnt(5)
  v_mfma_f32_32x32x16_bf16 v[48:63], v[84:87], v[208:211], v[48:63]
  ds_read_b64_tr_b16 v[96:97], v10 offset:49152
  ds_read_b64_tr_b16 v[98:99], v10 offset:49664
  v_mfma_f32_16x16x32_bf16 v[120:123], v[112:115], v[84:87], v[120:123]
  v_mfma_f32_32x32x16_bf16 v[48:63], v[108:111], v[212:215], v[48:63]
  ds_read_b64_tr_b16 v[100:101], v11 offset:49152
  ds_read_b64_tr_b16 v[102:103], v11 offset:49664
  s_waitcnt lgkmcnt(4)
  v_add_f32 v6, v6, v7
  v_add_f32 v8, v8, v9
  v_mov_b32 v9, 0
  v_add_f32 v6, v6, v8
  v_cvt_pk_bf16_f32 v7, v6, 0
  v_lshlrev_b32 v8, 16, v7
  v_sub_f32 v6, v6, v8
  v_cvt_pk_bf16_f32 v6, v8, v6
  v_mfma_f32_32x32x16_bf16 v[48:63], v[88:91], v[216:219], v[48:63]
  ds_read_b64_tr_b16 v[80:81], v12 offset:49152
  ds_read_b64_tr_b16 v[82:83], v12 offset:49664
  v_mfma_f32_32x32x16_bf16 v[64:79], v[6:9], v[2:5], v[64:79]
  s_waitcnt vmcnt(1)
  buffer_store_dword v18, v19, s[28:31], s84 offen offset:16
  v_mfma_f32_32x32x16_bf16 v[48:63], v[92:95], v[220:223], v[48:63]
  ds_read_b64_tr_b16 v[84:85], v13 offset:49152
  ds_read_b64_tr_b16 v[86:87], v13 offset:49664
  s_waitcnt lgkmcnt(4)
  v_mfma_f32_32x32x16_bf16 v[48:63], v[96:99], v[224:227], v[48:63]
  ds_read_b64_tr_b16 v[108:109], v10 offset:57344
  ds_read_b64_tr_b16 v[110:111], v10 offset:57856
  v_mfma_f32_16x16x32_bf16 v[120:123], v[112:115], v[96:99], v[120:123]
  s_waitcnt vmcnt(1)
  v_cmp_eq_u32 vcc, s12, v27
  s_mov_b32 s15, s85
  s_and_b32 s14, vcc_lo, s15
  s_cmp_eq_u32 s14, s15
  s_cbranch_scc1 L_bk122
L_in121:
  s_sub_u32 s13, s13, 1
  s_cbranch_scc1 L_sl123
  buffer_load_dword v27, v25, s[28:31], s83 offen sc1
  s_waitcnt vmcnt(0)
  v_cmp_eq_u32 vcc, s12, v27
  s_nop 1
  s_mov_b32 s15, s85
  s_and_b32 s14, vcc_lo, s15
  s_cmp_eq_u32 s14, s15
  s_cbranch_scc0 L_in121
L_bk122:
  v_mul_f32 v64, v23, v64
  v_mul_f32 v65, v23, v65
  v_mul_f32 v66, v23, v66
  v_mul_f32 v67, v23, v67
  v_exp_f32 v28, v64
  v_mfma_f32_32x32x16_bf16 v[48:63], v[100:103], v[228:231], v[48:63]
  ds_read_b64_tr_b16 v[88:89], v11 offset:57344
  ds_read_b64_tr_b16 v[90:91], v11 offset:57856
  v_exp_f32 v29, v65
  v_exp_f32 v30, v66
  v_exp_f32 v31, v67
  v_add_f32 v28, 1.0, v28
  s_waitcnt lgkmcnt(4)
  v_mfma_f32_32x32x16_bf16 v[48:63], v[80:83], v[232:235], v[48:63]
  ds_read_b64_tr_b16 v[92:93], v12 offset:57344
  ds_read_b64_tr_b16 v[94:95], v12 offset:57856
  buffer_load_dwordx4 v[192:195], v16, s[44:47], s57 offen offset:0 sc1
  v_add_f32 v29, 1.0, v29
  v_add_f32 v30, 1.0, v30
  v_add_f32 v31, 1.0, v31
  v_rcp_f32 v28, v28
  v_mfma_f32_32x32x16_bf16 v[48:63], v[84:87], v[236:239], v[48:63]
  ds_read_b64_tr_b16 v[96:97], v13 offset:57344
  ds_read_b64_tr_b16 v[98:99], v13 offset:57856
  buffer_load_dwordx4 v[196:199], v16, s[44:47], s57 offen offset:2048 sc1
  v_rcp_f32 v29, v29
  v_rcp_f32 v30, v30
  v_rcp_f32 v31, v31
  v_mul_f32 v64, v64, v28
  s_waitcnt lgkmcnt(4)
  v_mfma_f32_32x32x16_bf16 v[48:63], v[108:111], v[240:243], v[48:63]
  ds_read_b64_tr_b16 v[100:101], v10 offset:0
  ds_read_b64_tr_b16 v[102:103], v10 offset:512
  v_mfma_f32_16x16x32_bf16 v[120:123], v[112:115], v[108:111], v[120:123]
  ds_write_b8 v21, v24 offset:28
  buffer_load_dwordx4 v[208:211], v16, s[44:47], s58 offen offset:0 sc1
  buffer_load_dword v27, v25, s[28:31], s83 offen sc1
  v_mul_f32 v65, v65, v29
  v_mul_f32 v66, v66, v30
  v_mul_f32 v67, v67, v31
  v_mul_f32 v68, v23, v68
  v_mfma_f32_32x32x16_bf16 v[48:63], v[88:91], v[244:247], v[48:63]
  ds_read_b64_tr_b16 v[80:81], v11 offset:0
  ds_read_b64_tr_b16 v[82:83], v11 offset:512
  buffer_load_dwordx4 v[212:215], v16, s[44:47], s58 offen offset:2048 sc1
  v_mul_f32 v69, v23, v69
  v_mul_f32 v70, v23, v70
  v_mul_f32 v71, v23, v71
  v_exp_f32 v28, v68
  s_waitcnt lgkmcnt(5)
  v_mfma_f32_32x32x16_bf16 v[48:63], v[92:95], v[248:251], v[48:63]
  ds_read_b64_tr_b16 v[84:85], v12 offset:0
  ds_read_b64_tr_b16 v[86:87], v12 offset:512
  buffer_load_dwordx4 v[224:227], v16, s[44:47], s59 offen offset:0 sc1
  v_exp_f32 v29, v69
  v_exp_f32 v30, v70
  v_exp_f32 v31, v71
  v_add_f32 v28, 1.0, v28
  v_mfma_f32_32x32x16_bf16 v[48:63], v[96:99], v[252:255], v[48:63]
  ds_read_b64_tr_b16 v[108:109], v13 offset:0
  ds_read_b64_tr_b16 v[110:111], v13 offset:512
  buffer_load_dwordx4 v[228:231], v16, s[44:47], s59 offen offset:2048 sc1
  v_add_f32 v29, 1.0, v29
  v_add_f32 v30, 1.0, v30
  v_add_f32 v31, 1.0, v31
  v_rcp_f32 v28, v28
  s_waitcnt lgkmcnt(4)
  v_mfma_f32_32x32x16_bf16 v[48:63], v[100:103], v[128:131], v[48:63]
  ds_read_b64_tr_b16 v[88:89], v10 offset:8192
  ds_read_b64_tr_b16 v[90:91], v10 offset:8704
  v_mfma_f32_16x16x32_bf16 v[120:123], v[112:115], v[100:103], v[120:123]
  v_rcp_f32 v29, v29
  v_rcp_f32 v30, v30
  v_rcp_f32 v31, v31
  v_mul_f32 v68, v68, v28
  v_mfma_f32_32x32x16_bf16 v[48:63], v[80:83], v[132:135], v[48:63]
  ds_read_b64_tr_b16 v[92:93], v11 offset:8192
  ds_read_b64_tr_b16 v[94:95], v11 offset:8704
  s_waitcnt vmcnt(3)
  v_cmp_eq_u32 vcc, s12, v27
  s_lshl_b32 s15, s85, 4
  s_and_b32 s14, vcc_lo, s15
  s_cmp_eq_u32 s14, s15
  s_cbranch_scc1 L_bk125
L_in124:
  s_sub_u32 s13, s13, 1
  s_cbranch_scc1 L_sl126
  buffer_load_dword v27, v25, s[28:31], s83 offen sc1
  s_waitcnt vmcnt(0)
  v_cmp_eq_u32 vcc, s12, v27
  s_nop 1
  s_lshl_b32 s15, s85, 4
  s_and_b32 s14, vcc_lo, s15
  s_cmp_eq_u32 s14, s15
  s_cbranch_scc0 L_in124
L_bk125:
  v_mul_f32 v69, v69, v29
  v_mul_f32 v70, v70, v30
  v_mul_f32 v71, v71, v31
  v_cvt_pk_bf16_f32 v64, v64, v65
  s_waitcnt lgkmcnt(4)
  v_mfma_f32_32x32x16_bf16 v[48:63], v[84:87], v[136:139], v[48:63]
  ds_read_b64_tr_b16 v[96:97], v12 offset:8192
  ds_read_b64_tr_b16 v[98:99], v12 offset:8704
  buffer_load_dwordx4 v[200:203], v17, s[44:47], s57 offen offset:0 sc1
  v_cvt_pk_bf16_f32 v65, v66, v67
  v_cvt_pk_bf16_f32 v66, v68, v69
  v_cvt_pk_bf16_f32 v67, v70, v71
  buffer_store_dwordx4 v[64:67], v1, s[28:31], s81 offen offset:0 sc1
  v_mfma_f32_32x32x16_bf16 v[48:63], v[108:111], v[140:143], v[48:63]
  ds_read_b64_tr_b16 v[100:101], v13 offset:8192
  ds_read_b64_tr_b16 v[102:103], v13 offset:8704
  buffer_load_dwordx4 v[204:207], v17, s[44:47], s57 offen offset:2048 sc1
  v_mul_f32 v72, v23, v72
  v_mul_f32 v73, v23, v73
  v_mul_f32 v74, v23, v74
  v_mul_f32 v75, v23, v75
  v_exp_f32 v28, v72
  s_waitcnt lgkmcnt(4)
  v_mfma_f32_32x32x16_bf16 v[48:63], v[88:91], v[144:147], v[48:63]
  ds_read_b64_tr_b16 v[80:81], v10 offset:16384
  ds_read_b64_tr_b16 v[82:83], v10 offset:16896
  v_mfma_f32_16x16x32_bf16 v[120:123], v[112:115], v[88:91], v[120:123]
  buffer_load_dwordx4 v[216:219], v17, s[44:47], s58 offen offset:0 sc1
  v_exp_f32 v29, v73
  v_exp_f32 v30, v74
  v_exp_f32 v31, v75
  v_add_f32 v28, 1.0, v28
  v_mfma_f32_32x32x16_bf16 v[48:63], v[92:95], v[148:151], v[48:63]
  ds_read_b64_tr_b16 v[84:85], v11 offset:16384
  ds_read_b64_tr_b16 v[86:87], v11 offset:16896
  buffer_load_dwordx4 v[220:223], v17, s[44:47], s58 offen offset:2048 sc1
  v_add_f32 v29, 1.0, v29
  v_add_f32 v30, 1.0, v30
  v_add_f32 v31, 1.0, v31
  v_rcp_f32 v28, v28
  s_waitcnt lgkmcnt(4)
  v_mfma_f32_32x32x16_bf16 v[48:63], v[96:99], v[152:155], v[48:63]
  ds_read_b64_tr_b16 v[108:109], v12 offset:16384
  ds_read_b64_tr_b16 v[110:111], v12 offset:16896
  buffer_load_dwordx4 v[232:235], v17, s[44:47], s59 offen offset:0 sc1
  ds_read_b64 v[124:125], v20 offset:0
  v_rcp_f32 v29, v29
  v_rcp_f32 v30, v30
  v_rcp_f32 v31, v31
  v_mul_f32 v72, v72, v28
  v_mfma_f32_32x32x16_bf16 v[48:63], v[100:103], v[156:159], v[48:63]
  ds_read_b64_tr_b16 v[88:89], v13 offset:16384
  ds_read_b64_tr_b16 v[90:91], v13 offset:16896
  buffer_load_dwordx4 v[236:239], v17, s[44:47], s59 offen offset:2048 sc1
  v_mul_f32 v73, v73, v29
  v_mul_f32 v74, v74, v30
  v_mul_f32 v75, v75, v31
  v_mul_f32 v76, v23, v76
  s_waitcnt lgkmcnt(5)
  v_mfma_f32_32x32x16_bf16 v[48:63], v[80:83], v[160:163], v[48:63]
  ds_read_b64_tr_b16 v[92:93], v10 offset:24576
  ds_read_b64_tr_b16 v[94:95], v10 offset:25088
  v_mfma_f32_16x16x32_bf16 v[120:123], v[112:115], v[80:83], v[120:123]
  v_mul_f32 v77, v23, v77
  v_mul_f32 v78, v23, v78
  v_mul_f32 v79, v23, v79
  v_exp_f32 v28, v76
  v_mfma_f32_32x32x16_bf16 v[48:63], v[84:87], v[164:167], v[48:63]
  ds_read_b64_tr_b16 v[96:97], v11 offset:24576
  ds_read_b64_tr_b16 v[98:99], v11 offset:25088
  s_waitcnt lgkmcnt(6)
  v_readfirstlane_b32 s14, v124
  v_readfirstlane_b32 s15, v125
  s_nop 0
  s_and_b32 s14, s14, s15
  s_cmp_eq_u32 s14, 0x01010101
  s_cbranch_scc1 L_bk128
L_in127:
  s_sub_u32 s13, s13, 1
  s_cbranch_scc1 L_sl129
  ds_read_b64 v[124:125], v20 offset:0
  s_waitcnt lgkmcnt(0)
  v_readfirstlane_b32 s14, v124
  s_nop 1
  v_readfirstlane_b32 s15, v125
  s_nop 1
  s_and_b32 s14, s14, s15
  s_cmp_eq_u32 s14, 0x01010101
  s_cbranch_scc0 L_in127
L_bk128:
  v_exp_f32 v29, v77
  v_exp_f32 v30, v78
  v_exp_f32 v31, v79
  v_add_f32 v28, 1.0, v28
  s_waitcnt lgkmcnt(4)
  v_mfma_f32_32x32x16_bf16 v[48:63], v[108:111], v[168:171], v[48:63]
  ds_read_b64_tr_b16 v[100:101], v12 offset:24576
  ds_read_b64_tr_b16 v[102:103], v12 offset:25088
  ds_read_b64_tr_b16 v[240:241], v116 offset:32768
  ds_read_b64_tr_b16 v[242:243], v116 offset:34816
  v_add_f32 v29, 1.0, v29
  v_add_f32 v30, 1.0, v30
  v_add_f32 v31, 1.0, v31
  v_rcp_f32 v28, v28
  v_mfma_f32_32x32x16_bf16 v[48:63], v[88:91], v[172:175], v[48:63]
  ds_read_b64_tr_b16 v[80:81], v13 offset:24576
  ds_read_b64_tr_b16 v[82:83], v13 offset:25088
  ds_read_b64_tr_b16 v[244:245], v117 offset:32768
  ds_read_b64_tr_b16 v[246:247], v117 offset:34816
  v_rcp_f32 v29, v29
  v_rcp_f32 v30, v30
  v_rcp_f32 v31, v31
  v_mul_f32 v76, v76, v28
  s_waitcnt lgkmcnt(8)
  v_mfma_f32_32x32x16_bf16 v[48:63], v[92:95], v[176:179], v[48:63]
  v_mfma_f32_16x16x32_bf16 v[120:123], v[112:115], v[92:95], v[120:123]
  ds_read_b64_tr_b16 v[248:249], v118 offset:32768
  ds_read_b64_tr_b16 v[250:251], v118 offset:34816
  v_mul_f32 v77, v77, v29
  v_mul_f32 v78, v78, v30
  v_mul_f32 v79, v79, v31
  v_cvt_pk_bf16_f32 v68, v72, v73
  v_mfma_f32_32x32x16_bf16 v[48:63], v[96:99], v[180:183], v[48:63]
  ds_read_b64_tr_b16 v[252:253], v119 offset:32768
  ds_read_b64_tr_b16 v[254:255], v119 offset:34816
  v_cvt_pk_bf16_f32 v69, v74, v75
  v_cvt_pk_bf16_f32 v70, v76, v77
  v_cvt_pk_bf16_f32 v71, v78, v79
  buffer_store_dwordx4 v[68:71], v1, s[28:31], s81 offen offset:1024 sc1
  s_waitcnt lgkmcnt(6)
  v_mfma_f32_32x32x16_bf16 v[48:63], v[100:103], v[184:187], v[48:63]
  ds_read_b64_tr_b16 v[96:97], v116 offset:36864
  ds_read_b64_tr_b16 v[98:99], v116 offset:38912
  s_lshl_b32 s86, s4, 2
  s_add_u32 s86, s86, 0x26400
  v_and_b32 v124, 0x1f0, v1
  v_add_u32 v124, s86, v124
  ds_write_b32 v124, v120
  ds_write_b8 v21, v24 offset:32
  v_mfma_f32_32x32x16_bf16 v[48:63], v[80:83], v[188:191], v[48:63]
  ds_read_b64_tr_b16 v[100:101], v117 offset:36864
  ds_read_b64_tr_b16 v[102:103], v117 offset:38912
  s_waitcnt lgkmcnt(10)
  v_mfma_f32_32x32x16_bf16 v[128:143], v[240:243], v[32:35], 0
  ds_read_b64_tr_b16 v[104:105], v118 offset:36864
  ds_read_b64_tr_b16 v[106:107], v118 offset:38912
  ds_read_b32 v126, v20 offset:32
  v_mfma_f32_32x32x16_bf16 v[144:159], v[244:247], v[32:35], 0
  ds_read_b64_tr_b16 v[108:109], v119 offset:36864
  ds_read_b64_tr_b16 v[110:111], v119 offset:38912
  s_waitcnt lgkmcnt(11)
  v_mfma_f32_32x32x16_bf16 v[160:175], v[248:251], v[32:35], 0
  v_add_u32 v116, 0xfffe8000, v116
  ds_read_b64_tr_b16 v[80:81], v116 offset:0
  ds_read_b64_tr_b16 v[82:83], v116 offset:2048
  v_mfma_f32_32x32x16_bf16 v[176:191], v[252:255], v[32:35], 0
  v_add_u32 v117, 0xfffe8000, v117
  ds_read_b64_tr_b16 v[84:85], v117 offset:0
  ds_read_b64_tr_b16 v[86:87], v117 offset:2048
  s_waitcnt lgkmcnt(6)
  v_readfirstlane_b32 s14, v126
  s_nop 0
  s_cmp_eq_u32 s14, 0x01010101
  s_cbranch_scc1 L_bk140
L_in139:
  s_sub_u32 s13, s13, 1
  s_cbranch_scc1 L_sl141
  ds_read_b32 v126, v20 offset:32
  s_waitcnt lgkmcnt(0)
  v_readfirstlane_b32 s14, v126
  s_nop 1
  s_cmp_eq_u32 s14, 0x01010101
  s_cbranch_scc0 L_in139
L_bk140:
  v_and_b32 v124, 0x1f0, v1
  v_add_u32 v124, 0x26400, v124
  ds_read_b128 v[6:9], v124
  v_mfma_f32_32x32x16_bf16 v[128:143], v[96:99], v[36:39], v[128:143]
  v_add_u32 v118, 0xfffe8000, v118
  ds_read_b64_tr_b16 v[88:89], v118 offset:0
  ds_read_b64_tr_b16 v[90:91], v118 offset:2048
  v_mfma_f32_32x32x16_bf16 v[144:159], v[100:103], v[36:39], v[144:159]
  v_add_u32 v119, 0xfffe8000, v119
  ds_read_b64_tr_b16 v[92:93], v119 offset:0
  ds_read_b64_tr_b16 v[94:95], v119 offset:2048
  s_waitcnt lgkmcnt(4)
  v_add_f32 v6, v6, v7
  v_add_f32 v8, v8, v9
  v_mov_b32 v9, 0
  v_add_f32 v6, v6, v8
  v_cvt_pk_bf16_f32 v7, v6, 0
  v_lshlrev_b32 v8, 16, v7
  v_sub_f32 v6, v6, v8
  v_cvt_pk_bf16_f32 v6, v8, v6
  v_mfma_f32_32x32x16_bf16 v[160:175], v[104:107], v[36:39], v[160:175]
  ds_read_b64_tr_b16 v[240:241], v116 offset:4096
  ds_read_b64_tr_b16 v[242:243], v116 offset:6144
  v_mfma_f32_32x32x16_bf16 v[48:63], v[6:9], v[2:5], v[48:63]
  s_waitcnt vmcnt(1)
  buffer_store_dword v18, v19, s[28:31], s84 offen offset:80
  v_mfma_f32_32x32x16_bf16 v[176:191], v[108:111], v[36:39], v[176:191]
  ds_read_b64_tr_b16 v[244:245], v117 offset:4096
  ds_read_b64_tr_b16 v[246:247], v117 offset:6144
  v_mfma_f32_32x32x16_bf16 v[128:143], v[80:83], v[40:43], v[128:143]
  ds_read_b64_tr_b16 v[248:249], v118 offset:4096
  ds_read_b64_tr_b16 v[250:251], v118 offset:6144
  s_nop 3
  v_mul_f32 v48, v23, v48
  v_mul_f32 v49, v23, v49
  v_mul_f32 v50, v23, v50
  v_mul_f32 v51, v23, v51
  v_exp_f32 v28, v48
  v_exp_f32 v29, v49
  v_exp_f32 v30, v50
  v_mfma_f32_32x32x16_bf16 v[144:159], v[84:87], v[40:43], v[144:159]
  ds_read_b64_tr_b16 v[252:253], v119 offset:4096
  ds_read_b64_tr_b16 v[254:255], v119 offset:6144
  v_exp_f32 v31, v51
  v_add_f32 v28, 1.0, v28
  v_add_f32 v29, 1.0, v29
  v_add_f32 v30, 1.0, v30
  v_add_f32 v31, 1.0, v31
  v_rcp_f32 v28, v28
  s_waitcnt lgkmcnt(8)
  v_mfma_f32_32x32x16_bf16 v[160:175], v[88:91], v[40:43], v[160:175]
  ds_read_b64_tr_b16 v[96:97], v116 offset:8192
  ds_read_b64_tr_b16 v[98:99], v116 offset:10240
  v_rcp_f32 v29, v29
  v_rcp_f32 v30, v30
  v_rcp_f32 v31, v31
  v_mul_f32 v48, v48, v28
  v_mul_f32 v49, v49, v29
  v_mul_f32 v50, v50, v30
  v_mul_f32 v51, v51, v31
  v_mfma_f32_32x32x16_bf16 v[176:191], v[92:95], v[40:43], v[176:191]
  ds_read_b64_tr_b16 v[100:101], v117 offset:8192
  ds_read_b64_tr_b16 v[102:103], v117 offset:10240
  v_mul_f32 v52, v23, v52
  v_mul_f32 v53, v23, v53
  v_mul_f32 v54, v23, v54
  v_mul_f32 v55, v23, v55
  v_exp_f32 v28, v52
  v_exp_f32 v29, v53
  s_waitcnt lgkmcnt(8)
  v_mfma_f32_32x32x16_bf16 v[128:143], v[240:243], v[44:47], v[128:143]
  ds_read_b64_tr_b16 v[104:105], v118 offset:8192
  ds_read_b64_tr_b16 v[106:107], v118 offset:10240
  v_exp_f32 v30, v54
  v_exp_f32 v31, v55
  v_add_f32 v28, 1.0, v28
  v_add_f32 v29, 1.0, v29
  v_add_f32 v30, 1.0, v30
  v_add_f32 v31, 1.0, v31
  v_rcp_f32 v28, v28
  v_mfma_f32_32x32x16_bf16 v[144:159], v[244:247], v[44:47], v[144:159]
  ds_read_b64_tr_b16 v[108:109], v119 offset:8192
  ds_read_b64_tr_b16 v[110:111], v119 offset:10240
  v_rcp_f32 v29, v29
  v_rcp_f32 v30, v30
  v_rcp_f32 v31, v31
  v_mul_f32 v52, v52, v28
  v_mul_f32 v53, v53, v29
  v_mul_f32 v54, v54, v30
  s_waitcnt lgkmcnt(8)
  v_mfma_f32_32x32x16_bf16 v[160:175], v[248:251], v[44:47], v[160:175]
  ds_read_b64_tr_b16 v[80:81], v116 offset:12288
  ds_read_b64_tr_b16 v[82:83], v116 offset:14336
  v_mul_f32 v55, v55, v31
  v_cvt_pk_bf16_f32 v48, v48, v49
  v_cvt_pk_bf16_f32 v49, v50, v51
  v_cvt_pk_bf16_f32 v50, v52, v53
  v_cvt_pk_bf16_f32 v51, v54, v55
  buffer_store_dwordx4 v[48:51], v1, s[64:67], s81 offen offset:2048 sc1
  v_mfma_f32_32x32x16_bf16 v[176:191], v[252:255], v[44:47], v[176:191]
  ds_read_b64_tr_b16 v[84:85], v117 offset:12288
  ds_read_b64_tr_b16 v[86:87], v117 offset:14336
  v_mul_f32 v56, v23, v56
  v_mul_f32 v57, v23, v57
  v_mul_f32 v58, v23, v58
  v_mul_f32 v59, v23, v59
  v_exp_f32 v28, v56
  v_exp_f32 v29, v57
  v_exp_f32 v30, v58
  s_waitcnt lgkmcnt(8)
  v_mfma_f32_32x32x16_bf16 v[128:143], v[96:99], v[64:67], v[128:143]
  ds_read_b64_tr_b16 v[88:89], v118 offset:12288
  ds_read_b64_tr_b16 v[90:91], v118 offset:14336
  s_waitcnt vmcnt(2)
  buffer_store_dword v18, v19, s[28:31], s84 offen offset:32
  v_exp_f32 v31, v59
  v_add_f32 v28, 1.0, v28
  v_add_f32 v29, 1.0, v29
  v_add_f32 v30, 1.0, v30
  v_add_f32 v31, 1.0, v31
  v_rcp_f32 v28, v28
  v_mfma_f32_32x32x16_bf16 v[144:159], v[100:103], v[64:67], v[144:159]
  ds_read_b64_tr_b16 v[92:93], v119 offset:12288
  ds_read_b64_tr_b16 v[94:95], v119 offset:14336
  v_rcp_f32 v29, v29
  v_rcp_f32 v30, v30
  v_rcp_f32 v31, v31
  v_mul_f32 v56, v56, v28
  v_mul_f32 v57, v57, v29
  v_mul_f32 v58, v58, v30
  v_mul_f32 v59, v59, v31
  s_waitcnt lgkmcnt(8)
  v_mfma_f32_32x32x16_bf16 v[160:175], v[104:107], v[64:67], v[160:175]
  ds_read_b64_tr_b16 v[240:241], v116 offset:16384
  ds_read_b64_tr_b16 v[242:243], v116 offset:18432
  v_mul_f32 v60, v23, v60
  v_mul_f32 v61, v23, v61
  v_mul_f32 v62, v23, v62
  v_mul_f32 v63, v23, v63
  v_exp_f32 v28, v60
  v_exp_f32 v29, v61
  v_mfma_f32_32x32x16_bf16 v[176:191], v[108:111], v[64:67], v[176:191]
  ds_read_b64_tr_b16 v[244:245], v117 offset:16384
  ds_read_b64_tr_b16 v[246:247], v117 offset:18432
  v_exp_f32 v30, v62
  v_exp_f32 v31, v63
  v_add_f32 v28, 1.0, v28
  v_add_f32 v29, 1.0, v29
  v_add_f32 v30, 1.0, v30
  v_add_f32 v31, 1.0, v31
  v_rcp_f32 v28, v28
  s_waitcnt lgkmcnt(8)
  v_mfma_f32_32x32x16_bf16 v[128:143], v[80:83], v[68:71], v[128:143]
  ds_read_b64_tr_b16 v[248:249], v118 offset:16384
  ds_read_b64_tr_b16 v[250:251], v118 offset:18432
  v_rcp_f32 v29, v29
  v_rcp_f32 v30, v30
  v_rcp_f32 v31, v31
  v_mul_f32 v60, v60, v28
  v_mul_f32 v61, v61, v29
  v_mul_f32 v62, v62, v30
  v_mfma_f32_32x32x16_bf16 v[144:159], v[84:87], v[68:71], v[144:159]
  ds_read_b64_tr_b16 v[252:253], v119 offset:16384
  ds_read_b64_tr_b16 v[254:255], v119 offset:18432
  v_mul_f32 v63, v63, v31
  v_cvt_pk_bf16_f32 v52, v56, v57
  v_cvt_pk_bf16_f32 v53, v58, v59
  v_cvt_pk_bf16_f32 v54, v60, v61
  v_cvt_pk_bf16_f32 v55, v62, v63
  buffer_store_dwordx4 v[52:55], v1, s[64:67], s81 offen offset:3072 sc1
  s_waitcnt lgkmcnt(8)
  v_mfma_f32_32x32x16_bf16 v[160:175], v[88:91], v[68:71], v[160:175]
  ds_read_b64_tr_b16 v[96:97], v116 offset:20480
  ds_read_b64_tr_b16 v[98:99], v116 offset:22528
  ds_read_b32 v126, v20 offset:24
  v_mfma_f32_32x32x16_bf16 v[176:191], v[92:95], v[68:71], v[176:191]
  ds_read_b64_tr_b16 v[100:101], v117 offset:20480
  ds_read_b64_tr_b16 v[102:103], v117 offset:22528
  s_waitcnt lgkmcnt(9)
  v_mfma_f32_32x32x16_bf16 v[128:143], v[240:243], v[192:195], v[128:143]
  ds_read_b64_tr_b16 v[104:105], v118 offset:20480
  ds_read_b64_tr_b16 v[106:107], v118 offset:22528
  v_mfma_f32_32x32x16_bf16 v[144:159], v[244:247], v[192:195], v[144:159]
  ds_read_b64_tr_b16 v[108:109], v119 offset:20480
  ds_read_b64_tr_b16 v[110:111], v119 offset:22528
  s_waitcnt lgkmcnt(9)
  v_mfma_f32_32x32x16_bf16 v[160:175], v[248:251], v[192:195], v[160:175]
  s_waitcnt lgkmcnt(6)
  v_readfirstlane_b32 s14, v126
  s_nop 0
  s_cmp_eq_u32 s14, 0x01010101
  s_cbranch_scc1 L_bk131
L_in130:
  s_sub_u32 s13, s13, 1
  s_cbranch_scc1 L_sl132
  ds_read_b32 v126, v20 offset:24
  s_waitcnt lgkmcnt(0)
  v_readfirstlane_b32 s14, v126
  s_nop 1
  s_cmp_eq_u32 s14, 0x01010101
  s_cbranch_scc0 L_in130
L_bk131:
  ds_read_b64_tr_b16 v[80:81], v116 offset:24576
  ds_read_b64_tr_b16 v[82:83], v116 offset:26624
  v_mfma_f32_32x32x16_bf16 v[176:191], v[252:255], v[192:195], v[176:191]
  ds_read_b64_tr_b16 v[84:85], v117 offset:24576
  ds_read_b64_tr_b16 v[86:87], v117 offset:26624
  s_waitcnt lgkmcnt(8)
  v_mfma_f32_32x32x16_bf16 v[128:143], v[96:99], v[196:199], v[128:143]
  ds_read_b64_tr_b16 v[88:89], v118 offset:24576
  ds_read_b64_tr_b16 v[90:91], v118 offset:26624
  v_mfma_f32_32x32x16_bf16 v[144:159], v[100:103], v[196:199], v[144:159]
  ds_read_b64_tr_b16 v[92:93], v119 offset:24576
  ds_read_b64_tr_b16 v[94:95], v119 offset:26624
  s_waitcnt lgkmcnt(8)
  v_mfma_f32_32x32x16_bf16 v[160:175], v[104:107], v[196:199], v[160:175]
  ds_read_b64_tr_b16 v[240:241], v116 offset:28672
  ds_read_b64_tr_b16 v[242:243], v116 offset:30720
  v_mfma_f32_32x32x16_bf16 v[176:191], v[108:111], v[196:199], v[176:191]
  ds_read_b64_tr_b16 v[244:245], v117 offset:28672
  ds_read_b64_tr_b16 v[246:247], v117 offset:30720
  s_waitcnt lgkmcnt(8)
  v_mfma_f32_32x32x16_bf16 v[128:143], v[80:83], v[208:211], v[128:143]
  ds_read_b64_tr_b16 v[248:249], v118 offset:28672
  ds_read_b64_tr_b16 v[250:251], v118 offset:30720
  v_mfma_f32_32x32x16_bf16 v[144:159], v[84:87], v[208:211], v[144:159]
  ds_read_b64_tr_b16 v[252:253], v119 offset:28672
  ds_read_b64_tr_b16 v[254:255], v119 offset:30720
  s_waitcnt lgkmcnt(8)
  v_mfma_f32_32x32x16_bf16 v[160:175], v[88:91], v[208:211], v[160:175]
  ds_read_b64_tr_b16 v[96:97], v116 offset:32768
  ds_read_b64_tr_b16 v[98:99], v116 offset:34816
  ds_write_b8 v21, v24 offset:36
  v_mfma_f32_32x32x16_bf16 v[176:191], v[92:95], v[208:211], v[176:191]
  ds_read_b64_tr_b16 v[100:101], v117 offset:32768
  ds_read_b64_tr_b16 v[102:103], v117 offset:34816
  s_waitcnt lgkmcnt(9)
  v_mfma_f32_32x32x16_bf16 v[128:143], v[240:243], v[212:215], v[128:143]
  ds_read_b64_tr_b16 v[104:105], v118 offset:32768
  ds_read_b64_tr_b16 v[106:107], v118 offset:34816
  buffer_load_dword v27, v25, s[28:31], s83 offen sc1
  v_mfma_f32_32x32x16_bf16 v[144:159], v[244:247], v[212:215], v[144:159]
  ds_read_b64_tr_b16 v[108:109], v119 offset:32768
  ds_read_b64_tr_b16 v[110:111], v119 offset:34816
  s_waitcnt lgkmcnt(9)
  v_mfma_f32_32x32x16_bf16 v[160:175], v[248:251], v[212:215], v[160:175]
  ds_read_b64_tr_b16 v[80:81], v116 offset:36864
  ds_read_b64_tr_b16 v[82:83], v116 offset:38912
  v_mfma_f32_32x32x16_bf16 v[176:191], v[252:255], v[212:215], v[176:191]
  ds_read_b64_tr_b16 v[84:85], v117 offset:36864
  ds_read_b64_tr_b16 v[86:87], v117 offset:38912
  s_waitcnt lgkmcnt(8)
  v_mfma_f32_32x32x16_bf16 v[128:143], v[96:99], v[224:227], v[128:143]
  ds_read_b64_tr_b16 v[88:89], v118 offset:36864
  ds_read_b64_tr_b16 v[90:91], v118 offset:38912
  v_mfma_f32_32x32x16_bf16 v[144:159], v[100:103], v[224:227], v[144:159]
  ds_read_b64_tr_b16 v[92:93], v119 offset:36864
  ds_read_b64_tr_b16 v[94:95], v119 offset:38912
  s_waitcnt lgkmcnt(8)
  v_mfma_f32_32x32x16_bf16 v[160:175], v[104:107], v[224:227], v[160:175]
  ds_read_b64_tr_b16 v[240:241], v116 offset:40960
  ds_read_b64_tr_b16 v[242:243], v116 offset:43008
  v_mfma_f32_32x32x16_bf16 v[176:191], v[108:111], v[224:227], v[176:191]
  ds_read_b64_tr_b16 v[244:245], v117 offset:40960
  ds_read_b64_tr_b16 v[246:247], v117 offset:43008
  s_waitcnt lgkmcnt(8)
  v_mfma_f32_32x32x16_bf16 v[128:143], v[80:83], v[228:231], v[128:143]
  ds_read_b64_tr_b16 v[248:249], v118 offset:40960
  ds_read_b64_tr_b16 v[250:251], v118 offset:43008
  s_waitcnt vmcnt(1)
  buffer_store_dword v18, v19, s[64:67], s84 offen offset:48
  s_waitcnt vmcnt(1)
  v_cmp_eq_u32 vcc, s12, v27
  s_lshl_b32 s15, s85, 8
  s_and_b32 s14, vcc_lo, s15
  s_cmp_eq_u32 s14, s15
  s_cbranch_scc1 L_bk143
L_in142:
  s_sub_u32 s13, s13, 1
  s_cbranch_scc1 L_sl144
  buffer_load_dword v27, v25, s[28:31], s83 offen sc1
  s_waitcnt vmcnt(0)
  v_cmp_eq_u32 vcc, s12, v27
  s_nop 1
  s_lshl_b32 s15, s85, 8
  s_and_b32 s14, vcc_lo, s15
  s_cmp_eq_u32 s14, s15
  s_cbranch_scc0 L_in142
L_bk143:
  v_mfma_f32_32x32x16_bf16 v[144:159], v[84:87], v[228:231], v[144:159]
  ds_read_b64_tr_b16 v[252:253], v119 offset:40960
  ds_read_b64_tr_b16 v[254:255], v119 offset:43008
  buffer_load_dwordx4 v[32:35], v26, s[28:31], s88 offen offset:0 sc1
  s_waitcnt lgkmcnt(8)
  v_mfma_f32_32x32x16_bf16 v[160:175], v[88:91], v[228:231], v[160:175]
  ds_read_b64_tr_b16 v[96:97], v116 offset:45056
  ds_read_b64_tr_b16 v[98:99], v116 offset:47104
  v_mfma_f32_32x32x16_bf16 v[176:191], v[92:95], v[228:231], v[176:191]
  ds_read_b64_tr_b16 v[100:101], v117 offset:45056
  ds_read_b64_tr_b16 v[102:103], v117 offset:47104
  buffer_load_dwordx4 v[36:39], v26, s[28:31], s88 offen offset:1024 sc1
  s_waitcnt lgkmcnt(8)
  v_mfma_f32_32x32x16_bf16 v[128:143], v[240:243], v[200:203], v[128:143]
  ds_read_b64_tr_b16 v[104:105], v118 offset:45056
  ds_read_b64_tr_b16 v[106:107], v118 offset:47104
  v_mfma_f32_32x32x16_bf16 v[144:159], v[244:247], v[200:203], v[144:159]
  ds_read_b64_tr_b16 v[108:109], v119 offset:45056
  ds_read_b64_tr_b16 v[110:111], v119 offset:47104
  buffer_load_dwordx4 v[40:43], v26, s[28:31], s89 offen offset:0 sc1
  s_waitcnt lgkmcnt(8)
  v_mfma_f32_32x32x16_bf16 v[160:175], v[248:251], v[200:203], v[160:175]
  ds_read_b64_tr_b16 v[80:81], v116 offset:49152
  ds_read_b64_tr_b16 v[82:83], v116 offset:51200
  v_mfma_f32_32x32x16_bf16 v[176:191], v[252:255], v[200:203], v[176:191]
  ds_read_b64_tr_b16 v[84:85], v117 offset:49152
  ds_read_b64_tr_b16 v[86:87], v117 offset:51200
  buffer_load_dwordx4 v[44:47], v26, s[28:31], s89 offen offset:1024 sc1
  s_waitcnt lgkmcnt(8)
  v_mfma_f32_32x32x16_bf16 v[128:143], v[96:99], v[204:207], v[128:143]
  ds_read_b64_tr_b16 v[88:89], v118 offset:49152
  ds_read_b64_tr_b16 v[90:91], v118 offset:51200
  v_mfma_f32_32x32x16_bf16 v[144:159], v[100:103], v[204:207], v[144:159]
  ds_read_b64_tr_b16 v[92:93], v119 offset:49152
  ds_read_b64_tr_b16 v[94:95], v119 offset:51200
  buffer_load_dwordx4 v[72:75], v26, s[28:31], s90 offen offset:0 sc1
  s_waitcnt lgkmcnt(8)
  v_mfma_f32_32x32x16_bf16 v[160:175], v[104:107], v[204:207], v[160:175]
  ds_read_b64_tr_b16 v[240:241], v116 offset:53248
  ds_read_b64_tr_b16 v[242:243], v116 offset:55296
  v_mfma_f32_32x32x16_bf16 v[176:191], v[108:111], v[204:207], v[176:191]
  ds_read_b64_tr_b16 v[244:245], v117 offset:53248
  ds_read_b64_tr_b16 v[246:247], v117 offset:55296
  buffer_load_dwordx4 v[76:79], v26, s[28:31], s90 offen offset:1024 sc1
  s_waitcnt lgkmcnt(8)
  v_mfma_f32_32x32x16_bf16 v[128:143], v[80:83], v[216:219], v[128:143]
  ds_read_b64_tr_b16 v[248:249], v118 offset:53248
  ds_read_b64_tr_b16 v[250:251], v118 offset:55296
  v_mfma_f32_32x32x16_bf16 v[144:159], v[84:87], v[216:219], v[144:159]
  ds_read_b64_tr_b16 v[252:253], v119 offset:53248
  ds_read_b64_tr_b16 v[254:255], v119 offset:55296
  s_waitcnt lgkmcnt(8)
  v_mfma_f32_32x32x16_bf16 v[160:175], v[88:91], v[216:219], v[160:175]
  ds_read_b64_tr_b16 v[96:97], v116 offset:57344
  ds_read_b64_tr_b16 v[98:99], v116 offset:59392
  v_mfma_f32_32x32x16_bf16 v[176:191], v[92:95], v[216:219], v[176:191]
  ds_read_b64_tr_b16 v[100:101], v117 offset:57344
  ds_read_b64_tr_b16 v[102:103], v117 offset:59392
  s_waitcnt lgkmcnt(8)
  v_mfma_f32_32x32x16_bf16 v[128:143], v[240:243], v[220:223], v[128:143]
  ds_read_b64_tr_b16 v[104:105], v118 offset:57344
  ds_read_b64_tr_b16 v[106:107], v118 offset:59392
  v_mfma_f32_32x32x16_bf16 v[144:159], v[244:247], v[220:223], v[144:159]
  ds_read_b64_tr_b16 v[108:109], v119 offset:57344
  ds_read_b64_tr_b16 v[110:111], v119 offset:59392
  s_waitcnt lgkmcnt(8)
  v_mfma_f32_32x32x16_bf16 v[160:175], v[248:251], v[220:223], v[160:175]
  ds_read_b64_tr_b16 v[80:81], v116 offset:61440
  ds_read_b64_tr_b16 v[82:83], v116 offset:63488
  ds_read_b32 v126, v20 offset:44
  v_mfma_f32_32x32x16_bf16 v[176:191], v[252:255], v[220:223], v[176:191]
  ds_read_b64_tr_b16 v[84:85], v117 offset:61440
  ds_read_b64_tr_b16 v[86:87], v117 offset:63488
  s_waitcnt lgkmcnt(9)
  v_mfma_f32_32x32x16_bf16 v[128:143], v[96:99], v[232:235], v[128:143]
  ds_read_b64_tr_b16 v[88:89], v118 offset:61440
  ds_read_b64_tr_b16 v[90:91], v118 offset:63488
  v_mfma_f32_32x32x16_bf16 v[144:159], v[100:103], v[232:235], v[144:159]
  ds_read_b64_tr_b16 v[92:93], v119 offset:61440
  ds_read_b64_tr_b16 v[94:95], v119 offset:63488
  s_waitcnt lgkmcnt(9)
  v_mfma_f32_32x32x16_bf16 v[160:175], v[104:107], v[232:235], v[160:175]
  s_waitcnt lgkmcnt(6)
  v_readfirstlane_b32 s14, v126
  s_nop 0
  s_cmp_eq_u32 s14, 0x01010101
  s_cbranch_scc1 L_bk134
L_in133:
  s_sub_u32 s13, s13, 1
  s_cbranch_scc1 L_sl135
  ds_read_b32 v126, v20 offset:44
  s_waitcnt lgkmcnt(0)
  v_readfirstlane_b32 s14, v126
  s_nop 1
  s_cmp_eq_u32 s14, 0x01010101
  s_cbranch_scc0 L_in133
L_bk134:
  v_add_u32 v116, 0x18000, v116
  ds_read_b64_tr_b16 v[240:241], v116 offset:0
  ds_read_b64_tr_b16 v[242:243], v116 offset:2048
  ds_write_b8 v21, v24 offset:40
  v_mfma_f32_32x32x16_bf16 v[176:191], v[108:111], v[232:235], v[176:191]
  v_add_u32 v117, 0x18000, v117
  ds_read_b64_tr_b16 v[244:245], v117 offset:0
  ds_read_b64_tr_b16 v[246:247], v117 offset:2048
  s_waitcnt lgkmcnt(9)
  v_mfma_f32_32x32x16_bf16 v[128:143], v[80:83], v[236:239], v[128:143]
  v_add_u32 v118, 0x18000, v118
  ds_read_b64_tr_b16 v[248:249], v118 offset:0
  ds_read_b64_tr_b16 v[250:251], v118 offset:2048
  v_mfma_f32_32x32x16_bf16 v[144:159], v[84:87], v[236:239], v[144:159]
  v_add_u32 v119, 0x18000, v119
  ds_read_b64_tr_b16 v[252:253], v119 offset:0
  ds_read_b64_tr_b16 v[254:255], v119 offset:2048
  s_waitcnt lgkmcnt(9)
  v_mfma_f32_32x32x16_bf16 v[160:175], v[88:91], v[236:239], v[160:175]
  ds_read_b64_tr_b16 v[96:97], v116 offset:4096
  ds_read_b64_tr_b16 v[98:99], v116 offset:6144
  buffer_load_dword v27, v25, s[28:31], s83 offen sc1
  v_mfma_f32_32x32x16_bf16 v[176:191], v[92:95], v[236:239], v[176:191]
  ds_read_b64_tr_b16 v[100:101], v117 offset:4096
  ds_read_b64_tr_b16 v[102:103], v117 offset:6144
  s_waitcnt lgkmcnt(8)
  s_waitcnt vmcnt(6)
  v_mfma_f32_32x32x16_bf16 v[128:143], v[240:243], v[32:35], v[128:143]
  ds_read_b64_tr_b16 v[104:105], v118 offset:4096
  ds_read_b64_tr_b16 v[106:107], v118 offset:6144
  ds_read_b32 v29, v20 offset:40
  s_lshl_b32 s86, s4, 12
  v_add_u32 v124, s86, v1
  v_add_u32 v125, 0x22000, v124
  v_mfma_f32_32x32x16_bf16 v[144:159], v[244:247], v[32:35], v[144:159]
  ds_read_b64_tr_b16 v[108:109], v119 offset:4096
  ds_read_b64_tr_b16 v[110:111], v119 offset:6144
  s_waitcnt lgkmcnt(9)
  v_mfma_f32_32x32x16_bf16 v[160:175], v[248:251], v[32:35], v[160:175]
  ds_read_b64_tr_b16 v[80:81], v116 offset:8192
  ds_read_b64_tr_b16 v[82:83], v116 offset:10240
  v_mfma_f32_32x32x16_bf16 v[176:191], v[252:255], v[32:35], v[176:191]
  ds_read_b64_tr_b16 v[84:85], v117 offset:8192
  ds_read_b64_tr_b16 v[86:87], v117 offset:10240
  s_waitcnt lgkmcnt(6)
  v_readfirstlane_b32 s14, v29
  s_nop 0
  s_cmp_eq_u32 s14, 0x01010101
  s_cbranch_scc1 L_bk149
L_in148:
  s_sub_u32 s13, s13, 1
  s_cbranch_scc1 L_sl150
  ds_read_b32 v29, v20 offset:40
  s_waitcnt lgkmcnt(0)
  v_readfirstlane_b32 s14, v29
  s_nop 1
  s_cmp_eq_u32 s14, 0x01010101
  s_cbranch_scc0 L_in148
L_bk149:
  s_waitcnt vmcnt(5)
  v_mfma_f32_32x32x16_bf16 v[128:143], v[96:99], v[36:39], v[128:143]
  ds_read_b64_tr_b16 v[88:89], v118 offset:8192
  ds_read_b64_tr_b16 v[90:91], v118 offset:10240
  v_mfma_f32_32x32x16_bf16 v[144:159], v[100:103], v[36:39], v[144:159]
  ds_read_b64_tr_b16 v[92:93], v119 offset:8192
  ds_read_b64_tr_b16 v[94:95], v119 offset:10240
  s_waitcnt lgkmcnt(8)
  v_mfma_f32_32x32x16_bf16 v[160:175], v[104:107], v[36:39], v[160:175]
  ds_read_b64_tr_b16 v[240:241], v116 offset:12288
  ds_read_b64_tr_b16 v[242:243], v116 offset:14336
  v_mfma_f32_32x32x16_bf16 v[176:191], v[108:111], v[36:39], v[176:191]
  ds_read_b64_tr_b16 v[244:245], v117 offset:12288
  ds_read_b64_tr_b16 v[246:247], v117 offset:14336
  s_waitcnt lgkmcnt(8)
  s_waitcnt vmcnt(4)
  v_mfma_f32_32x32x16_bf16 v[128:143], v[80:83], v[40:43], v[128:143]
  ds_read_b64_tr_b16 v[248:249], v118 offset:12288
  ds_read_b64_tr_b16 v[250:251], v118 offset:14336
  s_waitcnt vmcnt(0)
  v_cmp_eq_u32 vcc, s12, v27
  s_mov_b32 s15, 0x3000
  s_and_b32 s14, vcc_lo, s15
  s_cmp_eq_u32 s14, s15
  s_cbranch_scc1 L_bk146
L_in145:
  s_sub_u32 s13, s13, 1
  s_cbranch_scc1 L_sl147
  buffer_load_dword v27, v25, s[28:31], s83 offen sc1
  s_waitcnt vmcnt(0)
  v_cmp_eq_u32 vcc, s12, v27
  s_nop 1
  s_mov_b32 s15, 0x3000
  s_and_b32 s14, vcc_lo, s15
  s_cmp_eq_u32 s14, s15
  s_cbranch_scc0 L_in145
L_bk146:
  v_mfma_f32_32x32x16_bf16 v[144:159], v[84:87], v[40:43], v[144:159]
  ds_read_b64_tr_b16 v[252:253], v119 offset:12288
  ds_read_b64_tr_b16 v[254:255], v119 offset:14336
  buffer_load_dwordx4 v[48:51], v26, s[28:31], s79 offen offset:2048 sc1
  s_waitcnt lgkmcnt(8)
  v_mfma_f32_32x32x16_bf16 v[160:175], v[88:91], v[40:43], v[160:175]
  ds_read_b64_tr_b16 v[96:97], v116 offset:16384
  ds_read_b64_tr_b16 v[98:99], v116 offset:18432
  v_mfma_f32_32x32x16_bf16 v[176:191], v[92:95], v[40:43], v[176:191]
  ds_read_b64_tr_b16 v[100:101], v117 offset:16384
  ds_read_b64_tr_b16 v[102:103], v117 offset:18432
  buffer_load_dwordx4 v[52:55], v26, s[28:31], s79 offen offset:3072 sc1
  s_waitcnt lgkmcnt(8)
  v_mfma_f32_32x32x16_bf16 v[128:143], v[240:243], v[44:47], v[128:143]
  ds_read_b64_tr_b16 v[104:105], v118 offset:16384
  ds_read_b64_tr_b16 v[106:107], v118 offset:18432
  v_mfma_f32_32x32x16_bf16 v[144:159], v[244:247], v[44:47], v[144:159]
  ds_read_b64_tr_b16 v[108:109], v119 offset:16384
  ds_read_b64_tr_b16 v[110:111], v119 offset:18432
  buffer_load_dwordx4 v[56:59], v26, s[28:31], s91 offen offset:2048 sc1
  s_waitcnt lgkmcnt(8)
  v_mfma_f32_32x32x16_bf16 v[160:175], v[248:251], v[44:47], v[160:175]
  ds_read_b64_tr_b16 v[80:81], v116 offset:20480
  ds_read_b64_tr_b16 v[82:83], v116 offset:22528
  v_mfma_f32_32x32x16_bf16 v[176:191], v[252:255], v[44:47], v[176:191]
  ds_read_b64_tr_b16 v[84:85], v117 offset:20480
  ds_read_b64_tr_b16 v[86:87], v117 offset:22528
  buffer_load_dwordx4 v[60:63], v26, s[28:31], s91 offen offset:3072 sc1
  s_waitcnt lgkmcnt(8)
  v_mfma_f32_32x32x16_bf16 v[128:143], v[96:99], v[72:75], v[128:143]
  ds_read_b64_tr_b16 v[88:89], v118 offset:20480
  ds_read_b64_tr_b16 v[90:91], v118 offset:22528
  ds_read_b32 v126, v20 offset:48
  v_mfma_f32_32x32x16_bf16 v[144:159], v[100:103], v[72:75], v[144:159]
  ds_read_b64_tr_b16 v[92:93], v119 offset:20480
  ds_read_b64_tr_b16 v[94:95], v119 offset:22528
  s_waitcnt lgkmcnt(9)
  v_mfma_f32_32x32x16_bf16 v[160:175], v[104:107], v[72:75], v[160:175]
  ds_read_b64_tr_b16 v[240:241], v116 offset:24576
  ds_read_b64_tr_b16 v[242:243], v116 offset:26624
  v_mfma_f32_32x32x16_bf16 v[176:191], v[108:111], v[72:75], v[176:191]
  ds_read_b64_tr_b16 v[244:245], v116 offset:28672
  ds_read_b64_tr_b16 v[246:247], v116 offset:30720
  s_waitcnt lgkmcnt(9)
  v_mfma_f32_32x32x16_bf16 v[128:143], v[80:83], v[76:79], v[128:143]
  s_waitcnt lgkmcnt(6)
  v_readfirstlane_b32 s14, v126
  s_nop 0
  s_cmp_eq_u32 s14, 0x01010101
  s_cbranch_scc1 L_bk137
L_in136:
  s_sub_u32 s13, s13, 1
  s_cbranch_scc1 L_sl138
  ds_read_b32 v126, v20 offset:48
  s_waitcnt lgkmcnt(0)
  v_readfirstlane_b32 s14, v126
  s_nop 1
  s_cmp_eq_u32 s14, 0x01010101
  s_cbranch_scc0 L_in136
L_bk137:
  ds_read_b64_tr_b16 v[248:249], v116 offset:32768
  ds_read_b64_tr_b16 v[250:251], v116 offset:34816
  v_mfma_f32_32x32x16_bf16 v[144:159], v[84:87], v[76:79], v[144:159]
  ds_read_b64_tr_b16 v[252:253], v116 offset:36864
  ds_read_b64_tr_b16 v[254:255], v116 offset:38912
  s_waitcnt lgkmcnt(8)
  v_mfma_f32_32x32x16_bf16 v[160:175], v[88:91], v[76:79], v[160:175]
  ds_read_b64_tr_b16 v[96:97], v117 offset:24576
  ds_read_b64_tr_b16 v[98:99], v117 offset:26624
  v_mfma_f32_32x32x16_bf16 v[176:191], v[92:95], v[76:79], v[176:191]
  ds_read_b64_tr_b16 v[100:101], v117 offset:28672
  ds_read_b64_tr_b16 v[102:103], v117 offset:30720
  s_waitcnt lgkmcnt(8)
  s_waitcnt vmcnt(3)
  v_mfma_f32_32x32x16_bf16 v[128:143], v[240:243], v[48:51], v[128:143]
  ds_read_b64_tr_b16 v[104:105], v117 offset:32768
  ds_read_b64_tr_b16 v[106:107], v117 offset:34816
  s_waitcnt vmcnt(2)
  v_mfma_f32_32x32x16_bf16 v[128:143], v[244:247], v[52:55], v[128:143]
  ds_read_b64_tr_b16 v[108:109], v117 offset:36864
  ds_read_b64_tr_b16 v[110:111], v117 offset:38912
  s_waitcnt lgkmcnt(8)
  s_waitcnt vmcnt(1)
  v_mfma_f32_32x32x16_bf16 v[128:143], v[248:251], v[56:59], v[128:143]
  ds_read_b64_tr_b16 v[80:81], v118 offset:24576
  ds_read_b64_tr_b16 v[82:83], v118 offset:26624
  s_waitcnt vmcnt(0)
  v_mfma_f32_32x32x16_bf16 v[128:143], v[252:255], v[60:63], v[128:143]
  ds_read_b64_tr_b16 v[84:85], v118 offset:28672
  ds_read_b64_tr_b16 v[86:87], v118 offset:30720
  s_waitcnt lgkmcnt(8)
  v_mfma_f32_32x32x16_bf16 v[144:159], v[96:99], v[48:51], v[144:159]
  ds_read_b64_tr_b16 v[88:89], v118 offset:32768
  ds_read_b64_tr_b16 v[90:91], v118 offset:34816
  v_mfma_f32_32x32x16_bf16 v[144:159], v[100:103], v[52:55], v[144:159]
  ds_read_b64_tr_b16 v[92:93], v118 offset:36864
  ds_read_b64_tr_b16 v[94:95], v118 offset:38912
  s_nop 2
  ds_write_b128 v124, v[128:131] offset:32768
  ds_write_b128 v124, v[132:135] offset:33792
  ds_write_b128 v124, v[136:139] offset:34816
  ds_write_b128 v124, v[140:143] offset:35840
  ds_write_b8 v21, v24 offset:68
  s_waitcnt lgkmcnt(13)
  v_mfma_f32_32x32x16_bf16 v[144:159], v[104:107], v[56:59], v[144:159]
  ds_read_b64_tr_b16 v[240:241], v119 offset:24576
  ds_read_b64_tr_b16 v[242:243], v119 offset:26624
  v_mfma_f32_32x32x16_bf16 v[144:159], v[108:111], v[60:63], v[144:159]
  ds_read_b64_tr_b16 v[244:245], v119 offset:28672
  ds_read_b64_tr_b16 v[246:247], v119 offset:30720
  s_waitcnt lgkmcnt(13)
  v_mfma_f32_32x32x16_bf16 v[160:175], v[80:83], v[48:51], v[160:175]
  ds_read_b64_tr_b16 v[248:249], v119 offset:32768
  ds_read_b64_tr_b16 v[250:251], v119 offset:34816
  v_mfma_f32_32x32x16_bf16 v[160:175], v[84:87], v[52:55], v[160:175]
  ds_read_b64_tr_b16 v[252:253], v119 offset:36864
  ds_read_b64_tr_b16 v[254:255], v119 offset:38912
  s_nop 2
  ds_write_b128 v124, v[144:147] offset:49152
  ds_write_b128 v124, v[148:151] offset:50176
  ds_write_b128 v124, v[152:155] offset:51200
  ds_write_b128 v124, v[156:159] offset:52224
  ds_write_b8 v21, v24 offset:72
  ds_read_b32 v28, v20 offset:60
  s_waitcnt lgkmcnt(15)
  v_mfma_f32_32x32x16_bf16 v[160:175], v[88:91], v[56:59], v[160:175]
  v_mfma_f32_32x32x16_bf16 v[160:175], v[92:95], v[60:63], v[160:175]
  s_waitcnt lgkmcnt(10)
  v_mfma_f32_32x32x16_bf16 v[176:191], v[240:243], v[48:51], v[176:191]
  v_mfma_f32_32x32x16_bf16 v[176:191], v[244:247], v[52:55], v[176:191]
  s_waitcnt lgkmcnt(0)
  v_readfirstlane_b32 s14, v28
  s_nop 0
  s_bitcmp1_b32 s14, s101
  s_cbranch_scc1 L_bk152
L_in151:
  s_sub_u32 s13, s13, 1
  s_cbranch_scc1 L_sl153
  ds_read_b32 v28, v20 offset:60
  s_waitcnt lgkmcnt(0)
  v_readfirstlane_b32 s14, v28
  s_nop 1
  s_bitcmp1_b32 s14, s101
  s_cbranch_scc0 L_in151
L_bk152:
  s_nop 3
  ds_write_b128 v125, v[160:163] offset:0
  ds_write_b128 v125, v[164:167] offset:1024
  ds_write_b128 v125, v[168:171] offset:2048
  ds_write_b128 v125, v[172:175] offset:3072
  ds_write_b8 v21, v24 offset:76
  ds_read_b32 v28, v20 offset:64
  v_mfma_f32_32x32x16_bf16 v[176:191], v[248:251], v[56:59], v[176:191]
  v_mfma_f32_32x32x16_bf16 v[176:191], v[252:255], v[60:63], v[176:191]
  s_waitcnt lgkmcnt(0)
  v_readfirstlane_b32 s14, v28
  s_nop 0
  s_bitcmp1_b32 s14, s101
  s_cbranch_scc1 L_bk155
L_in154:
  s_sub_u32 s13, s13, 1
  s_cbranch_scc1 L_sl156
  ds_read_b32 v28, v20 offset:64
  s_waitcnt lgkmcnt(0)
  v_readfirstlane_b32 s14, v28
  s_nop 1
  s_bitcmp1_b32 s14, s101
  s_cbranch_scc0 L_in154
L_bk155:
  s_nop 6
  ds_write_b128 v124, v[176:179] offset:32768
  ds_write_b128 v124, v[180:183] offset:33792
  ds_write_b128 v124, v[184:187] offset:34816
  ds_write_b128 v124, v[188:191] offset:35840
  ds_write_b8 v21, v24 offset:80
  s_endpgm
L_Y:
  v_and_b32 v252, 31, v0
  s_lshl_b32 s14, s10, 5
  v_add_lshl_u32 v252, s14, v252, 1
  buffer_load_ushort v117, v252, s[48:51], 0 offen
  buffer_load_ushort v118, v252, s[52:55], 0 offen
  buffer_load_ushort v119, v252, s[56:59], 0 offen
  v_and_b32 v252, 31, v0
  v_bfe_u32 v253, v0, 1, 3
  v_lshrrev_b32 v14, 5, v0
  v_xor_b32 v253, v253, v14
  v_lshlrev_b32 v253, 4, v253
  v_lshl_add_u32 v172, v252, 7, v253
  s_add_u32 s14, s4, 0
  s_and_b32 s14, s14, 3
  s_lshl_b32 s14, s14, 5
  v_xor_b32 v10, s14, v172
  s_add_u32 s14, s4, 1
  s_and_b32 s14, s14, 3
  s_lshl_b32 s14, s14, 5
  v_xor_b32 v11, s14, v172
  s_add_u32 s14, s4, 2
  s_and_b32 s14, s14, 3
  s_lshl_b32 s14, s14, 5
  v_xor_b32 v12, s14, v172
  s_add_u32 s14, s4, 3
  s_and_b32 s14, s14, 3
  s_lshl_b32 s14, s14, 5
  v_xor_b32 v13, s14, v172
  s_mov_b32 s48, s73
  s_add_u32 s14, s11, 1
  s_and_b32 s14, s14, 7
  s_mul_i32 s49, s14, 229376
  s_add_u32 s14, s11, 2
  s_and_b32 s14, s14, 7
  s_mul_i32 s50, s14, 229376
  s_add_u32 s14, s11, 3
  s_and_b32 s14, s14, 7
  s_mul_i32 s51, s14, 229376
  s_add_u32 s14, s11, 4
  s_and_b32 s14, s14, 7
  s_mul_i32 s52, s14, 229376
  s_add_u32 s14, s11, 5
  s_and_b32 s14, s14, 7
  s_mul_i32 s53, s14, 229376
  s_add_u32 s14, s11, 6
  s_and_b32 s14, s14, 7
  s_mul_i32 s54, s14, 229376
  s_add_u32 s14, s11, 7
  s_and_b32 s14, s14, 7
  s_mul_i32 s55, s14, 229376
  s_sub_u32 s14, s75, s74
  v_add_u32 v71, s14, v5
  s_add_u32 m0, s76, 32768
  s_add_u32 s72, s72, 128
  s_and_b32 s72, s72, 0x3ff
  buffer_load_dwordx4 v2, s[16:19], s72 offen lds
  s_add_u32 m0, s76, 33792
  s_nop 0
  buffer_load_dwordx4 v3, s[16:19], s72 offen lds
  s_add_u32 m0, s77, 32768
  s_nop 0
  buffer_load_dwordx4 v4, s[20:23], s72 offen lds
  s_add_u32 m0, s78, 57344
  s_nop 0
  buffer_load_dwordx4 v5, s[24:27], s49 offen lds
  s_waitcnt lgkmcnt(0)
  s_waitcnt vmcnt(7)
  s_barrier
  ds_read_b128 v[128:131], v6 offset:0
  ds_read_b128 v[72:75], v10 offset:16384
  ds_read_b128 v[76:79], v10 offset:20480
  s_lshl_b32 s14, s5, 7
  s_lshl_b32 s15, s10, 3
  s_add_u32 s14, s14, s15
  s_add_u32 s87, s14, s3
  s_lshl_b32 s14, s87, 10
  v_mov_b32 v237, 0
  buffer_load_dword v236, v237, s[28:31], 0 offen sc1
  buffer_load_dwordx4 v[232:235], v1, s[16:19], s14 offen
  s_add_u32 m0, s76, 65536
  s_add_u32 s72, s72, 128
  s_and_b32 s72, s72, 0x3ff
  buffer_load_dwordx4 v2, s[16:19], s72 offen lds
  ds_read_b128 v[132:135], v7 offset:0
  ds_read_b128 v[80:83], v11 offset:16384
  ds_read_b128 v[84:87], v11 offset:20480
  s_lshl_b32 s14, s4, 1
  v_add_u32 v14, s14, v14
  v_lshrrev_b32 v252, 4, v0
  v_and_b32 v253, 15, v0
  v_lshlrev_b32 v254, 2, v252
  v_xor_b32 v253, v253, v254
  s_lshl_b32 s14, s4, 12
  s_lshl_b32 s15, s9, 8
  s_add_u32 s14, s14, s15
  v_lshlrev_b32 v253, 4, v253
  v_lshl_add_u32 v144, v252, 10, v253
  v_add_u32 v144, s14, v144
  v_lshrrev_b32 v254, 5, v0
  v_and_b32 v255, 31, v0
  s_lshl_b32 s14, s4, 7
  s_add_u32 s14, s14, 155648
  v_lshl_add_u32 v145, v254, 6, s14
  v_lshl_add_u32 v168, v254, 9, s14
  v_lshl_add_u32 v168, v24, 2, v168
  v_mul_u32_u24 v148, 48, v255
  v_add_u32 v146, 0x26800, v148
  ds_read_b128 v[136:139], v8 offset:0
  ds_read_b128 v[88:91], v12 offset:16384
  ds_read_b128 v[92:95], v12 offset:20480
  v_add_u32 v148, 0x27800, v148
  s_lshl_b32 s14, s4, 3
  v_add_u32 v149, s14, v148
  s_lshl_b32 s14, s4, 2
  v_lshl_add_u32 v169, v254, 4, v146
  v_add_u32 v169, s14, v169
  v_mul_u32_u24 v147, 80, v255
  v_add_u32 v147, 0x26e00, v147
  v_lshl_add_u32 v170, v14, 3, v147
  s_add_u32 m0, s76, 66560
  s_nop 0
  buffer_load_dwordx4 v3, s[16:19], s72 offen lds
  s_cmp_eq_u32 s4, 0
  s_cselect_b32 s14, 32, 0
  v_cmp_gt_u32 vcc, s14, v0
  v_mov_b32 v171, 0x40000000
  s_nop 0
  v_cndmask_b32 v171, v171, v1, vcc
  s_lshl_b32 s14, s10, 4
  s_add_u32 s14, s14, s5
  s_lshl_b32 s14, s14, 9
  s_add_u32 s88, s14, 0x10000
  s_lshl_b32 s14, s10, 13
  s_add_u32 s89, s14, 0x10000
  s_lshl_b32 s14, s8, 8
  s_lshr_b32 s15, s9, 1
  s_lshl_b32 s15, s15, 7
  s_add_u32 s91, s14, s15
  s_xor_b32 s92, s91, 128
  s_lshl_b32 s14, s5, 2
  s_add_u32 s14, s14, s9
  s_lshl_b32 s14, s14, 2
  s_xor_b32 s15, s8, 2
  s_add_u32 s14, s14, s15
  s_lshl_b32 s14, s14, 2
  s_add_u32 s14, s14, s4
  s_mul_i32 s14, s14, 2176
  s_add_u32 s93, s14, 0x100000
  s_xor_b32 s94, s84, 512
  s_lshl_b32 s14, s5, 2
  s_add_u32 s14, s14, s4
  s_lshl_b32 s14, s14, 16
  s_lshl_b32 s15, s9, 9
  s_add_u32 s14, s14, s15
  s_lshl_b32 s15, s8, 7
  s_add_u32 s56, s14, s15
  s_xor_b32 s57, s56, 512
  s_xor_b32 s58, s56, 1024
  s_xor_b32 s59, s56, 1536
  s_waitcnt lgkmcnt(7)
  v_mfma_f32_32x32x16_bf16 v[32:47], v[128:131], v[72:75], 0
  ds_read_b128 v[140:143], v9 offset:0
  ds_read_b128 v[96:99], v13 offset:16384
  ds_read_b128 v[100:103], v13 offset:20480
  v_lshrrev_b32 v158, 3, v0
  v_and_b32 v159, 0x70, v1
  v_lshl_add_u32 v158, v158, 13, v159
  v_add_u32 v159, 0x1000, v158
  v_lshlrev_b32 v151, 1, v254
  v_bfe_u32 v252, v0, 1, 2
  v_xor_b32 v151, v151, v252
  v_lshlrev_b32 v150, 6, v255
  v_lshl_add_u32 v150, v151, 4, v150
  s_add_u32 m0, s77, 65536
  s_waitcnt lgkmcnt(9)
  v_mfma_f32_32x32x16_bf16 v[48:63], v[128:131], v[76:79], 0
  buffer_load_dwordx4 v4, s[20:23], s72 offen lds
  v_mfma_f32_16x16x32_bf16 v[104:107], v[112:115], v[72:75], 0
  v_mfma_f32_16x16x32_bf16 v[108:111], v[112:115], v[76:79], 0
  s_lshl_b32 s14, s4, 12
  v_add_u32 v166, s14, v1
  s_add_u32 s14, s14, 139264
  v_add_u32 v150, s14, v150
  v_add_u32 v167, s14, v1
  v_xor_b32 v151, 16, v150
  v_bfe_u32 v252, v0, 2, 2
  v_lshrrev_b32 v153, 5, v0
  v_lshl_add_u32 v152, v153, 3, v252
  v_lshlrev_b32 v152, 6, v152
  s_waitcnt lgkmcnt(7)
  v_mfma_f32_32x32x16_bf16 v[32:47], v[132:135], v[80:83], v[32:47]
  v_lshrrev_b32 v252, 1, v252
  v_and_b32 v153, 1, v0
  v_lshlrev_b32 v153, 1, v153
  v_xor_b32 v252, v252, v153
  v_bfe_u32 v153, v0, 4, 1
  v_xor_b32 v252, v252, v153
  s_add_u32 m0, s78, 90112
  s_waitcnt lgkmcnt(6)
  v_mfma_f32_32x32x16_bf16 v[48:63], v[132:135], v[84:87], v[48:63]
  buffer_load_dwordx4 v5, s[24:27], s50 offen lds
  v_lshl_add_u32 v152, v252, 4, v152
  v_bfe_u32 v252, v0, 1, 1
  v_lshl_add_u32 v152, v252, 3, v152
  s_lshl_b32 s14, s4, 12
  s_add_u32 s14, s14, 139264
  v_add_u32 v152, s14, v152
  v_xor_b32 v153, 32, v152
  v_add_u32 v153, 256, v153
  s_waitcnt lgkmcnt(0)
  s_waitcnt vmcnt(6)
  s_barrier
  v_mfma_f32_32x32x16_bf16 v[32:47], v[136:139], v[88:91], v[32:47]
  ds_read_b128 v[128:131], v6 offset:32768
  ds_read_b128 v[72:75], v10 offset:49152
  ds_read_b128 v[76:79], v10 offset:53248
  v_lshrrev_b32 v252, 3, v0
  v_lshrrev_b32 v253, 4, v0
  v_and_b32 v155, 7, v0
  v_xor_b32 v253, v253, v155
  s_lshl_b32 s14, s9, 7
  s_lshl_b32 s15, s4, 5
  s_add_u32 s14, s14, s15
  v_add_u32 v252, s14, v252
  v_lshlrev_b32 v253, 4, v253
  s_add_u32 m0, s76, 0
  s_add_u32 s72, s72, 128
  s_and_b32 s72, s72, 0x3ff
  v_mfma_f32_32x32x16_bf16 v[48:63], v[136:139], v[92:95], v[48:63]
  buffer_load_dwordx4 v2, s[16:19], s72 offen lds
  ds_read_b128 v[132:135], v7 offset:32768
  ds_read_b128 v[80:83], v11 offset:49152
  ds_read_b128 v[84:87], v11 offset:53248
  v_lshl_add_u32 v154, v252, 10, v253
  v_xor_b32 v155, 64, v154
  v_add_u32 v155, 0x2000, v155
  v_cmp_gt_u32 vcc, 32, v0
  v_lshlrev_b32 v252, 2, v0
  v_mov_b32 v156, 0x40000000
  v_cndmask_b32 v156, v156, v252, vcc
  s_and_b32 s14, s9, 1
  s_lshl_b32 s14, s14, 6
  s_add_u32 s14, s14, 0x10000
  v_xor_b32 v252, s14, v172
  v_mfma_f32_32x32x16_bf16 v[32:47], v[140:143], v[96:99], v[32:47]
  ds_read_b128 v[136:139], v8 offset:32768
  ds_read_b128 v[88:91], v12 offset:49152
  ds_read_b128 v[92:95], v12 offset:53248
  s_xor_b32 s14, s8, 3
  s_lshl_b32 s14, s14, 12
  v_add_u32 v172, s14, v252
  v_xor_b32 v173, 32, v172
  s_xor_b32 s14, s8, 1
  s_lshl_b32 s14, s14, 12
  v_add_u32 v174, s14, v252
  v_xor_b32 v175, 32, v174
  s_xor_b32 s14, s8, 0
  s_lshl_b32 s14, s14, 12
  v_add_u32 v176, s14, v252
  v_xor_b32 v177, 32, v176
  s_add_u32 m0, s76, 1024
  v_mfma_f32_32x32x16_bf16 v[48:63], v[140:143], v[100:103], v[48:63]
  buffer_load_dwordx4 v3, s[16:19], s72 offen lds
  v_xor_b32 v178, 0x40, v172
  v_xor_b32 v179, 0x60, v172
  v_xor_b32 v180, 0x10000, v172
  v_xor_b32 v181, 0x10020, v172
  v_xor_b32 v182, 0x10040, v172
  s_waitcnt lgkmcnt(7)
  v_mfma_f32_32x32x16_bf16 v[32:47], v[128:131], v[72:75], v[32:47]
  ds_read_b128 v[140:143], v9 offset:32768
  ds_read_b128 v[96:99], v13 offset:49152
  ds_read_b128 v[100:103], v13 offset:53248
  v_xor_b32 v183, 0x10060, v172
  s_lshl_b32 s14, s5, 7
  s_lshl_b32 s15, s4, 5
  s_add_u32 s14, s14, s15
  v_add_u32 v164, s14, v24
  s_lshl_b32 s14, s9, 7
  s_lshl_b32 s15, s8, 5
  s_add_u32 s14, s14, s15
  v_lshlrev_b32 v165, 2, v254
  v_add_lshl_u32 v165, s14, v165, 1
  v_lshl_add_u32 v164, v164, 10, v165
  s_lshl_b32 s86, s4, 2
  s_sub_u32 s86, s5, s86
  s_sub_u32 s86, s86, 1
  v_sub_u32 v162, s86, v254
  v_subrev_u32 v163, 2, v162
  s_add_u32 m0, s77, 0
  s_waitcnt lgkmcnt(9)
  v_mfma_f32_32x32x16_bf16 v[48:63], v[128:131], v[76:79], v[48:63]
  buffer_load_dwordx4 v4, s[20:23], s72 offen lds
  v_mfma_f32_16x16x32_bf16 v[104:107], v[112:115], v[72:75], v[104:107]
  v_mfma_f32_16x16x32_bf16 v[108:111], v[112:115], v[76:79], v[108:111]
  v_and_b32 v252, 0x1f0, v1
  v_mov_b32 v122, 1
  v_cmp_le_i32 vcc, 0, v162
  v_lshl_add_u32 v160, v162, 9, v252
  v_mov_b32 v162, 0x40000000
  v_cndmask_b32 v160, v162, v160, vcc
  v_cndmask_b32 v162, 0, -1, vcc
  v_cmp_le_i32 vcc, 0, v163
  v_lshl_add_u32 v161, v163, 9, v252
  v_mov_b32 v163, 0x40000000
  v_cndmask_b32 v161, v163, v161, vcc
  v_cndmask_b32 v163, 0, -1, vcc
  v_lshlrev_b32 v64, 16, v117
  s_waitcnt lgkmcnt(7)
  v_mfma_f32_32x32x16_bf16 v[32:47], v[132:135], v[80:83], v[32:47]
  v_lshlrev_b32 v68, 16, v119
  v_mul_f32 v68, 0x3fb8aa3b, v68
  v_exp_f32 v68, v68
  v_lshlrev_b32 v65, 16, v118
  v_cvt_pk_bf16_f32 v68, v68, v68
  v_lshlrev_b32 v68, 16, v68
  s_add_u32 m0, s78, 24576
  s_waitcnt lgkmcnt(6)
  v_mfma_f32_32x32x16_bf16 v[48:63], v[132:135], v[84:87], v[48:63]
  buffer_load_dwordx4 v5, s[24:27], s51 offen lds
  v_mul_f32 v66, v68, v64
  v_mul_f32 v67, v68, v65
  v_mul_f32 v66, 0x3fb8aa3b, v66
  v_mul_f32 v67, 0.15915494, v67
  v_mul_f32 v69, 1.0, v67
  s_waitcnt lgkmcnt(0)
  s_waitcnt vmcnt(4)
  s_barrier
  v_mfma_f32_32x32x16_bf16 v[32:47], v[136:139], v[88:91], v[32:47]
  v_add_u32 v6, 0x10000, v6
  v_add_u32 v7, 0x10000, v7
  v_add_u32 v8, 0x10000, v8
  v_add_u32 v9, 0x10000, v9
  v_add_u32 v10, 0x14000, v10
  v_add_u32 v11, 0x14000, v11
  v_add_u32 v12, 0x14000, v12
  v_add_u32 v13, 0x14000, v13
  ds_read_b128 v[128:131], v6 offset:0
  ds_read_b128 v[72:75], v10 offset:0
  ds_read_b128 v[76:79], v10 offset:4096
  v_mul_f32 v68, 1.0, v66
  v_fract_f32 v69, v69
  v_cos_f32 v15, v69
  v_exp_f32 v68, v68
  s_add_u32 m0, s76, 32768
  s_add_u32 s72, s72, 128
  s_and_b32 s72, s72, 0x3ff
  v_mfma_f32_32x32x16_bf16 v[48:63], v[136:139], v[92:95], v[48:63]
  buffer_load_dwordx4 v2, s[16:19], s72 offen lds
  ds_read_b128 v[132:135], v7 offset:0
  ds_read_b128 v[80:83], v11 offset:0
  ds_read_b128 v[84:87], v11 offset:4096
  v_sin_f32 v16, v69
  v_mul_f32 v15, v68, v15
  v_mul_f32 v16, v68, v16
  v_sub_f32 v17, 0, v16
  s_add_u32 m0, s78, 98304
  v_mfma_f32_32x32x16_bf16 v[32:47], v[140:143], v[96:99], v[32:47]
  ds_read_b128 v[136:139], v8 offset:0
  ds_read_b128 v[88:91], v12 offset:0
  ds_read_b128 v[92:95], v12 offset:4096
  buffer_load_dwordx4 v71, s[24:27], s52 offen lds
  v_mul_f32 v69, 0x41800000, v67
  v_mul_f32 v68, 0x41800000, v66
  v_fract_f32 v69, v69
  s_add_u32 m0, s76, 33792
  v_mfma_f32_32x32x16_bf16 v[48:63], v[140:143], v[100:103], v[48:63]
  buffer_load_dwordx4 v3, s[16:19], s72 offen lds
  v_readfirstlane_b32 s100, v236
  s_mov_b32 s98, 0x3f803f80
  v_dot2_f32_bf16 v248, v232, v232, 0
  v_dot2_f32_bf16 v246, s98, v232, 0
  s_mul_i32 s12, s100, 0x9E3779B1
  s_add_u32 s12, s12, 0x7F4A7C15
  s_or_b32 s12, s12, 8
  v_dot2_f32_bf16 v248, v233, v233, v248
  v_cos_f32 v25, v69
  v_exp_f32 v68, v68
  v_sin_f32 v26, v69
  v_mul_f32 v25, v68, v25
  s_waitcnt lgkmcnt(7)
  v_mfma_f32_32x32x16_bf16 v[32:47], v[128:131], v[72:75], v[32:47]
  ds_read_b128 v[140:143], v9 offset:0
  ds_read_b128 v[96:99], v13 offset:0
  ds_read_b128 v[100:103], v13 offset:4096
  v_dot2_f32_bf16 v246, s98, v233, v246
  v_dot2_f32_bf16 v248, v234, v234, v248
  v_dot2_f32_bf16 v246, s98, v234, v246
  v_dot2_f32_bf16 v248, v235, v235, v248
  v_dot2_f32_bf16 v246, s98, v235, v246
  v_mov_b32 v18, s12
  s_nop 0
  v_add_f32_dpp v248, v248, v248 quad_perm:[1,0,3,2] row_mask:0xf bank_mask:0xf
  v_add_f32_dpp v246, v246, v246 quad_perm:[1,0,3,2] row_mask:0xf bank_mask:0xf
  v_mul_f32 v26, v68, v26
  v_sub_f32 v27, 0, v26
  v_lshlrev_b32 v70, 4, v14
  v_cvt_f32_u32 v70, v70
  s_add_u32 m0, s77, 32768
  s_waitcnt lgkmcnt(9)
  v_mfma_f32_32x32x16_bf16 v[48:63], v[128:131], v[76:79], v[48:63]
  buffer_load_dwordx4 v4, s[20:23], s72 offen lds
  v_mfma_f32_16x16x32_bf16 v[104:107], v[112:115], v[72:75], v[104:107]
  v_mfma_f32_16x16x32_bf16 v[108:111], v[112:115], v[76:79], v[108:111]
  v_mov_b32 v247, s12
  v_add_f32_dpp v248, v248, v248 quad_perm:[2,3,0,1] row_mask:0xf bank_mask:0xf
  v_add_f32_dpp v246, v246, v246 quad_perm:[2,3,0,1] row_mask:0xf bank_mask:0xf
  s_xor_b32 s99, s12, s69
  v_add_f32_dpp v248, v248, v248 row_half_mirror row_mask:0xf bank_mask:0xf
  v_add_f32_dpp v246, v246, v246 row_half_mirror row_mask:0xf bank_mask:0xf
  v_mov_b32 v249, s99
  v_add_f32_dpp v248, v248, v248 row_mirror row_mask:0xf bank_mask:0xf
  v_mul_f32 v69, v70, v67
  v_mul_f32 v68, v70, v66
  v_fract_f32 v69, v69
  s_waitcnt lgkmcnt(7)
  v_mfma_f32_32x32x16_bf16 v[32:47], v[132:135], v[80:83], v[32:47]
  v_add_f32_dpp v246, v246, v246 row_mirror row_mask:0xf bank_mask:0xf
  s_lshl_b32 s87, s87, 4
  v_add_f32_dpp v248, v248, v248 row_bcast:15 row_mask:0xa bank_mask:0xf
  v_add_f32_dpp v246, v246, v246 row_bcast:15 row_mask:0xa bank_mask:0xf
  s_add_u32 s87, s87, 0x1000
  v_add_f32_dpp v248, v248, v248 row_bcast:31 row_mask:0xc bank_mask:0xf
  v_add_f32_dpp v246, v246, v246 row_bcast:31 row_mask:0xc bank_mask:0xf
  v_mul_f32 v248, 0x3b000000, v248
  v_cos_f32 v28, v69
  v_exp_f32 v68, v68
  v_sin_f32 v29, v69
  v_mul_f32 v28, v68, v28
  s_add_u32 m0, s78, 57344
  s_waitcnt lgkmcnt(6)
  v_mfma_f32_32x32x16_bf16 v[48:63], v[132:135], v[84:87], v[48:63]
  buffer_load_dwordx4 v5, s[24:27], s52 offen lds
  v_mul_f32 v246, 0x3b000000, v246
  v_fma_f32 v248, -v246, v246, v248
  v_max_f32 v248, 0, v248
  v_add_f32 v248, 0x3727c5ac, v248
  v_rsq_f32 v248, v248
  s_nop 0
  buffer_store_dwordx4 v[246:249], v238, s[28:31], s87 offen sc1
  v_mul_f32 v29, v68, v29
  v_lshrrev_b32 v70, 5, v0
  s_lshl_b32 s86, s4, 2
  v_add_lshl_u32 v70, s86, v70, 7
  s_waitcnt lgkmcnt(0)
  s_waitcnt vmcnt(6)
  s_barrier
  v_mfma_f32_32x32x16_bf16 v[32:47], v[136:139], v[88:91], v[32:47]
  v_add_u32 v6, 0xffff0000, v6
  v_add_u32 v7, 0xffff0000, v7
  v_add_u32 v8, 0xffff0000, v8
  v_add_u32 v9, 0xffff0000, v9
  v_add_u32 v10, 0xffff0000, v10
  v_add_u32 v11, 0xffff0000, v11
  v_add_u32 v12, 0xffff0000, v12
  v_add_u32 v13, 0xffff0000, v13
  ds_read_b128 v[128:131], v6 offset:0
  ds_read_b128 v[72:75], v10 offset:0
  ds_read_b128 v[76:79], v10 offset:4096
  s_add_u32 m0, s76, 65536
  s_add_u32 s72, s72, 128
  s_and_b32 s72, s72, 0x3ff
  v_mfma_f32_32x32x16_bf16 v[48:63], v[136:139], v[92:95], v[48:63]
  buffer_load_dwordx4 v2, s[16:19], s72 offen lds
  ds_read_b128 v[132:135], v7 offset:0
  ds_read_b128 v[80:83], v11 offset:0
  ds_read_b128 v[84:87], v11 offset:4096
  s_add_u32 m0, s78, 106496
  v_mfma_f32_32x32x16_bf16 v[32:47], v[140:143], v[96:99], v[32:47]
  ds_read_b128 v[136:139], v8 offset:0
  ds_read_b128 v[88:91], v12 offset:0
  ds_read_b128 v[92:95], v12 offset:4096
  buffer_load_dwordx4 v71, s[24:27], s53 offen lds
  s_add_u32 m0, s76, 66560
  v_mfma_f32_32x32x16_bf16 v[48:63], v[140:143], v[100:103], v[48:63]
  buffer_load_dwordx4 v3, s[16:19], s72 offen lds
  s_waitcnt lgkmcnt(7)
  v_mfma_f32_32x32x16_bf16 v[32:47], v[128:131], v[72:75], v[32:47]
  ds_read_b128 v[140:143], v9 offset:0
  ds_read_b128 v[96:99], v13 offset:0
  ds_read_b128 v[100:103], v13 offset:4096
  s_add_u32 m0, s77, 65536
  s_waitcnt lgkmcnt(9)
  v_mfma_f32_32x32x16_bf16 v[48:63], v[128:131], v[76:79], v[48:63]
  buffer_load_dwordx4 v4, s[20:23], s72 offen lds
  v_mfma_f32_16x16x32_bf16 v[104:107], v[112:115], v[72:75], v[104:107]
  v_mfma_f32_16x16x32_bf16 v[108:111], v[112:115], v[76:79], v[108:111]
  s_waitcnt lgkmcnt(7)
  v_mfma_f32_32x32x16_bf16 v[32:47], v[132:135], v[80:83], v[32:47]
  s_add_u32 m0, s78, 90112
  s_waitcnt lgkmcnt(6)
  v_mfma_f32_32x32x16_bf16 v[48:63], v[132:135], v[84:87], v[48:63]
  buffer_load_dwordx4 v5, s[24:27], s53 offen lds
  s_waitcnt lgkmcnt(0)
  s_waitcnt vmcnt(6)
  s_barrier
  v_mfma_f32_32x32x16_bf16 v[32:47], v[136:139], v[88:91], v[32:47]
  ds_read_b128 v[128:131], v6 offset:32768
  ds_read_b128 v[72:75], v10 offset:32768
  ds_read_b128 v[76:79], v10 offset:36864
  v_cvt_f32_u32 v70, v70
  v_mul_f32 v69, v70, v67
  v_mul_f32 v68, v70, v66
  v_fract_f32 v69, v69
  s_add_u32 m0, s76, 0
  s_add_u32 s72, s72, 128
  s_and_b32 s72, s72, 0x3ff
  v_mfma_f32_32x32x16_bf16 v[48:63], v[136:139], v[92:95], v[48:63]
  buffer_load_dwordx4 v2, s[16:19], s72 offen lds
  ds_read_b128 v[132:135], v7 offset:32768
  ds_read_b128 v[80:83], v11 offset:32768
  ds_read_b128 v[84:87], v11 offset:36864
  v_cos_f32 v116, v69
  v_exp_f32 v68, v68
  v_sin_f32 v117, v69
  v_mul_f32 v116, v68, v116
  s_add_u32 m0, s78, 114688
  v_mfma_f32_32x32x16_bf16 v[32:47], v[140:143], v[96:99], v[32:47]
  ds_read_b128 v[136:139], v8 offset:32768
  ds_read_b128 v[88:91], v12 offset:32768
  ds_read_b128 v[92:95], v12 offset:36864
  buffer_load_dwordx4 v71, s[24:27], s54 offen lds
  v_mul_f32 v117, v68, v117
  v_add_f32 v70, 0x43800000, v70
  v_mul_f32 v69, v70, v67
  v_mul_f32 v68, v70, v66
  s_add_u32 m0, s76, 1024
  v_mfma_f32_32x32x16_bf16 v[48:63], v[140:143], v[100:103], v[48:63]
  buffer_load_dwordx4 v3, s[16:19], s72 offen lds
  v_fract_f32 v69, v69
  v_cos_f32 v118, v69
  v_exp_f32 v68, v68
  s_waitcnt lgkmcnt(7)
  v_mfma_f32_32x32x16_bf16 v[32:47], v[128:131], v[72:75], v[32:47]
  ds_read_b128 v[140:143], v9 offset:32768
  ds_read_b128 v[96:99], v13 offset:32768
  ds_read_b128 v[100:103], v13 offset:36864
  v_sin_f32 v119, v69
  v_mul_f32 v118, v68, v118
  v_mul_f32 v119, v68, v119
  v_add_f32 v68, -1.0, v15
  s_add_u32 m0, s77, 0
  s_waitcnt lgkmcnt(9)
  v_mfma_f32_32x32x16_bf16 v[48:63], v[128:131], v[76:79], v[48:63]
  buffer_load_dwordx4 v4, s[20:23], s72 offen lds
  v_mfma_f32_16x16x32_bf16 v[104:107], v[112:115], v[72:75], v[104:107]
  v_mfma_f32_16x16x32_bf16 v[108:111], v[112:115], v[76:79], v[108:111]
  v_mul_f32 v69, v64, v64
  v_fmac_f32 v69, v65, v65
  v_rcp_f32 v69, v69
  v_mul_f32 v30, v68, v64
  s_waitcnt lgkmcnt(7)
  v_mfma_f32_32x32x16_bf16 v[32:47], v[132:135], v[80:83], v[32:47]
  v_fmac_f32 v30, v16, v65
  v_mul_f32 v31, v16, v64
  v_mul_f32 v68, v68, v65
  v_sub_f32 v31, v31, v68
  s_add_u32 m0, s78, 24576
  s_waitcnt lgkmcnt(6)
  v_mfma_f32_32x32x16_bf16 v[48:63], v[132:135], v[84:87], v[48:63]
  buffer_load_dwordx4 v5, s[24:27], s54 offen lds
  v_mul_f32 v69, 0xc038aa3b, v69
  v_mul_f32 v30, v30, v69
  v_mul_f32 v31, v31, v69
  s_waitcnt lgkmcnt(0)
  s_waitcnt vmcnt(5)
  s_barrier
  v_mfma_f32_32x32x16_bf16 v[32:47], v[136:139], v[88:91], v[32:47]
  v_add_u32 v6, 0x10000, v6
  v_add_u32 v7, 0x10000, v7
  v_add_u32 v8, 0x10000, v8
  v_add_u32 v9, 0x10000, v9
  v_add_u32 v10, 0x10000, v10
  v_add_u32 v11, 0x10000, v11
  v_add_u32 v12, 0x10000, v12
  v_add_u32 v13, 0x10000, v13
  ds_read_b128 v[128:131], v6 offset:0
  ds_read_b128 v[72:75], v10 offset:0
  ds_read_b128 v[76:79], v10 offset:4096
  s_add_u32 m0, s76, 32768
  s_add_u32 s72, s72, 128
  s_and_b32 s72, s72, 0x3ff
  v_mfma_f32_32x32x16_bf16 v[48:63], v[136:139], v[92:95], v[48:63]
  buffer_load_dwordx4 v2, s[16:19], s72 offen lds
  ds_read_b128 v[132:135], v7 offset:0
  ds_read_b128 v[80:83], v11 offset:0
  ds_read_b128 v[84:87], v11 offset:4096
  s_add_u32 m0, s78, 122880
  v_mfma_f32_32x32x16_bf16 v[32:47], v[140:143], v[96:99], v[32:47]
  ds_read_b128 v[136:139], v8 offset:0
  ds_read_b128 v[88:91], v12 offset:0
  ds_read_b128 v[92:95], v12 offset:4096
  buffer_load_dwordx4 v71, s[24:27], s55 offen lds
  s_add_u32 m0, s76, 33792
  v_mfma_f32_32x32x16_bf16 v[48:63], v[140:143], v[100:103], v[48:63]
  buffer_load_dwordx4 v3, s[16:19], s72 offen lds
  s_waitcnt lgkmcnt(7)
  v_mfma_f32_32x32x16_bf16 v[32:47], v[128:131], v[72:75], v[32:47]
  ds_read_b128 v[140:143], v9 offset:0
  ds_read_b128 v[96:99], v13 offset:0
  ds_read_b128 v[100:103], v13 offset:4096
  s_add_u32 m0, s77, 32768
  s_waitcnt lgkmcnt(9)
  v_mfma_f32_32x32x16_bf16 v[48:63], v[128:131], v[76:79], v[48:63]
  buffer_load_dwordx4 v4, s[20:23], s72 offen lds
  v_mfma_f32_16x16x32_bf16 v[104:107], v[112:115], v[72:75], v[104:107]
  v_mfma_f32_16x16x32_bf16 v[108:111], v[112:115], v[76:79], v[108:111]
  s_waitcnt lgkmcnt(7)
  v_mfma_f32_32x32x16_bf16 v[32:47], v[132:135], v[80:83], v[32:47]
  s_add_u32 m0, s78, 57344
  s_waitcnt lgkmcnt(6)
  v_mfma_f32_32x32x16_bf16 v[48:63], v[132:135], v[84:87], v[48:63]
  buffer_load_dwordx4 v5, s[24:27], s55 offen lds
  s_waitcnt lgkmcnt(0)
  s_waitcnt vmcnt(5)
  s_barrier
  v_mfma_f32_32x32x16_bf16 v[32:47], v[136:139], v[88:91], v[32:47]
  v_add_u32 v6, 0xffff0000, v6
  v_add_u32 v7, 0xffff0000, v7
  v_add_u32 v8, 0xffff0000, v8
  v_add_u32 v9, 0xffff0000, v9
  v_add_u32 v10, 0xffff0000, v10
  v_add_u32 v11, 0xffff0000, v11
  v_add_u32 v12, 0xffff0000, v12
  v_add_u32 v13, 0xffff0000, v13
  ds_read_b128 v[128:131], v6 offset:0
  ds_read_b128 v[72:75], v10 offset:0
  ds_read_b128 v[76:79], v10 offset:4096
  v_lshlrev_b32 v120, 4, v24
  s_lshl_b32 s14, s5, 11
  s_lshl_b32 s15, s4, 9
  s_add_u32 s14, s14, s15
  s_add_u32 s82, s14, 0x1000
  buffer_load_dwordx4 v[64:67], v120, s[28:31], s82 offen sc1
  v_and_b32 v162, v18, v162
  v_and_b32 v163, v18, v163
  s_add_u32 m0, s78, 65536
  v_mfma_f32_32x32x16_bf16 v[48:63], v[136:139], v[92:95], v[48:63]
  buffer_load_dwordx4 v71, s[24:27], s48 offen lds
  ds_read_b128 v[132:135], v7 offset:0
  ds_read_b128 v[80:83], v11 offset:0
  ds_read_b128 v[84:87], v11 offset:4096
  v_mfma_f32_32x32x16_bf16 v[32:47], v[140:143], v[96:99], v[32:47]
  ds_read_b128 v[136:139], v8 offset:0
  ds_read_b128 v[88:91], v12 offset:0
  ds_read_b128 v[92:95], v12 offset:4096
  s_add_u32 m0, s78, 73728
  v_mfma_f32_32x32x16_bf16 v[48:63], v[140:143], v[100:103], v[48:63]
  buffer_load_dwordx4 v71, s[24:27], s49 offen lds
  s_waitcnt lgkmcnt(7)
  v_mfma_f32_32x32x16_bf16 v[32:47], v[128:131], v[72:75], v[32:47]
  ds_read_b128 v[140:143], v9 offset:0
  ds_read_b128 v[96:99], v13 offset:0
  ds_read_b128 v[100:103], v13 offset:4096
  s_add_u32 m0, s78, 81920
  s_waitcnt lgkmcnt(9)
  v_mfma_f32_32x32x16_bf16 v[48:63], v[128:131], v[76:79], v[48:63]
  buffer_load_dwordx4 v71, s[24:27], s50 offen lds
  v_mfma_f32_16x16x32_bf16 v[104:107], v[112:115], v[72:75], v[104:107]
  v_mfma_f32_16x16x32_bf16 v[108:111], v[112:115], v[76:79], v[108:111]
  s_waitcnt lgkmcnt(7)
  v_mfma_f32_32x32x16_bf16 v[32:47], v[132:135], v[80:83], v[32:47]
  s_add_u32 m0, s78, 90112
  s_waitcnt lgkmcnt(6)
  v_mfma_f32_32x32x16_bf16 v[48:63], v[132:135], v[84:87], v[48:63]
  buffer_load_dwordx4 v71, s[24:27], s51 offen lds
  s_waitcnt lgkmcnt(0)
  s_waitcnt vmcnt(5)
  s_barrier
  v_mfma_f32_32x32x16_bf16 v[32:47], v[136:139], v[88:91], v[32:47]
  ds_read_b128 v[128:131], v6 offset:32768
  ds_read_b128 v[72:75], v10 offset:32768
  ds_read_b128 v[76:79], v10 offset:36864
  s_add_u32 m0, s71, 8192
  s_xor_b32 s86, s9, 0
  s_lshl_b32 s87, s86, 17
  s_add_u32 s87, s87, 0x10000
  s_lshl_b32 s74, s86, 15
  s_add_u32 s74, s74, 0x40000
  s_cmp_ge_u32 s86, 2
  s_cselect_b32 s87, s74, s87
  s_add_u32 s87, s87, s70
  v_mfma_f32_32x32x16_bf16 v[48:63], v[136:139], v[92:95], v[48:63]
  buffer_load_dwordx4 v144, s[32:35], s87 offen lds
  ds_read_b128 v[132:135], v7 offset:32768
  ds_read_b128 v[80:83], v11 offset:32768
  ds_read_b128 v[84:87], v11 offset:36864
  v_mfma_f32_32x32x16_bf16 v[32:47], v[140:143], v[96:99], v[32:47]
  ds_read_b128 v[136:139], v8 offset:32768
  ds_read_b128 v[88:91], v12 offset:32768
  ds_read_b128 v[92:95], v12 offset:36864
  s_add_u32 m0, s71, 12288
  s_add_u32 s87, s87, 0x4000
  v_mfma_f32_32x32x16_bf16 v[48:63], v[140:143], v[100:103], v[48:63]
  buffer_load_dwordx4 v144, s[32:35], s87 offen lds
  s_waitcnt vmcnt(6)
  v_cmp_ne_u32 vcc, s12, v65
  v_xor_b32 v65, s12, v67
  v_cmp_lt_u32 s[98:99], 7, v65
  s_nop 0
  s_or_b64 vcc, vcc, s[98:99]
  s_cbranch_vccz L_bk158
L_in157:
  s_sub_u32 s13, s13, 1
  s_cbranch_scc1 L_sl159
  buffer_load_dwordx4 v[64:67], v120, s[28:31], s82 offen sc1
  s_waitcnt vmcnt(0)
  v_cmp_ne_u32 vcc, s12, v65
  s_nop 1
  v_xor_b32 v65, s12, v67
  s_nop 1
  v_cmp_lt_u32 s[98:99], 7, v65
  s_nop 1
  s_or_b64 vcc, vcc, s[98:99]
  s_cbranch_vccnz L_in157
L_bk158:
  v_cmp_ne_u32 s[98:99], s69, v65
  v_sub_f32 v22, 0, v64
  v_mov_b32 v23, v66
  v_cmp_gt_u32 vcc, 32, v0
  s_cmp_eq_u64 s[98:99], 0
  s_cselect_b32 s86, 1, 0
  v_mov_b32 v67, s86
  v_cndmask_b32 v65, v66, v22, vcc
  ds_write_b8 v21, v67 offset:16
  ds_write_b32 v168, v65
  s_waitcnt lgkmcnt(9)
  v_mfma_f32_32x32x16_bf16 v[32:47], v[128:131], v[72:75], v[32:47]
  ds_read_b128 v[140:143], v9 offset:32768
  ds_read_b128 v[96:99], v13 offset:32768
  ds_read_b128 v[100:103], v13 offset:36864
  s_add_u32 m0, s71, 16384
  s_xor_b32 s87, s9, 1
  s_lshl_b32 s87, s87, 17
  s_add_u32 s87, s87, s70
  s_waitcnt lgkmcnt(11)
  v_mfma_f32_32x32x16_bf16 v[48:63], v[128:131], v[76:79], v[48:63]
  buffer_load_dwordx4 v144, s[32:35], s87 offen lds
  v_mfma_f32_16x16x32_bf16 v[104:107], v[112:115], v[72:75], v[104:107]
  v_mfma_f32_16x16x32_bf16 v[108:111], v[112:115], v[76:79], v[108:111]
  v_cmp_gt_u32 vcc, 32, v0
  v_mov_b32 v8, 0
  v_mov_b32 v9, 0
  v_cndmask_b32 v7, 0, v22, vcc
  v_cvt_pk_bf16_f32 v6, v7, v7
  v_and_b32 v8, 0xffff0000, v6
  s_waitcnt lgkmcnt(9)
  v_mfma_f32_32x32x16_bf16 v[32:47], v[132:135], v[80:83], v[32:47]
  v_sub_f32 v7, v7, v8
  v_mov_b32 v8, 0
  v_cvt_pk_bf16_f32 v7, v7, 0
  s_add_u32 m0, s71, 20480
  s_add_u32 s87, s87, 0x4000
  s_waitcnt lgkmcnt(8)
  v_mfma_f32_32x32x16_bf16 v[48:63], v[132:135], v[84:87], v[48:63]
  buffer_load_dwordx4 v144, s[32:35], s87 offen lds
  v_cmp_gt_u32 vcc, 32, v0
  s_nop 1
  v_cndmask_b32 v65, v108, v104, vcc
  ds_write_b32 v169, v65
  s_waitcnt lgkmcnt(0)
  s_barrier
  s_setprio 2
  v_mfma_f32_32x32x16_bf16 v[32:47], v[136:139], v[88:91], v[32:47]
  ds_read_b128 v[64:67], v146
  ds_read_b128 v[68:71], v146 offset:16
  s_lshl_b32 s76, s4, 12
  v_mfma_f32_32x32x16_bf16 v[48:63], v[136:139], v[92:95], v[48:63]
  ds_read_b128 v[72:75], v145 offset:512
  ds_read_b128 v[76:79], v145 offset:528
  ds_read_b128 v[80:83], v145 offset:544
  ds_read_b128 v[84:87], v145 offset:560
  v_mfma_f32_32x32x16_bf16 v[32:47], v[140:143], v[96:99], v[32:47]
  s_waitcnt lgkmcnt(5)
  v_add_f32 v64, v64, v65
  v_add_f32 v66, v66, v67
  v_mov_b32 v67, 0
  v_add_f32 v64, v64, v66
  v_cvt_pk_bf16_f32 v65, v64, 0
  v_lshlrev_b32 v66, 16, v65
  v_sub_f32 v64, v64, v66
  v_cvt_pk_bf16_f32 v64, v66, v64
  v_mfma_f32_32x32x16_bf16 v[48:63], v[140:143], v[100:103], v[48:63]
  s_waitcnt lgkmcnt(4)
  v_add_f32 v68, v68, v69
  v_add_f32 v70, v70, v71
  v_mov_b32 v71, 0
  v_add_f32 v68, v68, v70
  v_cvt_pk_bf16_f32 v69, v68, 0
  v_lshlrev_b32 v70, 16, v69
  v_sub_f32 v68, v68, v70
  v_cvt_pk_bf16_f32 v68, v70, v68
  v_mfma_f32_32x32x16_bf16 v[32:47], v[6:9], v[64:67], v[32:47]
  s_nop 0
  v_mfma_f32_32x32x16_bf16 v[48:63], v[6:9], v[68:71], v[48:63]
  s_waitcnt vmcnt(4)
  ds_write_b8 v21, v122 offset:92
  s_add_u32 m0, s71, 24576
  s_xor_b32 s87, s9, 2
  s_lshl_b32 s87, s87, 17
  s_add_u32 s87, s87, s70
  buffer_load_dwordx4 v144, s[32:35], s87 offen lds
  s_add_u32 m0, s71, 28672
  s_add_u32 s87, s87, 0x4000
  buffer_load_dwordx4 v144, s[32:35], s87 offen lds
  s_add_u32 m0, s71, 32768
  s_xor_b32 s87, s9, 3
  s_lshl_b32 s87, s87, 17
  s_add_u32 s87, s87, s70
  buffer_load_dwordx4 v144, s[32:35], s87 offen lds
  s_waitcnt lgkmcnt(4)
  v_mul_f32 v32, v72, v32
  v_mul_f32 v48, v72, v48
  v_mul_f32 v33, v73, v33
  v_mul_f32 v49, v73, v49
  v_fma_f32 v64, v15, v32, v33
  s_add_u32 m0, s71, 36864
  s_add_u32 s87, s87, 0x4000
  buffer_load_dwordx4 v144, s[32:35], s87 offen lds
  v_fma_f32 v65, v15, v48, v49
  v_fmac_f32 v64, v17, v48
  v_fmac_f32 v65, v16, v32
  v_mul_f32 v34, v74, v34
  v_mov_b32 v89, s12
  v_mul_f32 v50, v74, v50
  v_mov_b32 v91, s12
  v_fma_f32 v66, v15, v64, v34
  v_fma_f32 v67, v15, v65, v50
  v_fmac_f32 v66, v17, v65
  v_fmac_f32 v67, v16, v64
  v_mul_f32 v35, v75, v35
  v_mul_f32 v51, v75, v51
  v_fma_f32 v64, v15, v66, v35
  v_fma_f32 v65, v15, v67, v51
  v_fmac_f32 v64, v17, v67
  v_fmac_f32 v65, v16, v66
  s_waitcnt lgkmcnt(3)
  v_mul_f32 v36, v76, v36
  v_mul_f32 v52, v76, v52
  v_fma_f32 v66, v15, v64, v36
  v_fma_f32 v67, v15, v65, v52
  v_fmac_f32 v66, v17, v65
  v_fmac_f32 v67, v16, v64
  v_mul_f32 v37, v77, v37
  v_mul_f32 v53, v77, v53
  v_fma_f32 v64, v15, v66, v37
  v_fma_f32 v65, v15, v67, v53
  v_fmac_f32 v64, v17, v67
  v_fmac_f32 v65, v16, v66
  v_mul_f32 v38, v78, v38
  v_mul_f32 v54, v78, v54
  s_add_u32 m0, s71, 40960
  s_xor_b32 s87, s9, 1
  s_lshl_b32 s87, s87, 17
  s_add_u32 s87, s87, s70
  s_add_u32 s87, s87, 0x8000
  buffer_load_dwordx4 v144, s[32:35], s87 offen lds
  v_fma_f32 v66, v15, v64, v38
  v_fma_f32 v67, v15, v65, v54
  v_fmac_f32 v66, v17, v65
  v_fmac_f32 v67, v16, v64
  v_mul_f32 v39, v79, v39
  v_mul_f32 v55, v79, v55
  v_fma_f32 v64, v15, v66, v39
  v_fma_f32 v65, v15, v67, v55
  v_fmac_f32 v64, v17, v67
  v_fmac_f32 v65, v16, v66
  s_waitcnt lgkmcnt(2)
  v_mul_f32 v40, v80, v40
  v_mul_f32 v56, v80, v56
  v_fma_f32 v66, v15, v64, v40
  v_fma_f32 v67, v15, v65, v56
  v_fmac_f32 v66, v17, v65
  v_fmac_f32 v67, v16, v64
  v_mul_f32 v41, v81, v41
  v_mul_f32 v57, v81, v57
  v_fma_f32 v64, v15, v66, v41
  v_fma_f32 v65, v15, v67, v57
  v_fmac_f32 v64, v17, v67
  v_fmac_f32 v65, v16, v66
  v_mul_f32 v42, v82, v42
  v_mul_f32 v58, v82, v58
  v_fma_f32 v66, v15, v64, v42
  v_fma_f32 v67, v15, v65, v58
  v_fmac_f32 v66, v17, v65
  v_fmac_f32 v67, v16, v64
  v_mul_f32 v43, v83, v43
  s_add_u32 m0, s71, 45056
  s_add_u32 s87, s87, 0x4000
  buffer_load_dwordx4 v144, s[32:35], s87 offen lds
  v_mul_f32 v59, v83, v59
  v_fma_f32 v64, v15, v66, v43
  v_fma_f32 v65, v15, v67, v59
  v_fmac_f32 v64, v17, v67
  v_fmac_f32 v65, v16, v66
  s_waitcnt lgkmcnt(1)
  v_mul_f32 v44, v84, v44
  v_mul_f32 v60, v84, v60
  v_fma_f32 v66, v15, v64, v44
  v_fma_f32 v67, v15, v65, v60
  v_fmac_f32 v66, v17, v65
  v_fmac_f32 v67, v16, v64
  v_mul_f32 v45, v85, v45
  v_mul_f32 v61, v85, v61
  v_fma_f32 v64, v15, v66, v45
  v_fma_f32 v65, v15, v67, v61
  v_fmac_f32 v64, v17, v67
  v_fmac_f32 v65, v16, v66
  v_mul_f32 v46, v86, v46
  v_mul_f32 v62, v86, v62
  v_fma_f32 v66, v15, v64, v46
  v_fma_f32 v67, v15, v65, v62
  v_fmac_f32 v66, v17, v65
  v_fmac_f32 v67, v16, v64
  v_mul_f32 v47, v87, v47
  v_mul_f32 v63, v87, v63
  v_fma_f32 v64, v15, v66, v47
  v_fma_f32 v65, v15, v67, v63
  v_fmac_f32 v64, v17, v67
  v_fmac_f32 v65, v16, v66
  ds_write_b64 v170, v[64:65]
  ds_write_b8 v21, v122 offset:20
  ds_read_b32 v68, v20 offset:20
  s_waitcnt lgkmcnt(0)
  v_readfirstlane_b32 s14, v68
  s_nop 0
  s_cmp_eq_u32 s14, 0x01010101
  s_cbranch_scc1 L_bk161
L_in160:
  s_sub_u32 s13, s13, 1
  s_cbranch_scc1 L_sl162
  ds_read_b32 v68, v20 offset:20
  s_waitcnt lgkmcnt(0)
  v_readfirstlane_b32 s14, v68
  s_nop 1
  s_cmp_eq_u32 s14, 0x01010101
  s_cbranch_scc0 L_in160
L_bk161:
  ds_read_b128 v[72:75], v147 offset:0
  ds_read_b128 v[76:79], v147 offset:16
  ds_read_b128 v[80:83], v147 offset:32
  ds_read_b128 v[84:87], v147 offset:48
  s_waitcnt lgkmcnt(3)
  v_fmac_f32 v74, v25, v72
  v_fmac_f32 v75, v25, v73
  v_fmac_f32 v74, v27, v73
  v_fmac_f32 v75, v26, v72
  s_waitcnt lgkmcnt(2)
  v_fmac_f32 v76, v25, v74
  v_fmac_f32 v77, v25, v75
  v_fmac_f32 v76, v27, v75
  v_fmac_f32 v77, v26, v74
  v_fmac_f32 v78, v25, v76
  v_fmac_f32 v79, v25, v77
  v_fmac_f32 v78, v27, v77
  v_fmac_f32 v79, v26, v76
  s_waitcnt lgkmcnt(1)
  v_fmac_f32 v80, v25, v78
  v_fmac_f32 v81, v25, v79
  v_fmac_f32 v80, v27, v79
  v_fmac_f32 v81, v26, v78
  v_fmac_f32 v82, v25, v80
  v_fmac_f32 v83, v25, v81
  v_fmac_f32 v82, v27, v81
  v_fmac_f32 v83, v26, v80
  s_waitcnt lgkmcnt(0)
  v_fmac_f32 v84, v25, v82
  v_fmac_f32 v85, v25, v83
  v_fmac_f32 v84, v27, v83
  v_fmac_f32 v85, v26, v82
  v_fma_f32 v88, v25, v84, v86
  v_fma_f32 v90, v25, v85, v87
  v_fmac_f32 v88, v27, v85
  v_fmac_f32 v90, v26, v84
  buffer_store_dwordx4 v[88:91], v171, s[28:31], s88 offen sc1
  s_setprio 0
  v_cmp_gt_u32 vcc, 32, v0
  s_cmp_eq_u32 s4, 0
  s_cbranch_scc0 L_gn164
  v_mov_b32 v92, 0
  v_cndmask_b32 v120, v72, v92, vcc
  v_cndmask_b32 v121, v73, v92, vcc
  s_branch L_ge163
L_gn164:
  s_cmp_eq_u32 s4, 1
  s_cbranch_scc0 L_gn165
  v_cndmask_b32 v120, v76, v74, vcc
  v_cndmask_b32 v121, v77, v75, vcc
  s_branch L_ge163
L_gn165:
  s_cmp_eq_u32 s4, 2
  s_cbranch_scc0 L_gn166
  v_cndmask_b32 v120, v80, v78, vcc
  v_cndmask_b32 v121, v81, v79, vcc
  s_branch L_ge163
L_gn166:
  v_cndmask_b32 v120, v84, v82, vcc
  v_cndmask_b32 v121, v85, v83, vcc
L_ge163:
  v_mul_f32 v92, v31, v48
  s_add_u32 m0, s71, 49152
  s_xor_b32 s87, s9, 2
  s_lshl_b32 s87, s87, 17
  s_add_u32 s87, s87, s70
  s_add_u32 s87, s87, 0x8000
  buffer_load_dwordx4 v144, s[32:35], s87 offen lds
  v_mul_f32 v93, v31, v32
  v_fma_f32 v32, v30, v32, -v92
  v_lshlrev_b32 v224, 2, v0
  s_lshl_b32 s14, s4, 12
  s_add_u32 s14, s14, 140288
  s_lshl_b32 s86, s9, 8
  s_lshl_b32 s15, s8, 6
  s_add_u32 s86, s86, s15
  s_mov_b32 m0, s14
  v_lshrrev_b32 v225, 2, v0
  buffer_load_dword v224, s[60:63], s86 offen lds
  v_and_b32 v224, 0x30, v1
  v_lshl_add_u32 v225, v225, 10, v224
  s_lshl_b32 s15, s5, 2
  s_add_u32 s15, s15, s4
  s_lshl_b32 s15, s15, 15
  s_add_u32 s86, s86, s15
  s_add_u32 m0, s14, 1024
  s_nop 0
  buffer_load_dwordx4 v225, s[16:19], s86 offen lds
  s_add_u32 m0, s14, 2048
  s_add_u32 s86, s86, 16384
  buffer_load_dwordx4 v225, s[16:19], s86 offen lds
  v_fma_f32 v48, v30, v48, v93
  v_mul_f32 v94, v31, v49
  v_mul_f32 v95, v31, v33
  v_fma_f32 v33, v30, v33, -v94
  s_add_u32 m0, s71, 53248
  s_add_u32 s87, s87, 0x4000
  buffer_load_dwordx4 v144, s[32:35], s87 offen lds
  v_fma_f32 v49, v30, v49, v95
  v_mul_f32 v92, v31, v50
  v_mul_f32 v93, v31, v34
  v_fma_f32 v34, v30, v34, -v92
  v_fma_f32 v50, v30, v50, v93
  v_mul_f32 v94, v31, v51
  s_add_u32 m0, s71, 57344
  s_xor_b32 s87, s9, 3
  s_lshl_b32 s87, s87, 17
  s_add_u32 s87, s87, s70
  s_add_u32 s87, s87, 0x8000
  buffer_load_dwordx4 v144, s[32:35], s87 offen lds
  v_mul_f32 v95, v31, v35
  v_fma_f32 v35, v30, v35, -v94
  v_fma_f32 v51, v30, v51, v95
  v_mul_f32 v92, v31, v52
  v_mul_f32 v93, v31, v36
  v_fma_f32 v36, v30, v36, -v92
  s_add_u32 m0, s71, 61440
  s_add_u32 s87, s87, 0x4000
  buffer_load_dwordx4 v144, s[32:35], s87 offen lds
  v_fma_f32 v52, v30, v52, v93
  v_mul_f32 v94, v31, v53
  s_waitcnt vmcnt(14)
  ds_write_b8 v21, v122 offset:0
  v_mul_f32 v95, v31, v37
  v_fma_f32 v37, v30, v37, -v94
  v_fma_f32 v53, v30, v53, v95
  v_mul_f32 v92, v31, v54
  v_mul_f32 v93, v31, v38
  v_fma_f32 v38, v30, v38, -v92
  v_fma_f32 v54, v30, v54, v93
  v_mul_f32 v94, v31, v55
  v_mul_f32 v95, v31, v39
  v_fma_f32 v39, v30, v39, -v94
  v_fma_f32 v55, v30, v55, v95
  v_mul_f32 v92, v31, v56
  v_mul_f32 v93, v31, v40
  v_fma_f32 v40, v30, v40, -v92
  v_fma_f32 v56, v30, v56, v93
  v_mul_f32 v94, v31, v57
  v_mul_f32 v95, v31, v41
  v_fma_f32 v41, v30, v41, -v94
  v_fma_f32 v57, v30, v57, v95
  v_mul_f32 v92, v31, v58
  v_mul_f32 v93, v31, v42
  v_fma_f32 v42, v30, v42, -v92
  v_fma_f32 v58, v30, v58, v93
  v_mul_f32 v94, v31, v59
  v_mul_f32 v95, v31, v43
  v_fma_f32 v43, v30, v43, -v94
  v_fma_f32 v59, v30, v59, v95
  v_mul_f32 v92, v31, v60
  v_mul_f32 v93, v31, v44
  v_fma_f32 v44, v30, v44, -v92
  v_lshrrev_b32 v224, 5, v0
  s_lshl_b32 s14, s4, 12
  s_add_u32 s14, s14, 140288
  v_lshl_add_u32 v224, v224, 3, s14
  v_lshl_add_u32 v225, v24, 6, v224
  s_waitcnt vmcnt(3)
  ds_read_b64 v[208:209], v224 offset:0
  ds_read_b64 v[210:211], v224 offset:16
  ds_read_b64 v[212:213], v224 offset:32
  ds_read_b64 v[214:215], v224 offset:48
  ds_read_b64 v[216:217], v225 offset:1024
  ds_read_b64 v[218:219], v225 offset:1040
  ds_read_b64 v[220:221], v225 offset:1056
  ds_read_b64 v[222:223], v225 offset:1072
  v_fma_f32 v60, v30, v60, v93
  v_mul_f32 v94, v31, v61
  v_mul_f32 v95, v31, v45
  v_fma_f32 v45, v30, v45, -v94
  v_fma_f32 v61, v30, v61, v95
  v_mul_f32 v92, v31, v62
  v_mul_f32 v93, v31, v46
  v_fma_f32 v46, v30, v46, -v92
  v_fma_f32 v62, v30, v62, v93
  v_mul_f32 v94, v31, v63
  buffer_load_dwordx4 v[96:99], v160, s[28:31], s89 offen sc1
  buffer_load_dwordx4 v[100:103], v161, s[28:31], s89 offen sc1
  v_mul_f32 v95, v31, v47
  v_fma_f32 v47, v30, v47, -v94
  v_fma_f32 v63, v30, v63, v95
  v_mul_f32 v92, v22, v23
  s_waitcnt lgkmcnt(3)
  v_lshlrev_b32 v184, 16, v216
  v_lshlrev_b32 v88, 16, v208
  v_fma_f32 v89, v184, v23, v92
  v_fmac_f32 v184, v88, v89
  v_and_b32 v185, 0xffff0000, v216
  v_and_b32 v90, 0xffff0000, v208
  v_fma_f32 v91, v185, v23, v92
  v_fmac_f32 v185, v90, v91
  v_lshlrev_b32 v186, 16, v217
  v_lshlrev_b32 v88, 16, v209
  v_fma_f32 v89, v186, v23, v92
  v_fmac_f32 v186, v88, v89
  v_and_b32 v187, 0xffff0000, v217
  v_and_b32 v90, 0xffff0000, v209
  v_fma_f32 v91, v187, v23, v92
  v_fmac_f32 v187, v90, v91
  s_waitcnt lgkmcnt(2)
  v_lshlrev_b32 v188, 16, v218
  v_lshlrev_b32 v88, 16, v210
  v_fma_f32 v89, v188, v23, v92
  v_fmac_f32 v188, v88, v89
  v_and_b32 v189, 0xffff0000, v218
  v_and_b32 v90, 0xffff0000, v210
  v_fma_f32 v91, v189, v23, v92
  v_fmac_f32 v189, v90, v91
  v_lshlrev_b32 v190, 16, v219
  v_lshlrev_b32 v88, 16, v211
  v_fma_f32 v89, v190, v23, v92
  v_fmac_f32 v190, v88, v89
  v_and_b32 v191, 0xffff0000, v219
  v_and_b32 v90, 0xffff0000, v211
  v_fma_f32 v91, v191, v23, v92
  v_fmac_f32 v191, v90, v91
  s_waitcnt lgkmcnt(1)
  v_lshlrev_b32 v10, 16, v220
  v_lshlrev_b32 v88, 16, v212
  v_fma_f32 v89, v10, v23, v92
  v_fmac_f32 v10, v88, v89
  v_and_b32 v11, 0xffff0000, v220
  v_and_b32 v90, 0xffff0000, v212
  v_fma_f32 v91, v11, v23, v92
  v_fmac_f32 v11, v90, v91
  v_lshlrev_b32 v12, 16, v221
  v_lshlrev_b32 v88, 16, v213
  v_fma_f32 v89, v12, v23, v92
  v_fmac_f32 v12, v88, v89
  v_and_b32 v13, 0xffff0000, v221
  v_and_b32 v90, 0xffff0000, v213
  v_fma_f32 v91, v13, v23, v92
  v_fmac_f32 v13, v90, v91
  s_waitcnt lgkmcnt(0)
  v_lshlrev_b32 v124, 16, v222
  v_lshlrev_b32 v88, 16, v214
  v_fma_f32 v89, v124, v23, v92
  v_fmac_f32 v124, v88, v89
  v_and_b32 v125, 0xffff0000, v222
  v_and_b32 v90, 0xffff0000, v214
  v_fma_f32 v91, v125, v23, v92
  v_fmac_f32 v125, v90, v91
  v_lshlrev_b32 v2, 16, v223
  v_lshlrev_b32 v88, 16, v215
  v_fma_f32 v89, v2, v23, v92
  v_fmac_f32 v2, v88, v89
  v_and_b32 v3, 0xffff0000, v223
  v_and_b32 v90, 0xffff0000, v215
  v_fma_f32 v91, v3, v23, v92
  v_fmac_f32 v3, v90, v91
  v_lshlrev_b32 v164, 1, v164
  v_bfe_u32 v165, v0, 4, 1
  v_mul_u32_u24 v165, 16352, v165
  v_sub_u32 v164, v164, v165
  v_add_u32 v165, 0x4000, v164
  v_mov_b32 v23, 0xbf317218
  s_lshl_b32 s14, s5, 2
  s_add_u32 s14, s14, s9
  s_lshl_b32 s14, s14, 2
  s_xor_b32 s15, s8, 0
  s_add_u32 s14, s14, s15
  s_lshl_b32 s14, s14, 2
  s_add_u32 s14, s14, s4
  s_mul_i32 s14, s14, 2176
  s_add_u32 s48, s14, 0x100000
  v_xor_b32 v8, 0x1000, v172
  v_xor_b32 v9, 0x1000, v173
  ds_read_b32 v123, v20 offset:16
  s_waitcnt vmcnt(1)
  v_cmp_ne_u32 vcc, v162, v97
  v_cmp_ne_u32 s[98:99], v162, v99
  s_nop 0
  s_or_b64 vcc, vcc, s[98:99]
  s_waitcnt vmcnt(0)
  v_cmp_ne_u32 s[98:99], v163, v101
  s_nop 0
  s_or_b64 vcc, vcc, s[98:99]
  v_cmp_ne_u32 s[98:99], v163, v103
  s_nop 0
  s_or_b64 vcc, vcc, s[98:99]
  s_cbranch_vccz L_bk169
L_in168:
  s_sub_u32 s13, s13, 1
  s_cbranch_scc1 L_sl170
  buffer_load_dwordx4 v[96:99], v160, s[28:31], s89 offen sc1
  buffer_load_dwordx4 v[100:103], v161, s[28:31], s89 offen sc1
  s_waitcnt vmcnt(0)
  v_cmp_ne_u32 vcc, v162, v97
  s_nop 1
  v_cmp_ne_u32 s[98:99], v162, v99
  s_nop 1
  s_or_b64 vcc, vcc, s[98:99]
  v_cmp_ne_u32 s[98:99], v163, v101
  s_nop 1
  s_or_b64 vcc, vcc, s[98:99]
  v_cmp_ne_u32 s[98:99], v163, v103
  s_nop 1
  s_or_b64 vcc, vcc, s[98:99]
  s_cbranch_vccnz L_in168
L_bk169:
  s_setprio 1
  ds_write_b8 v21, v122 offset:24
  v_mul_f32 v72, v116, v96
  v_mul_f32 v73, v116, v98
  v_fma_f32 v72, -v117, v98, v72
  v_fmac_f32 v73, v117, v96
  v_fmac_f32 v72, v118, v100
  v_fmac_f32 v73, v118, v102
  v_fma_f32 v72, -v119, v102, v72
  v_fmac_f32 v73, v119, v100
  v_mov_b32 v74, v72
  v_mov_b32 v75, v73
  s_nop 0
  v_permlane32_swap_b32 v72, v74
  v_permlane32_swap_b32 v73, v75
  v_add_f32 v72, v72, v74
  v_add_f32 v73, v73, v75
  ds_write_b64 v149, v[72:73]
  ds_write_b8 v21, v122 offset:8
  ds_read_b64 v[74:75], v20 offset:8
  s_waitcnt lgkmcnt(4)
  v_readfirstlane_b32 s14, v123
  s_lshr_b32 s15, s8, 1
  s_lshl_b32 s15, s15, 4
  s_lshr_b32 s14, s14, s15
  s_and_b32 s14, s14, 0xffff
  s_cmp_eq_u32 s14, 0x101
  s_cbranch_scc0 L_Yslow
  s_waitcnt lgkmcnt(0)
  v_readfirstlane_b32 s14, v74
  v_readfirstlane_b32 s15, v75
  s_nop 0
  s_and_b32 s14, s14, s15
  s_cmp_eq_u32 s14, 0x01010101
  s_cbranch_scc1 L_bk175
L_in174:
  s_sub_u32 s13, s13, 1
  s_cbranch_scc1 L_sl176
  ds_read_b64 v[74:75], v20 offset:8
  s_waitcnt lgkmcnt(0)
  v_readfirstlane_b32 s14, v74
  s_nop 1
  v_readfirstlane_b32 s15, v75
  s_nop 1
  s_and_b32 s14, s14, s15
  s_cmp_eq_u32 s14, 0x01010101
  s_cbranch_scc0 L_in174
L_bk175:
  ds_read_b128 v[72:75], v148
  ds_read_b128 v[76:79], v148 offset:16
  ds_read_b32 v5, v20 offset:28
  s_waitcnt lgkmcnt(2)
  v_add_f32 v72, v72, v74
  v_add_f32 v73, v73, v75
  s_waitcnt lgkmcnt(1)
  v_add_f32 v76, v76, v78
  v_add_f32 v77, v77, v79
  v_add_f32 v72, v72, v76
  v_add_f32 v73, v73, v77
  v_fmac_f32 v120, v28, v72
  s_waitcnt lgkmcnt(0)
  v_readfirstlane_b32 s14, v5
  s_nop 0
  s_cmp_eq_u32 s14, 0x01010101
  s_cbranch_scc1 L_bk172
L_in171:
  s_sub_u32 s13, s13, 1
  s_cbranch_scc1 L_sl173
  ds_read_b32 v5, v20 offset:28
  s_waitcnt lgkmcnt(0)
  v_readfirstlane_b32 s14, v5
  s_nop 1
  s_cmp_eq_u32 s14, 0x01010101
  s_cbranch_scc0 L_in171
L_bk172:
  s_add_u32 m0, s71, 98304
  s_xor_b32 s86, s9, 1
  s_lshl_b32 s87, s86, 17
  s_add_u32 s87, s87, 0x10000
  s_lshl_b32 s74, s86, 15
  s_add_u32 s74, s74, 0x40000
  s_cmp_ge_u32 s86, 2
  s_cselect_b32 s87, s74, s87
  s_add_u32 s87, s87, s70
  buffer_load_dwordx4 v144, s[32:35], s87 offen lds
  v_fmac_f32 v121, v28, v73
  v_fma_f32 v120, -v29, v73, v120
  v_fmac_f32 v121, v29, v72
  v_mul_f32 v72, v30, v120
  v_mul_f32 v73, v30, v121
  v_fma_f32 v72, -v31, v121, v72
  v_fmac_f32 v73, v31, v120
  s_add_u32 m0, s71, 102400
  s_add_u32 s87, s87, 0x4000
  buffer_load_dwordx4 v144, s[32:35], s87 offen lds
  v_fmac_f32 v32, v15, v72
  v_fmac_f32 v48, v15, v73
  v_fmac_f32 v32, v17, v73
  v_fmac_f32 v48, v16, v72
  v_fmac_f32 v33, v15, v32
  v_fmac_f32 v49, v15, v48
  v_fmac_f32 v33, v17, v48
  v_fmac_f32 v49, v16, v32
  s_add_u32 m0, s71, 106496
  s_xor_b32 s86, s9, 2
  s_lshl_b32 s87, s86, 17
  s_add_u32 s87, s87, 0x10000
  s_lshl_b32 s74, s86, 15
  s_add_u32 s74, s74, 0x40000
  s_cmp_ge_u32 s86, 2
  s_cselect_b32 s87, s74, s87
  s_add_u32 s87, s87, s70
  buffer_load_dwordx4 v144, s[32:35], s87 offen lds
  v_cvt_pk_bf16_f32 v128, v32, v33
  v_cvt_pk_bf16_f32 v136, -v48, -v49
  v_fmac_f32 v34, v15, v33
  v_fmac_f32 v50, v15, v49
  v_fmac_f32 v34, v17, v49
  v_fmac_f32 v50, v16, v33
  v_fmac_f32 v35, v15, v34
  v_fmac_f32 v51, v15, v50
  s_add_u32 m0, s71, 110592
  s_add_u32 s87, s87, 0x4000
  buffer_load_dwordx4 v144, s[32:35], s87 offen lds
  v_fmac_f32 v35, v17, v50
  v_fmac_f32 v51, v16, v34
  v_cvt_pk_bf16_f32 v129, v34, v35
  v_cvt_pk_bf16_f32 v137, -v50, -v51
  v_fmac_f32 v36, v15, v35
  v_fmac_f32 v52, v15, v51
  v_fmac_f32 v36, v17, v51
  v_fmac_f32 v52, v16, v35
  s_add_u32 m0, s71, 114688
  s_xor_b32 s86, s9, 3
  s_lshl_b32 s87, s86, 17
  s_add_u32 s87, s87, 0x10000
  s_lshl_b32 s74, s86, 15
  s_add_u32 s74, s74, 0x40000
  s_cmp_ge_u32 s86, 2
  s_cselect_b32 s87, s74, s87
  s_add_u32 s87, s87, s70
  buffer_load_dwordx4 v144, s[32:35], s87 offen lds
  v_fmac_f32 v37, v15, v36
  v_fmac_f32 v53, v15, v52
  v_fmac_f32 v37, v17, v52
  v_fmac_f32 v53, v16, v36
  v_cvt_pk_bf16_f32 v130, v36, v37
  v_cvt_pk_bf16_f32 v138, -v52, -v53
  v_fmac_f32 v38, v15, v37
  s_add_u32 m0, s71, 118784
  s_add_u32 s87, s87, 0x4000
  buffer_load_dwordx4 v144, s[32:35], s87 offen lds
  v_fmac_f32 v54, v15, v53
  v_fmac_f32 v38, v17, v53
  v_fmac_f32 v54, v16, v37
  v_fmac_f32 v39, v15, v38
  v_fmac_f32 v55, v15, v54
  v_fmac_f32 v39, v17, v54
  v_fmac_f32 v55, v16, v38
  v_cvt_pk_bf16_f32 v131, v38, v39
  s_add_u32 m0, s71, 122880
  s_add_u32 s87, s70, 0x18000
  buffer_load_dwordx4 v144, s[32:35], s87 offen lds
  v_cvt_pk_bf16_f32 v139, -v54, -v55
  ds_write_b128 v150, v[128:131]
  ds_write_b128 v150, v[136:139] offset:2048
  v_fmac_f32 v40, v15, v39
  v_fmac_f32 v56, v15, v55
  v_fmac_f32 v40, v17, v55
  v_fmac_f32 v56, v16, v39
  v_fmac_f32 v41, v15, v40
  s_add_u32 m0, s71, 126976
  s_add_u32 s87, s70, 0x1c000
  buffer_load_dwordx4 v144, s[32:35], s87 offen lds
  v_fmac_f32 v57, v15, v56
  v_fmac_f32 v41, v17, v56
  v_fmac_f32 v57, v16, v40
  v_cvt_pk_bf16_f32 v132, v40, v41
  v_cvt_pk_bf16_f32 v140, -v56, -v57
  v_fmac_f32 v42, v15, v41
  v_fmac_f32 v58, v15, v57
  v_fmac_f32 v42, v17, v57
  v_fmac_f32 v58, v16, v41
  v_fmac_f32 v43, v15, v42
  v_fmac_f32 v59, v15, v58
  v_fmac_f32 v43, v17, v58
  v_fmac_f32 v59, v16, v42
  v_cvt_pk_bf16_f32 v133, v42, v43
  v_cvt_pk_bf16_f32 v141, -v58, -v59
  v_fmac_f32 v44, v15, v43
  v_fmac_f32 v60, v15, v59
  v_fmac_f32 v44, v17, v59
  v_fmac_f32 v60, v16, v43
  v_fmac_f32 v45, v15, v44
  v_fmac_f32 v61, v15, v60
  v_fmac_f32 v45, v17, v60
  v_fmac_f32 v61, v16, v44
  v_cvt_pk_bf16_f32 v134, v44, v45
  v_cvt_pk_bf16_f32 v142, -v60, -v61
  v_fmac_f32 v46, v15, v45
  v_fmac_f32 v62, v15, v61
  v_fmac_f32 v46, v17, v61
  buffer_load_dword v157, v156, s[28:31], s83 offen sc1
  v_fmac_f32 v62, v16, v45
  v_fmac_f32 v47, v15, v46
  v_fmac_f32 v63, v15, v62
  v_fmac_f32 v47, v17, v62
  v_fmac_f32 v63, v16, v46
  v_cvt_pk_bf16_f32 v135, v46, v47
  v_cvt_pk_bf16_f32 v143, -v62, -v63
  ds_read_b32 v126, v20 offset:32
  ds_write_b128 v151, v[132:135]
  ds_write_b128 v151, v[140:143] offset:2048
  ds_read_b64_tr_b16 v[104:105], v152 offset:0
  ds_read_b64_tr_b16 v[106:107], v153 offset:0
  ds_read_b64_tr_b16 v[108:109], v152 offset:1024
  ds_read_b64_tr_b16 v[110:111], v153 offset:1024
  ds_read_b64_tr_b16 v[112:113], v152 offset:2048
  ds_read_b64_tr_b16 v[114:115], v153 offset:2048
  ds_read_b64_tr_b16 v[116:117], v152 offset:3072
  ds_read_b64_tr_b16 v[118:119], v153 offset:3072
  ds_write_b8 v21, v122 offset:60
  s_xor_b32 s95, s56, 128
  s_xor_b32 s51, s83, 512
  s_waitcnt lgkmcnt(11)
  v_readfirstlane_b32 s14, v126
  s_nop 0
  s_cmp_eq_u32 s14, 0x01010101
  s_cbranch_scc1 L_bk181
L_in180:
  s_sub_u32 s13, s13, 1
  s_cbranch_scc1 L_sl182
  ds_read_b32 v126, v20 offset:32
  s_waitcnt lgkmcnt(0)
  v_readfirstlane_b32 s14, v126
  s_nop 1
  s_cmp_eq_u32 s14, 0x01010101
  s_cbranch_scc0 L_in180
L_bk181:
  s_add_u32 m0, s76, 65536
  s_add_u32 s87, s91, 0
  buffer_load_dwordx4 v154, s[36:39], s87 offen lds
  s_add_u32 m0, s76, 66560
  s_add_u32 s87, s91, 0
  buffer_load_dwordx4 v155, s[36:39], s87 offen lds
  s_add_u32 m0, s76, 67584
  s_add_u32 s87, s91, 16384
  buffer_load_dwordx4 v154, s[36:39], s87 offen lds
  s_add_u32 m0, s76, 68608
  s_add_u32 s87, s91, 16384
  buffer_load_dwordx4 v155, s[36:39], s87 offen lds
  s_add_u32 m0, s76, 81920
  s_add_u32 s87, s91, 0
  buffer_load_dwordx4 v154, s[40:43], s87 offen lds
  s_add_u32 m0, s76, 82944
  s_add_u32 s87, s91, 0
  buffer_load_dwordx4 v155, s[40:43], s87 offen lds
  s_add_u32 m0, s76, 83968
  s_add_u32 s87, s91, 16384
  buffer_load_dwordx4 v154, s[40:43], s87 offen lds
  s_add_u32 m0, s76, 84992
  s_add_u32 s87, s91, 16384
  buffer_load_dwordx4 v155, s[40:43], s87 offen lds
  s_waitcnt vmcnt(8)
  v_cmp_eq_u32 vcc, s12, v157
  s_lshl_b32 s15, s85, 20
  s_and_b32 s14, vcc_lo, s15
  s_cmp_eq_u32 s14, s15
  s_cbranch_scc1 L_bk178
L_in177:
  s_sub_u32 s13, s13, 1
  s_cbranch_scc1 L_sl179
  buffer_load_dword v157, v156, s[28:31], s83 offen sc1
  s_waitcnt vmcnt(0)
  v_cmp_eq_u32 vcc, s12, v157
  s_nop 1
  s_lshl_b32 s15, s85, 20
  s_and_b32 s14, vcc_lo, s15
  s_cmp_eq_u32 s14, s15
  s_cbranch_scc0 L_in177
L_bk178:
  ds_write_b8 v21, v122 offset:44
  s_waitcnt lgkmcnt(8)
  buffer_store_dwordx4 v[104:107], v158, s[44:47], s56 offen offset:0
  s_waitcnt lgkmcnt(6)
  buffer_store_dwordx4 v[108:111], v158, s[44:47], s56 offen offset:2048
  s_waitcnt lgkmcnt(4)
  buffer_store_dwordx4 v[112:115], v159, s[44:47], s56 offen offset:0
  s_waitcnt lgkmcnt(2)
  buffer_store_dwordx4 v[116:119], v159, s[44:47], s56 offen offset:2048
  ds_read_b32 v5, v20 offset:36
  s_waitcnt vmcnt(0)
  buffer_store_dword v18, v19, s[28:31], s84 offen offset:64
  ds_write_b8 v21, v122 offset:52
  ds_read_b32 v4, v20 offset:52
  s_waitcnt lgkmcnt(2)
  v_readfirstlane_b32 s14, v5
  s_nop 0
  s_cmp_eq_u32 s14, 0x01010101
  s_cbranch_scc1 L_bk184
L_in183:
  s_sub_u32 s13, s13, 1
  s_cbranch_scc1 L_sl185
  ds_read_b32 v5, v20 offset:36
  s_waitcnt lgkmcnt(0)
  v_readfirstlane_b32 s14, v5
  s_nop 1
  s_cmp_eq_u32 s14, 0x01010101
  s_cbranch_scc0 L_in183
L_bk184:
  s_add_u32 m0, s71, 131072
  s_add_u32 s87, s70, 0x38000
  buffer_load_dwordx4 v144, s[32:35], s87 offen lds
  s_add_u32 m0, s71, 135168
  s_add_u32 s87, s70, 0x3c000
  buffer_load_dwordx4 v144, s[32:35], s87 offen lds
  s_waitcnt lgkmcnt(0)
  v_readfirstlane_b32 s14, v4
  s_nop 0
  s_cmp_eq_u32 s14, 0x01010101
  s_cbranch_scc1 L_bk187
L_in186:
  s_sub_u32 s13, s13, 1
  s_cbranch_scc1 L_sl188
  ds_read_b32 v4, v20 offset:52
  s_waitcnt lgkmcnt(0)
  v_readfirstlane_b32 s14, v4
  s_nop 1
  s_cmp_eq_u32 s14, 0x01010101
  s_cbranch_scc0 L_in186
L_bk187:
  ds_read_b128 v[80:83], v172 offset:0
  ds_read_b128 v[84:87], v8 offset:0
  ds_read_b128 v[88:91], v174 offset:0
  ds_read_b128 v[92:95], v176 offset:0
  ds_read_b128 v[96:99], v172 offset:16384
  s_waitcnt lgkmcnt(4)
  v_mfma_f32_32x32x16_bf16 v[192:207], v[80:83], v[104:107], 0
  ds_read_b128 v[100:103], v8 offset:16384
  s_add_u32 m0, s76, 0
  s_add_u32 s87, s92, 0
  buffer_load_dwordx4 v154, s[36:39], s87 offen lds
  s_add_u32 m0, s76, 1024
  s_add_u32 s87, s92, 0
  buffer_load_dwordx4 v155, s[36:39], s87 offen lds
  s_waitcnt lgkmcnt(4)
  v_mfma_f32_32x32x16_bf16 v[208:223], v[84:87], v[104:107], 0
  ds_read_b128 v[80:83], v174 offset:16384
  s_add_u32 m0, s76, 2048
  s_add_u32 s87, s92, 16384
  buffer_load_dwordx4 v154, s[36:39], s87 offen lds
  s_add_u32 m0, s76, 3072
  s_add_u32 s87, s92, 16384
  buffer_load_dwordx4 v155, s[36:39], s87 offen lds
  s_waitcnt lgkmcnt(4)
  v_mfma_f32_32x32x16_bf16 v[224:239], v[88:91], v[104:107], 0
  ds_read_b128 v[84:87], v176 offset:16384
  s_add_u32 m0, s76, 16384
  s_add_u32 s87, s92, 0
  buffer_load_dwordx4 v154, s[40:43], s87 offen lds
  s_add_u32 m0, s76, 17408
  s_add_u32 s87, s92, 0
  buffer_load_dwordx4 v155, s[40:43], s87 offen lds
  s_waitcnt lgkmcnt(4)
  v_mfma_f32_32x32x16_bf16 v[240:255], v[92:95], v[104:107], 0
  ds_read_b128 v[88:91], v173 offset:0
  s_add_u32 m0, s76, 18432
  s_add_u32 s87, s92, 16384
  buffer_load_dwordx4 v154, s[40:43], s87 offen lds
  s_add_u32 m0, s76, 19456
  s_add_u32 s87, s92, 16384
  buffer_load_dwordx4 v155, s[40:43], s87 offen lds
  s_waitcnt lgkmcnt(4)
  v_mfma_f32_32x32x16_bf16 v[192:207], v[96:99], v[112:115], v[192:207]
  ds_read_b128 v[92:95], v9 offset:0
  buffer_load_dword v157, v156, s[28:31], s83 offen sc1
  s_waitcnt lgkmcnt(4)
  v_mfma_f32_32x32x16_bf16 v[208:223], v[100:103], v[112:115], v[208:223]
  ds_read_b128 v[96:99], v175 offset:0
  s_waitcnt lgkmcnt(4)
  v_mfma_f32_32x32x16_bf16 v[224:239], v[80:83], v[112:115], v[224:239]
  ds_read_b128 v[100:103], v177 offset:0
  s_waitcnt vmcnt(9)
  ds_write_b8 v21, v122 offset:48
  s_waitcnt lgkmcnt(5)
  v_mfma_f32_32x32x16_bf16 v[240:255], v[84:87], v[112:115], v[240:255]
  ds_read_b128 v[80:83], v173 offset:16384
  s_waitcnt lgkmcnt(5)
  v_mfma_f32_32x32x16_bf16 v[192:207], v[88:91], v[108:111], v[192:207]
  ds_read_b128 v[84:87], v9 offset:16384
  s_waitcnt lgkmcnt(5)
  v_mfma_f32_32x32x16_bf16 v[208:223], v[92:95], v[108:111], v[208:223]
  ds_read_b128 v[88:91], v175 offset:16384
  s_waitcnt lgkmcnt(5)
  v_mfma_f32_32x32x16_bf16 v[224:239], v[96:99], v[108:111], v[224:239]
  ds_read_b128 v[92:95], v177 offset:16384
  s_waitcnt vmcnt(0)
  v_cmp_eq_u32 vcc, s12, v157
  s_lshl_b32 s15, s85, 16
  s_and_b32 s14, vcc_lo, s15
  s_cmp_eq_u32 s14, s15
  s_cbranch_scc1 L_bk196
L_in195:
  s_sub_u32 s13, s13, 1
  s_cbranch_scc1 L_sl197
  buffer_load_dword v157, v156, s[28:31], s83 offen sc1
  s_waitcnt vmcnt(0)
  v_cmp_eq_u32 vcc, s12, v157
  s_nop 1
  s_lshl_b32 s15, s85, 16
  s_and_b32 s14, vcc_lo, s15
  s_cmp_eq_u32 s14, s15
  s_cbranch_scc0 L_in195
L_bk196:
  ds_write_b8 v21, v122 offset:56
  buffer_load_dwordx4 v[32:35], v158, s[44:47], s57 offen offset:0 sc1
  buffer_load_dwordx4 v[36:39], v158, s[44:47], s57 offen offset:2048 sc1
  buffer_load_dwordx4 v[48:51], v158, s[44:47], s58 offen offset:0 sc1
  buffer_load_dwordx4 v[52:55], v158, s[44:47], s58 offen offset:2048 sc1
  buffer_load_dwordx4 v[64:67], v158, s[44:47], s59 offen offset:0 sc1
  buffer_load_dwordx4 v[68:71], v158, s[44:47], s59 offen offset:2048 sc1
  buffer_load_dwordx4 v[40:43], v159, s[44:47], s57 offen offset:0 sc1
  buffer_load_dwordx4 v[44:47], v159, s[44:47], s57 offen offset:2048 sc1
  buffer_load_dwordx4 v[56:59], v159, s[44:47], s58 offen offset:0 sc1
  buffer_load_dwordx4 v[60:63], v159, s[44:47], s58 offen offset:2048 sc1
  buffer_load_dwordx4 v[72:75], v159, s[44:47], s59 offen offset:0 sc1
  buffer_load_dwordx4 v[76:79], v159, s[44:47], s59 offen offset:2048 sc1
  ds_read_b32 v4, v20 offset:56
  s_waitcnt lgkmcnt(7)
  v_mfma_f32_32x32x16_bf16 v[240:255], v[100:103], v[108:111], v[240:255]
  ds_read_b128 v[96:99], v178 offset:0
  s_waitcnt lgkmcnt(6)
  v_mfma_f32_32x32x16_bf16 v[192:207], v[80:83], v[116:119], v[192:207]
  ds_read_b128 v[100:103], v179 offset:0
  s_waitcnt lgkmcnt(6)
  v_mfma_f32_32x32x16_bf16 v[208:223], v[84:87], v[116:119], v[208:223]
  s_waitcnt lgkmcnt(2)
  v_readfirstlane_b32 s14, v4
  s_nop 0
  s_cmp_eq_u32 s14, 0x01010101
  s_cbranch_scc1 L_bk193
L_in192:
  s_sub_u32 s13, s13, 1
  s_cbranch_scc1 L_sl194
  ds_read_b32 v4, v20 offset:56
  s_waitcnt lgkmcnt(0)
  v_readfirstlane_b32 s14, v4
  s_nop 1
  s_cmp_eq_u32 s14, 0x01010101
  s_cbranch_scc0 L_in192
L_bk193:
  ds_read_b128 v[80:83], v180 offset:0
  v_mfma_f32_32x32x16_bf16 v[224:239], v[88:91], v[116:119], v[224:239]
  ds_read_b128 v[84:87], v181 offset:0
  v_mfma_f32_32x32x16_bf16 v[240:255], v[92:95], v[116:119], v[240:255]
  ds_read_b128 v[88:91], v182 offset:0
  s_waitcnt vmcnt(11) lgkmcnt(4)
  v_mfma_f32_32x32x16_bf16 v[192:207], v[96:99], v[32:35], v[192:207]
  ds_read_b128 v[92:95], v183 offset:0
  s_waitcnt vmcnt(10) lgkmcnt(4)
  v_mfma_f32_32x32x16_bf16 v[192:207], v[100:103], v[36:39], v[192:207]
  ds_read_b128 v[96:99], v178 offset:16384
  s_waitcnt vmcnt(9) lgkmcnt(4)
  v_mfma_f32_32x32x16_bf16 v[192:207], v[80:83], v[48:51], v[192:207]
  ds_read_b128 v[100:103], v179 offset:16384
  s_waitcnt vmcnt(8) lgkmcnt(4)
  v_mfma_f32_32x32x16_bf16 v[192:207], v[84:87], v[52:55], v[192:207]
  ds_read_b128 v[80:83], v180 offset:16384
  s_waitcnt vmcnt(7) lgkmcnt(4)
  v_mfma_f32_32x32x16_bf16 v[192:207], v[88:91], v[64:67], v[192:207]
  ds_read_b128 v[84:87], v181 offset:16384
  s_waitcnt vmcnt(6) lgkmcnt(4)
  v_mfma_f32_32x32x16_bf16 v[192:207], v[92:95], v[68:71], v[192:207]
  ds_read_b128 v[88:91], v182 offset:16384
  s_waitcnt vmcnt(5) lgkmcnt(4)
  v_mfma_f32_32x32x16_bf16 v[192:207], v[96:99], v[40:43], v[192:207]
  ds_read_b128 v[92:95], v183 offset:16384
  ds_read_b32 v5, v20 offset:68
  s_waitcnt vmcnt(4) lgkmcnt(5)
  v_mfma_f32_32x32x16_bf16 v[192:207], v[100:103], v[44:47], v[192:207]
  v_xor_b32 v178, 0x1000, v178
  ds_read_b128 v[96:99], v178 offset:0
  s_waitcnt vmcnt(3) lgkmcnt(5)
  v_mfma_f32_32x32x16_bf16 v[192:207], v[80:83], v[56:59], v[192:207]
  v_xor_b32 v179, 0x1000, v179
  ds_read_b128 v[100:103], v179 offset:0
  s_waitcnt vmcnt(0)
  buffer_store_dword v18, v19, s[28:31], s84 offen offset:96
  s_waitcnt lgkmcnt(5)
  v_mfma_f32_32x32x16_bf16 v[192:207], v[84:87], v[60:63], v[192:207]
  v_xor_b32 v180, 0x1000, v180
  ds_read_b128 v[80:83], v180 offset:0
  s_waitcnt lgkmcnt(3)
  v_readfirstlane_b32 s14, v5
  s_nop 0
  s_bitcmp1_b32 s14, s101
  s_cbranch_scc1 L_bk202
L_in201:
  s_sub_u32 s13, s13, 1
  s_cbranch_scc1 L_sl203
  ds_read_b32 v5, v20 offset:68
  s_waitcnt lgkmcnt(0)
  v_readfirstlane_b32 s14, v5
  s_nop 1
  s_bitcmp1_b32 s14, s101
  s_cbranch_scc0 L_in201
L_bk202:
  ds_read_b128 v[128:131], v166 offset:32768
  ds_read_b128 v[132:135], v166 offset:33792
  ds_read_b128 v[136:139], v166 offset:34816
  ds_read_b128 v[140:143], v166 offset:35840
  ds_write_b8 v21, v122 offset:64
  v_mfma_f32_32x32x16_bf16 v[192:207], v[88:91], v[72:75], v[192:207]
  v_xor_b32 v181, 0x1000, v181
  ds_read_b128 v[84:87], v181 offset:0
  v_mfma_f32_32x32x16_bf16 v[192:207], v[92:95], v[76:79], v[192:207]
  v_xor_b32 v182, 0x1000, v182
  ds_read_b128 v[88:91], v182 offset:0
  s_waitcnt lgkmcnt(9)
  v_mfma_f32_32x32x16_bf16 v[208:223], v[96:99], v[32:35], v[208:223]
  v_xor_b32 v183, 0x1000, v183
  ds_read_b128 v[92:95], v183 offset:0
  s_waitcnt lgkmcnt(9)
  v_mfma_f32_32x32x16_bf16 v[208:223], v[100:103], v[36:39], v[208:223]
  ds_read_b128 v[96:99], v178 offset:16384
  s_waitcnt lgkmcnt(8)
  s_nop 1
  v_add_f32 v128, v128, v192
  v_add_f32 v129, v129, v193
  v_cvt_pk_bf16_f32 v104, v128, v129
  v_add_f32 v130, v130, v194
  v_add_f32 v131, v131, v195
  v_cvt_pk_bf16_f32 v105, v130, v131
  v_mfma_f32_32x32x16_bf16 v[208:223], v[80:83], v[48:51], v[208:223]
  ds_read_b128 v[100:103], v179 offset:16384
  s_waitcnt lgkmcnt(8)
  v_add_f32 v132, v132, v196
  v_add_f32 v133, v133, v197
  v_cvt_pk_bf16_f32 v106, v132, v133
  v_add_f32 v134, v134, v198
  v_add_f32 v135, v135, v199
  v_cvt_pk_bf16_f32 v107, v134, v135
  s_waitcnt lgkmcnt(4)
  v_mfma_f32_32x32x16_bf16 v[208:223], v[84:87], v[52:55], v[208:223]
  ds_read_b128 v[80:83], v180 offset:16384
  v_add_f32 v136, v136, v200
  v_add_f32 v137, v137, v201
  v_cvt_pk_bf16_f32 v108, v136, v137
  v_add_f32 v138, v138, v202
  v_add_f32 v139, v139, v203
  s_waitcnt lgkmcnt(4)
  v_mfma_f32_32x32x16_bf16 v[208:223], v[88:91], v[64:67], v[208:223]
  ds_read_b128 v[84:87], v181 offset:16384
  buffer_load_dword v157, v156, s[28:31], s51 offen sc1
  v_cvt_pk_bf16_f32 v109, v138, v139
  v_add_f32 v140, v140, v204
  v_add_f32 v141, v141, v205
  v_cvt_pk_bf16_f32 v110, v140, v141
  v_add_f32 v142, v142, v206
  v_add_f32 v143, v143, v207
  s_waitcnt lgkmcnt(4)
  v_mfma_f32_32x32x16_bf16 v[208:223], v[92:95], v[68:71], v[208:223]
  ds_read_b128 v[88:91], v182 offset:16384
  v_cvt_pk_bf16_f32 v111, v142, v143
  v_add3_u32 v112, v104, v105, v106
  v_add3_u32 v113, v107, v108, v109
  v_add3_u32 v112, v112, v110, v111
  v_add_u32 v112, v112, v113
  s_nop 1
  v_add_u32_dpp v112, v112, v112 quad_perm:[1,0,3,2] row_mask:0xf bank_mask:0xf
  s_waitcnt lgkmcnt(4)
  v_mfma_f32_32x32x16_bf16 v[208:223], v[96:99], v[40:43], v[208:223]
  ds_read_b128 v[92:95], v183 offset:16384
  ds_read_b32 v5, v20 offset:72
  v_add_u32_dpp v112, v112, v112 quad_perm:[2,3,0,1] row_mask:0xf bank_mask:0xf
  s_nop 1
  v_add_u32_dpp v112, v112, v112 row_half_mirror row_mask:0xf bank_mask:0xf
  s_nop 1
  v_add_u32_dpp v112, v112, v112 row_mirror row_mask:0xf bank_mask:0xf
  s_nop 1
  v_add_u32_dpp v112, v112, v112 row_bcast:15 row_mask:0xa bank_mask:0xf
  s_nop 1
  v_add_u32_dpp v112, v112, v112 row_bcast:31 row_mask:0xc bank_mask:0xf
  s_waitcnt lgkmcnt(5)
  v_mfma_f32_32x32x16_bf16 v[208:223], v[100:103], v[44:47], v[208:223]
  v_xor_b32 v178, 0x3000, v178
  ds_read_b128 v[96:99], v178 offset:0
  s_waitcnt lgkmcnt(5)
  v_mfma_f32_32x32x16_bf16 v[208:223], v[80:83], v[56:59], v[208:223]
  v_xor_b32 v179, 0x3000, v179
  ds_read_b128 v[100:103], v179 offset:0
  s_waitcnt lgkmcnt(5)
  v_mfma_f32_32x32x16_bf16 v[208:223], v[84:87], v[60:63], v[208:223]
  v_xor_b32 v180, 0x3000, v180
  ds_read_b128 v[80:83], v180 offset:0
  s_waitcnt lgkmcnt(3)
  v_readfirstlane_b32 s14, v5
  s_nop 0
  s_bitcmp1_b32 s14, s101
  s_cbranch_scc1 L_bk205
L_in204:
  s_sub_u32 s13, s13, 1
  s_cbranch_scc1 L_sl206
  ds_read_b32 v5, v20 offset:72
  s_waitcnt lgkmcnt(0)
  v_readfirstlane_b32 s14, v5
  s_nop 1
  s_bitcmp1_b32 s14, s101
  s_cbranch_scc0 L_in204
L_bk205:
  ds_read_b128 v[128:131], v166 offset:49152
  ds_read_b128 v[132:135], v166 offset:50176
  ds_read_b128 v[136:139], v166 offset:51200
  ds_read_b128 v[140:143], v166 offset:52224
  v_mfma_f32_32x32x16_bf16 v[208:223], v[88:91], v[72:75], v[208:223]
  v_xor_b32 v181, 0x3000, v181
  ds_read_b128 v[84:87], v181 offset:0
  s_waitcnt vmcnt(0)
  v_cmp_eq_u32 vcc, s12, v157
  s_lshl_b32 s15, s85, 24
  s_and_b32 s14, vcc_lo, s15
  s_cmp_eq_u32 s14, s15
  s_cbranch_scc1 L_bk199
L_in198:
  s_sub_u32 s13, s13, 1
  s_cbranch_scc1 L_sl200
  buffer_load_dword v157, v156, s[28:31], s51 offen sc1
  s_waitcnt vmcnt(0)
  v_cmp_eq_u32 vcc, s12, v157
  s_nop 1
  s_lshl_b32 s15, s85, 24
  s_and_b32 s14, vcc_lo, s15
  s_cmp_eq_u32 s14, s15
  s_cbranch_scc0 L_in198
L_bk199:
  v_mfma_f32_32x32x16_bf16 v[208:223], v[92:95], v[76:79], v[208:223]
  v_xor_b32 v182, 0x3000, v182
  ds_read_b128 v[88:91], v182 offset:0
  buffer_store_dwordx4 v[104:107], v158, s[44:47], s95 offen offset:0
  buffer_store_dwordx4 v[108:111], v158, s[44:47], s95 offen offset:2048
  v_readlane_b32 s14, v112, 63
  s_nop 0
  s_add_u32 s14, s14, s12
  s_add_u32 s14, s14, 0x3c6ef372
  v_mov_b32 v112, s14
  buffer_store_dword v112, v19, s[28:31], s94 offen offset:112
  s_waitcnt lgkmcnt(8)
  v_mfma_f32_32x32x16_bf16 v[224:239], v[96:99], v[32:35], v[224:239]
  v_xor_b32 v183, 0x3000, v183
  ds_read_b128 v[92:95], v183 offset:0
  s_waitcnt lgkmcnt(8)
  v_mfma_f32_32x32x16_bf16 v[224:239], v[100:103], v[36:39], v[224:239]
  ds_read_b128 v[96:99], v178 offset:16384
  s_waitcnt lgkmcnt(7)
  v_add_f32 v208, v208, v128
  v_add_f32 v209, v209, v129
  v_add_f32 v210, v210, v130
  v_add_f32 v211, v211, v131
  v_mfma_f32_32x32x16_bf16 v[224:239], v[80:83], v[48:51], v[224:239]
  ds_read_b128 v[100:103], v179 offset:16384
  s_waitcnt lgkmcnt(7)
  v_add_f32 v212, v212, v132
  v_add_f32 v213, v213, v133
  v_add_f32 v214, v214, v134
  v_add_f32 v215, v215, v135
  s_waitcnt lgkmcnt(4)
  v_mfma_f32_32x32x16_bf16 v[224:239], v[84:87], v[52:55], v[224:239]
  ds_read_b128 v[80:83], v180 offset:16384
  v_add_f32 v216, v216, v136
  v_add_f32 v217, v217, v137
  v_add_f32 v218, v218, v138
  v_add_f32 v219, v219, v139
  s_waitcnt lgkmcnt(4)
  v_mfma_f32_32x32x16_bf16 v[224:239], v[88:91], v[64:67], v[224:239]
  ds_read_b128 v[84:87], v181 offset:16384
  v_add_f32 v220, v220, v140
  v_add_f32 v221, v221, v141
  v_add_f32 v222, v222, v142
  v_add_f32 v223, v223, v143
  s_waitcnt lgkmcnt(4)
  v_mfma_f32_32x32x16_bf16 v[224:239], v[92:95], v[68:71], v[224:239]
  ds_read_b128 v[88:91], v182 offset:16384
  s_waitcnt lgkmcnt(4)
  v_mfma_f32_32x32x16_bf16 v[224:239], v[96:99], v[40:43], v[224:239]
  ds_read_b128 v[92:95], v183 offset:16384
  ds_read_b32 v5, v20 offset:76
  s_waitcnt lgkmcnt(5)
  v_mfma_f32_32x32x16_bf16 v[224:239], v[100:103], v[44:47], v[224:239]
  v_xor_b32 v178, 0x1000, v178
  ds_read_b128 v[96:99], v178 offset:0
  s_waitcnt lgkmcnt(5)
  v_mfma_f32_32x32x16_bf16 v[224:239], v[80:83], v[56:59], v[224:239]
  v_xor_b32 v179, 0x1000, v179
  ds_read_b128 v[100:103], v179 offset:0
  s_waitcnt lgkmcnt(5)
  v_mfma_f32_32x32x16_bf16 v[224:239], v[84:87], v[60:63], v[224:239]
  v_xor_b32 v180, 0x1000, v180
  ds_read_b128 v[80:83], v180 offset:0
  s_waitcnt lgkmcnt(3)
  v_readfirstlane_b32 s14, v5
  s_nop 0
  s_bitcmp1_b32 s14, s101
  s_cbranch_scc1 L_bk208
L_in207:
  s_sub_u32 s13, s13, 1
  s_cbranch_scc1 L_sl209
  ds_read_b32 v5, v20 offset:76
  s_waitcnt lgkmcnt(0)
  v_readfirstlane_b32 s14, v5
  s_nop 1
  s_bitcmp1_b32 s14, s101
  s_cbranch_scc0 L_in207
L_bk208:
  ds_read_b128 v[128:131], v167 offset:0
  ds_read_b128 v[132:135], v167 offset:1024
  ds_read_b128 v[136:139], v167 offset:2048
  ds_read_b128 v[140:143], v167 offset:3072
  v_mfma_f32_32x32x16_bf16 v[224:239], v[88:91], v[72:75], v[224:239]
  v_xor_b32 v181, 0x1000, v181
  ds_read_b128 v[84:87], v181 offset:0
  buffer_load_dwordx4 v[144:147], v158, s[44:47], s56 offen offset:0 sc1
  buffer_load_dwordx4 v[148:151], v158, s[44:47], s56 offen offset:2048 sc1
  buffer_load_dword v152, v19, s[28:31], s84 offen offset:112 sc1
  v_mfma_f32_32x32x16_bf16 v[224:239], v[92:95], v[76:79], v[224:239]
  v_xor_b32 v182, 0x1000, v182
  ds_read_b128 v[88:91], v182 offset:0
  s_waitcnt lgkmcnt(8)
  v_mfma_f32_32x32x16_bf16 v[240:255], v[96:99], v[32:35], v[240:255]
  v_xor_b32 v183, 0x1000, v183
  ds_read_b128 v[92:95], v183 offset:0
  s_waitcnt lgkmcnt(8)
  v_mfma_f32_32x32x16_bf16 v[240:255], v[100:103], v[36:39], v[240:255]
  ds_read_b128 v[96:99], v178 offset:16384
  s_waitcnt lgkmcnt(7)
  s_nop 1
  v_add_f32 v128, v128, v224
  v_add_f32 v129, v129, v225
  v_cvt_pk_bf16_f32 v104, v128, v129
  v_add_f32 v130, v130, v226
  v_add_f32 v131, v131, v227
  v_cvt_pk_bf16_f32 v105, v130, v131
  s_waitcnt lgkmcnt(6)
  v_add_f32 v132, v132, v228
  v_mfma_f32_32x32x16_bf16 v[240:255], v[80:83], v[48:51], v[240:255]
  ds_read_b128 v[100:103], v179 offset:16384
  v_add_f32 v133, v133, v229
  v_cvt_pk_bf16_f32 v106, v132, v133
  v_add_f32 v134, v134, v230
  v_add_f32 v135, v135, v231
  v_cvt_pk_bf16_f32 v107, v134, v135
  s_waitcnt lgkmcnt(6)
  v_add_f32 v136, v136, v232
  s_waitcnt lgkmcnt(4)
  v_mfma_f32_32x32x16_bf16 v[240:255], v[84:87], v[52:55], v[240:255]
  ds_read_b128 v[80:83], v180 offset:16384
  v_add_f32 v137, v137, v233
  v_cvt_pk_bf16_f32 v108, v136, v137
  v_add_f32 v138, v138, v234
  v_add_f32 v139, v139, v235
  v_cvt_pk_bf16_f32 v109, v138, v139
  v_add_f32 v140, v140, v236
  s_waitcnt lgkmcnt(4)
  v_mfma_f32_32x32x16_bf16 v[240:255], v[88:91], v[64:67], v[240:255]
  ds_read_b128 v[84:87], v181 offset:16384
  v_add_f32 v141, v141, v237
  v_cvt_pk_bf16_f32 v110, v140, v141
  v_add_f32 v142, v142, v238
  v_add_f32 v143, v143, v239
  v_cvt_pk_bf16_f32 v111, v142, v143
  v_add3_u32 v112, v104, v105, v106
  v_add3_u32 v113, v107, v108, v109
  s_waitcnt lgkmcnt(4)
  v_mfma_f32_32x32x16_bf16 v[240:255], v[92:95], v[68:71], v[240:255]
  ds_read_b128 v[88:91], v182 offset:16384
  v_add3_u32 v112, v112, v110, v111
  v_add_u32 v112, v112, v113
  s_nop 1
  v_add_u32_dpp v112, v112, v112 quad_perm:[1,0,3,2] row_mask:0xf bank_mask:0xf
  s_nop 1
  v_add_u32_dpp v112, v112, v112 quad_perm:[2,3,0,1] row_mask:0xf bank_mask:0xf
  s_nop 1
  v_add_u32_dpp v112, v112, v112 row_half_mirror row_mask:0xf bank_mask:0xf
  s_nop 1
  v_add_u32_dpp v112, v112, v112 row_mirror row_mask:0xf bank_mask:0xf
  s_waitcnt lgkmcnt(4)
  v_mfma_f32_32x32x16_bf16 v[240:255], v[96:99], v[40:43], v[240:255]
  ds_read_b128 v[92:95], v183 offset:16384
  ds_read_b32 v5, v20 offset:80
  v_add_u32_dpp v112, v112, v112 row_bcast:15 row_mask:0xa bank_mask:0xf
  s_nop 1
  v_add_u32_dpp v112, v112, v112 row_bcast:31 row_mask:0xc bank_mask:0xf
  buffer_store_dwordx4 v[104:107], v159, s[44:47], s95 offen offset:0
  buffer_store_dwordx4 v[108:111], v159, s[44:47], s95 offen offset:2048
  v_readlane_b32 s14, v112, 63
  s_nop 0
  s_add_u32 s14, s14, s12
  s_add_u32 s14, s14, 0x7f4a1d35
  v_mov_b32 v112, s14
  buffer_store_dword v112, v19, s[28:31], s94 offen offset:0
  s_waitcnt lgkmcnt(5)
  v_mfma_f32_32x32x16_bf16 v[240:255], v[100:103], v[44:47], v[240:255]
  s_waitcnt lgkmcnt(4)
  v_mfma_f32_32x32x16_bf16 v[240:255], v[80:83], v[56:59], v[240:255]
  s_waitcnt vmcnt(5)
  v_add3_u32 v114, v144, v145, v146
  s_waitcnt vmcnt(4)
  v_add3_u32 v115, v147, v148, v149
  v_add3_u32 v114, v114, v150, v151
  v_add_u32 v114, v114, v115
  s_nop 1
  v_add_u32_dpp v114, v114, v114 quad_perm:[1,0,3,2] row_mask:0xf bank_mask:0xf
  s_nop 1
  v_add_u32_dpp v114, v114, v114 quad_perm:[2,3,0,1] row_mask:0xf bank_mask:0xf
  s_nop 1
  v_add_u32_dpp v114, v114, v114 row_half_mirror row_mask:0xf bank_mask:0xf
  s_nop 1
  v_add_u32_dpp v114, v114, v114 row_mirror row_mask:0xf bank_mask:0xf
  s_nop 1
  v_add_u32_dpp v114, v114, v114 row_bcast:15 row_mask:0xa bank_mask:0xf
  s_nop 1
  v_add_u32_dpp v114, v114, v114 row_bcast:31 row_mask:0xc bank_mask:0xf
  s_nop 0
  v_readlane_b32 s14, v114, 63
  s_waitcnt vmcnt(3)
  v_readfirstlane_b32 s15, v152
  s_nop 0
  s_sub_u32 s15, s15, s14
  s_sub_u32 s15, s15, s12
  s_cmp_eq_u32 s15, 0x3c6ef372
  s_cbranch_scc1 L_bk214
L_in213:
  s_sub_u32 s13, s13, 1
  s_cbranch_scc1 L_sl215
  buffer_load_dwordx4 v[144:147], v158, s[44:47], s56 offen offset:0 sc1
  buffer_load_dwordx4 v[148:151], v158, s[44:47], s56 offen offset:2048 sc1
  buffer_load_dword v152, v19, s[28:31], s84 offen offset:112 sc1
  s_waitcnt vmcnt(0)
  v_add3_u32 v114, v144, v145, v146
  s_nop 1
  v_add3_u32 v115, v147, v148, v149
  s_nop 1
  v_add3_u32 v114, v114, v150, v151
  s_nop 1
  v_add_u32 v114, v114, v115
  s_nop 1
  v_add_u32_dpp v114, v114, v114 quad_perm:[1,0,3,2] row_mask:0xf bank_mask:0xf
  s_nop 1
  v_add_u32_dpp v114, v114, v114 quad_perm:[2,3,0,1] row_mask:0xf bank_mask:0xf
  s_nop 1
  v_add_u32_dpp v114, v114, v114 row_half_mirror row_mask:0xf bank_mask:0xf
  s_nop 1
  v_add_u32_dpp v114, v114, v114 row_mirror row_mask:0xf bank_mask:0xf
  s_nop 1
  v_add_u32_dpp v114, v114, v114 row_bcast:15 row_mask:0xa bank_mask:0xf
  s_nop 1
  v_add_u32_dpp v114, v114, v114 row_bcast:31 row_mask:0xc bank_mask:0xf
  s_nop 1
  v_readlane_b32 s14, v114, 63
  s_nop 1
  v_readfirstlane_b32 s15, v152
  s_nop 1
  s_sub_u32 s15, s15, s14
  s_sub_u32 s15, s15, s12
  s_cmp_eq_u32 s15, 0x3c6ef372
  s_cbranch_scc0 L_in213
L_bk214:
  v_lshlrev_b32 v114, 16, v144
  v_and_b32 v144, 0xffff0000, v144
  v_add_f32 v208, v208, v114
  v_add_f32 v209, v209, v144
  v_lshlrev_b32 v114, 16, v145
  v_and_b32 v145, 0xffff0000, v145
  v_add_f32 v210, v210, v114
  v_add_f32 v211, v211, v145
  v_lshlrev_b32 v114, 16, v146
  v_and_b32 v146, 0xffff0000, v146
  v_add_f32 v212, v212, v114
  v_add_f32 v213, v213, v146
  v_lshlrev_b32 v114, 16, v147
  v_and_b32 v147, 0xffff0000, v147
  v_add_f32 v214, v214, v114
  v_add_f32 v215, v215, v147
  v_lshlrev_b32 v114, 16, v148
  v_and_b32 v148, 0xffff0000, v148
  v_add_f32 v216, v216, v114
  v_add_f32 v217, v217, v148
  v_lshlrev_b32 v114, 16, v149
  v_and_b32 v149, 0xffff0000, v149
  v_add_f32 v218, v218, v114
  v_add_f32 v219, v219, v149
  v_lshlrev_b32 v114, 16, v150
  v_and_b32 v150, 0xffff0000, v150
  v_add_f32 v220, v220, v114
  v_add_f32 v221, v221, v150
  v_lshlrev_b32 v114, 16, v151
  v_and_b32 v151, 0xffff0000, v151
  v_add_f32 v222, v222, v114
  v_add_f32 v223, v223, v151
  v_cvt_pk_bf16_f32 v32, v208, v209
  v_cvt_pk_bf16_f32 v33, v210, v211
  v_cvt_pk_bf16_f32 v34, v212, v213
  v_cvt_pk_bf16_f32 v35, v214, v215
  v_cvt_pk_bf16_f32 v36, v216, v217
  v_cvt_pk_bf16_f32 v37, v218, v219
  v_cvt_pk_bf16_f32 v38, v220, v221
  v_cvt_pk_bf16_f32 v39, v222, v223
  buffer_store_dwordx4 v[32:35], v1, s[28:31], s93 offen offset:0 sc1
  buffer_store_dwordx4 v[36:39], v1, s[28:31], s93 offen offset:1024 sc1
  v_add3_u32 v114, v32, v33, v34
  v_add3_u32 v115, v35, v36, v37
  v_add3_u32 v114, v114, v38, v39
  v_add_u32 v114, v114, v115
  s_nop 1
  v_add_u32_dpp v114, v114, v114 quad_perm:[1,0,3,2] row_mask:0xf bank_mask:0xf
  s_nop 1
  v_add_u32_dpp v114, v114, v114 quad_perm:[2,3,0,1] row_mask:0xf bank_mask:0xf
  s_nop 1
  v_add_u32_dpp v114, v114, v114 row_half_mirror row_mask:0xf bank_mask:0xf
  s_nop 1
  v_add_u32_dpp v114, v114, v114 row_mirror row_mask:0xf bank_mask:0xf
  s_nop 1
  v_add_u32_dpp v114, v114, v114 row_bcast:15 row_mask:0xa bank_mask:0xf
  s_nop 1
  v_add_u32_dpp v114, v114, v114 row_bcast:31 row_mask:0xc bank_mask:0xf
  s_nop 0
  v_readlane_b32 s14, v114, 63
  s_nop 0
  s_add_u32 s14, s14, s12
  s_add_u32 s14, s14, 0x1b873593
  v_mov_b32 v114, s14
  buffer_store_dword v114, v19, s[28:31], s93 offen offset:2048 sc1
  s_waitcnt lgkmcnt(3)
  v_mfma_f32_32x32x16_bf16 v[240:255], v[84:87], v[60:63], v[240:255]
  s_waitcnt lgkmcnt(0)
  v_readfirstlane_b32 s14, v5
  s_nop 0
  s_bitcmp1_b32 s14, s101
  s_cbranch_scc1 L_bk211
L_in210:
  s_sub_u32 s13, s13, 1
  s_cbranch_scc1 L_sl212
  ds_read_b32 v5, v20 offset:80
  s_waitcnt lgkmcnt(0)
  v_readfirstlane_b32 s14, v5
  s_nop 1
  s_bitcmp1_b32 s14, s101
  s_cbranch_scc0 L_in210
L_bk211:
  ds_read_b128 v[128:131], v166 offset:32768
  ds_read_b128 v[132:135], v166 offset:33792
  ds_read_b128 v[136:139], v166 offset:34816
  ds_read_b128 v[140:143], v166 offset:35840
  v_mfma_f32_32x32x16_bf16 v[240:255], v[88:91], v[72:75], v[240:255]
  v_mfma_f32_32x32x16_bf16 v[240:255], v[92:95], v[76:79], v[240:255]
  buffer_load_dwordx4 v[48:51], v159, s[44:47], s56 offen offset:0 sc1
  buffer_load_dwordx4 v[52:55], v159, s[44:47], s56 offen offset:2048 sc1
  buffer_load_dword v56, v19, s[28:31], s84 offen offset:0 sc1
  buffer_load_dwordx4 v[64:67], v1, s[28:31], s48 offen offset:0 sc1
  buffer_load_dwordx4 v[68:71], v1, s[28:31], s48 offen offset:1024 sc1
  buffer_load_dword v72, v19, s[28:31], s48 offen offset:2048 sc1
  s_waitcnt lgkmcnt(3)
  s_nop 4
  v_add_f32 v240, v240, v128
  v_add_f32 v241, v241, v129
  v_add_f32 v242, v242, v130
  v_add_f32 v243, v243, v131
  s_waitcnt lgkmcnt(2)
  v_add_f32 v244, v244, v132
  v_add_f32 v245, v245, v133
  v_add_f32 v246, v246, v134
  v_add_f32 v247, v247, v135
  s_waitcnt lgkmcnt(1)
  v_add_f32 v248, v248, v136
  v_add_f32 v249, v249, v137
  v_add_f32 v250, v250, v138
  v_add_f32 v251, v251, v139
  s_waitcnt lgkmcnt(0)
  v_add_f32 v252, v252, v140
  v_add_f32 v253, v253, v141
  v_add_f32 v254, v254, v142
  v_add_f32 v255, v255, v143
  v_fma_f32 v240, v240, v23, v184
  v_fma_f32 v241, v241, v23, v185
  v_fma_f32 v242, v242, v23, v186
  v_fma_f32 v243, v243, v23, v187
  v_fma_f32 v244, v244, v23, v188
  v_fma_f32 v245, v245, v23, v189
  v_fma_f32 v246, v246, v23, v190
  v_fma_f32 v247, v247, v23, v191
  v_fma_f32 v248, v248, v23, v10
  v_fma_f32 v249, v249, v23, v11
  v_fma_f32 v250, v250, v23, v12
  v_fma_f32 v251, v251, v23, v13
  v_fma_f32 v252, v252, v23, v124
  v_fma_f32 v253, v253, v23, v125
  v_fma_f32 v254, v254, v23, v2
  v_fma_f32 v255, v255, v23, v3
  s_waitcnt vmcnt(5)
  v_add3_u32 v112, v48, v49, v50
  s_waitcnt vmcnt(4)
  v_add3_u32 v113, v51, v52, v53
  v_add3_u32 v112, v112, v54, v55
  v_add_u32 v112, v112, v113
  s_nop 1
  v_add_u32_dpp v112, v112, v112 quad_perm:[1,0,3,2] row_mask:0xf bank_mask:0xf
  s_nop 1
  v_add_u32_dpp v112, v112, v112 quad_perm:[2,3,0,1] row_mask:0xf bank_mask:0xf
  s_nop 1
  v_add_u32_dpp v112, v112, v112 row_half_mirror row_mask:0xf bank_mask:0xf
  s_nop 1
  v_add_u32_dpp v112, v112, v112 row_mirror row_mask:0xf bank_mask:0xf
  s_nop 1
  v_add_u32_dpp v112, v112, v112 row_bcast:15 row_mask:0xa bank_mask:0xf
  s_nop 1
  v_add_u32_dpp v112, v112, v112 row_bcast:31 row_mask:0xc bank_mask:0xf
  s_nop 0
  v_readlane_b32 s14, v112, 63
  s_waitcnt vmcnt(3)
  v_readfirstlane_b32 s15, v56
  s_nop 0
  s_sub_u32 s15, s15, s14
  s_sub_u32 s15, s15, s12
  s_cmp_eq_u32 s15, 0x7f4a1d35
  s_cbranch_scc1 L_bk217
L_in216:
  s_sub_u32 s13, s13, 1
  s_cbranch_scc1 L_sl218
  buffer_load_dwordx4 v[48:51], v159, s[44:47], s56 offen offset:0 sc1
  buffer_load_dwordx4 v[52:55], v159, s[44:47], s56 offen offset:2048 sc1
  buffer_load_dword v56, v19, s[28:31], s84 offen offset:0 sc1
  s_waitcnt vmcnt(0)
  v_add3_u32 v112, v48, v49, v50
  s_nop 1
  v_add3_u32 v113, v51, v52, v53
  s_nop 1
  v_add3_u32 v112, v112, v54, v55
  s_nop 1
  v_add_u32 v112, v112, v113
  s_nop 1
  v_add_u32_dpp v112, v112, v112 quad_perm:[1,0,3,2] row_mask:0xf bank_mask:0xf
  s_nop 1
  v_add_u32_dpp v112, v112, v112 quad_perm:[2,3,0,1] row_mask:0xf bank_mask:0xf
  s_nop 1
  v_add_u32_dpp v112, v112, v112 row_half_mirror row_mask:0xf bank_mask:0xf
  s_nop 1
  v_add_u32_dpp v112, v112, v112 row_mirror row_mask:0xf bank_mask:0xf
  s_nop 1
  v_add_u32_dpp v112, v112, v112 row_bcast:15 row_mask:0xa bank_mask:0xf
  s_nop 1
  v_add_u32_dpp v112, v112, v112 row_bcast:31 row_mask:0xc bank_mask:0xf
  s_nop 1
  v_readlane_b32 s14, v112, 63
  s_nop 1
  v_readfirstlane_b32 s15, v56
  s_nop 1
  s_sub_u32 s15, s15, s14
  s_sub_u32 s15, s15, s12
  s_cmp_eq_u32 s15, 0x7f4a1d35
  s_cbranch_scc0 L_in216
L_bk217:
  v_lshlrev_b32 v128, 16, v48
  v_and_b32 v48, 0xffff0000, v48
  v_fmac_f32 v240, v23, v128
  v_fmac_f32 v241, v23, v48
  v_lshlrev_b32 v128, 16, v49
  v_and_b32 v49, 0xffff0000, v49
  v_fmac_f32 v242, v23, v128
  v_fmac_f32 v243, v23, v49
  v_lshlrev_b32 v128, 16, v50
  v_and_b32 v50, 0xffff0000, v50
  v_fmac_f32 v244, v23, v128
  v_fmac_f32 v245, v23, v50
  v_lshlrev_b32 v128, 16, v51
  v_and_b32 v51, 0xffff0000, v51
  v_fmac_f32 v246, v23, v128
  v_fmac_f32 v247, v23, v51
  v_lshlrev_b32 v128, 16, v52
  v_and_b32 v52, 0xffff0000, v52
  v_fmac_f32 v248, v23, v128
  v_fmac_f32 v249, v23, v52
  v_lshlrev_b32 v128, 16, v53
  v_and_b32 v53, 0xffff0000, v53
  v_fmac_f32 v250, v23, v128
  v_fmac_f32 v251, v23, v53
  v_lshlrev_b32 v128, 16, v54
  v_and_b32 v54, 0xffff0000, v54
  v_fmac_f32 v252, v23, v128
  v_fmac_f32 v253, v23, v54
  v_lshlrev_b32 v128, 16, v55
  v_and_b32 v55, 0xffff0000, v55
  v_fmac_f32 v254, v23, v128
  v_fmac_f32 v255, v23, v55
  s_waitcnt vmcnt(2)
  v_add3_u32 v112, v64, v65, v66
  s_waitcnt vmcnt(1)
  v_add3_u32 v113, v67, v68, v69
  v_add3_u32 v112, v112, v70, v71
  v_add_u32 v112, v112, v113
  s_nop 1
  v_add_u32_dpp v112, v112, v112 quad_perm:[1,0,3,2] row_mask:0xf bank_mask:0xf
  s_nop 1
  v_add_u32_dpp v112, v112, v112 quad_perm:[2,3,0,1] row_mask:0xf bank_mask:0xf
  s_nop 1
  v_add_u32_dpp v112, v112, v112 row_half_mirror row_mask:0xf bank_mask:0xf
  s_nop 1
  v_add_u32_dpp v112, v112, v112 row_mirror row_mask:0xf bank_mask:0xf
  s_nop 1
  v_add_u32_dpp v112, v112, v112 row_bcast:15 row_mask:0xa bank_mask:0xf
  s_nop 1
  v_add_u32_dpp v112, v112, v112 row_bcast:31 row_mask:0xc bank_mask:0xf
  s_nop 0
  v_readlane_b32 s14, v112, 63
  s_waitcnt vmcnt(0)
  v_readfirstlane_b32 s15, v72
  s_nop 0
  s_sub_u32 s15, s15, s14
  s_sub_u32 s15, s15, s12
  s_cmp_eq_u32 s15, 0x1b873593
  s_cbranch_scc1 L_bk220
L_in219:
  s_sub_u32 s13, s13, 1
  s_cbranch_scc1 L_sl221
  buffer_load_dwordx4 v[64:67], v1, s[28:31], s48 offen offset:0 sc1
  buffer_load_dwordx4 v[68:71], v1, s[28:31], s48 offen offset:1024 sc1
  buffer_load_dword v72, v19, s[28:31], s48 offen offset:2048 sc1
  s_waitcnt vmcnt(0)
  v_add3_u32 v112, v64, v65, v66
  s_nop 1
  v_add3_u32 v113, v67, v68, v69
  s_nop 1
  v_add3_u32 v112, v112, v70, v71
  s_nop 1
  v_add_u32 v112, v112, v113
  s_nop 1
  v_add_u32_dpp v112, v112, v112 quad_perm:[1,0,3,2] row_mask:0xf bank_mask:0xf
  s_nop 1
  v_add_u32_dpp v112, v112, v112 quad_perm:[2,3,0,1] row_mask:0xf bank_mask:0xf
  s_nop 1
  v_add_u32_dpp v112, v112, v112 row_half_mirror row_mask:0xf bank_mask:0xf
  s_nop 1
  v_add_u32_dpp v112, v112, v112 row_mirror row_mask:0xf bank_mask:0xf
  s_nop 1
  v_add_u32_dpp v112, v112, v112 row_bcast:15 row_mask:0xa bank_mask:0xf
  s_nop 1
  v_add_u32_dpp v112, v112, v112 row_bcast:31 row_mask:0xc bank_mask:0xf
  s_nop 1
  v_readlane_b32 s14, v112, 63
  s_nop 1
  v_readfirstlane_b32 s15, v72
  s_nop 1
  s_sub_u32 s15, s15, s14
  s_sub_u32 s15, s15, s12
  s_cmp_eq_u32 s15, 0x1b873593
  s_cbranch_scc0 L_in219
L_bk220:
  v_lshlrev_b32 v128, 16, v64
  v_and_b32 v64, 0xffff0000, v64
  v_fmac_f32 v240, v23, v128
  v_fmac_f32 v241, v23, v64
  v_lshlrev_b32 v128, 16, v65
  v_and_b32 v65, 0xffff0000, v65
  v_fmac_f32 v242, v23, v128
  v_fmac_f32 v243, v23, v65
  v_lshlrev_b32 v128, 16, v66
  v_and_b32 v66, 0xffff0000, v66
  v_fmac_f32 v244, v23, v128
  v_fmac_f32 v245, v23, v66
  v_lshlrev_b32 v128, 16, v67
  v_and_b32 v67, 0xffff0000, v67
  v_fmac_f32 v246, v23, v128
  v_fmac_f32 v247, v23, v67
  v_lshlrev_b32 v128, 16, v68
  v_and_b32 v68, 0xffff0000, v68
  v_fmac_f32 v248, v23, v128
  v_fmac_f32 v249, v23, v68
  v_lshlrev_b32 v128, 16, v69
  v_and_b32 v69, 0xffff0000, v69
  v_fmac_f32 v250, v23, v128
  v_fmac_f32 v251, v23, v69
  v_lshlrev_b32 v128, 16, v70
  v_and_b32 v70, 0xffff0000, v70
  v_fmac_f32 v252, v23, v128
  v_fmac_f32 v253, v23, v70
  v_lshlrev_b32 v128, 16, v71
  v_and_b32 v71, 0xffff0000, v71
  v_fmac_f32 v254, v23, v128
  v_fmac_f32 v255, v23, v71
  v_permlane16_swap_b32 v240, v244
  v_permlane16_swap_b32 v241, v245
  v_permlane16_swap_b32 v242, v246
  v_permlane16_swap_b32 v243, v247
  buffer_store_dwordx4 v[240:243], v164, s[44:47], 0 offen offset:0
  buffer_store_dwordx4 v[244:247], v165, s[44:47], 0 offen offset:0
  v_permlane16_swap_b32 v248, v252
  v_permlane16_swap_b32 v249, v253
  v_permlane16_swap_b32 v250, v254
  v_permlane16_swap_b32 v251, v255
  buffer_store_dwordx4 v[248:251], v164, s[44:47], 0 offen offset:64
  buffer_store_dwordx4 v[252:255], v165, s[44:47], 0 offen offset:64
  s_lshl_b32 s14, s5, 4
  s_add_u32 s14, s14, s10
  s_lshl_b32 s14, s14, 2
  s_add_u32 s14, s14, s4
  s_cmp_eq_u32 s14, 960
  s_cbranch_scc0 L_ne222
  s_add_u32 s100, s100, 1
  v_mov_b32 v128, s100
  buffer_store_dword v128, v19, s[28:31], 0 offen sc1
L_ne222:
  s_endpgm
L_Xslow:
  v_mfma_f32_32x32x16_bf16 v[48:63], v[28:31], v[2:5], v[48:63]
  s_waitcnt lgkmcnt(4)
  v_mfma_f32_32x32x16_bf16 v[64:79], v[80:83], v[192:195], 0
  ds_read_b64_tr_b16 v[92:93], v10 offset:40960
  ds_read_b64_tr_b16 v[94:95], v10 offset:41472
  v_mfma_f32_16x16x32_bf16 v[104:107], v[112:115], v[80:83], 0
  v_mfma_f32_32x32x16_bf16 v[64:79], v[84:87], v[196:199], v[64:79]
  ds_read_b64_tr_b16 v[96:97], v11 offset:40960
  ds_read_b64_tr_b16 v[98:99], v11 offset:41472
  v_mul_f32 v32, v23, v32
  v_mul_f32 v33, v23, v33
  v_mul_f32 v34, v23, v34
  v_mul_f32 v35, v23, v35
  v_exp_f32 v28, v32
  v_exp_f32 v29, v33
  v_exp_f32 v30, v34
  s_waitcnt lgkmcnt(4)
  v_mfma_f32_32x32x16_bf16 v[64:79], v[108:111], v[200:203], v[64:79]
  ds_read_b64_tr_b16 v[100:101], v12 offset:40960
  ds_read_b64_tr_b16 v[102:103], v12 offset:41472
  v_exp_f32 v31, v35
  v_add_f32 v28, 1.0, v28
  v_add_f32 v29, 1.0, v29
  v_add_f32 v30, 1.0, v30
  v_add_f32 v31, 1.0, v31
  v_rcp_f32 v28, v28
  v_mfma_f32_32x32x16_bf16 v[64:79], v[88:91], v[204:207], v[64:79]
  ds_read_b64_tr_b16 v[80:81], v13 offset:40960
  ds_read_b64_tr_b16 v[82:83], v13 offset:41472
  v_rcp_f32 v29, v29
  v_rcp_f32 v30, v30
  v_rcp_f32 v31, v31
  v_mul_f32 v32, v32, v28
  v_mul_f32 v33, v33, v29
  v_mul_f32 v34, v34, v30
  s_waitcnt lgkmcnt(4)
  v_mfma_f32_32x32x16_bf16 v[64:79], v[92:95], v[208:211], v[64:79]
  ds_read_b64_tr_b16 v[84:85], v10 offset:49152
  ds_read_b64_tr_b16 v[86:87], v10 offset:49664
  v_mfma_f32_16x16x32_bf16 v[104:107], v[112:115], v[92:95], v[104:107]
  s_waitcnt vmcnt(5)
  ds_write_b8 v21, v24 offset:88
  v_mul_f32 v35, v35, v31
  v_mul_f32 v36, v23, v36
  v_mul_f32 v37, v23, v37
  v_mul_f32 v38, v23, v38
  v_mul_f32 v39, v23, v39
  v_exp_f32 v28, v36
  v_mfma_f32_32x32x16_bf16 v[64:79], v[96:99], v[212:215], v[64:79]
  ds_read_b64_tr_b16 v[108:109], v11 offset:49152
  ds_read_b64_tr_b16 v[110:111], v11 offset:49664
  v_exp_f32 v29, v37
  v_exp_f32 v30, v38
  v_exp_f32 v31, v39
  v_add_f32 v28, 1.0, v28
  v_add_f32 v29, 1.0, v29
  v_add_f32 v30, 1.0, v30
  s_waitcnt lgkmcnt(5)
  v_mfma_f32_32x32x16_bf16 v[64:79], v[100:103], v[216:219], v[64:79]
  ds_read_b64_tr_b16 v[88:89], v12 offset:49152
  ds_read_b64_tr_b16 v[90:91], v12 offset:49664
  v_add_f32 v31, 1.0, v31
  v_rcp_f32 v28, v28
  v_rcp_f32 v29, v29
  v_rcp_f32 v30, v30
  v_rcp_f32 v31, v31
  v_mul_f32 v36, v36, v28
  v_mfma_f32_32x32x16_bf16 v[64:79], v[80:83], v[220:223], v[64:79]
  ds_read_b64_tr_b16 v[92:93], v13 offset:49152
  ds_read_b64_tr_b16 v[94:95], v13 offset:49664
  v_mul_f32 v37, v37, v29
  v_mul_f32 v38, v38, v30
  v_mul_f32 v39, v39, v31
  v_cvt_pk_bf16_f32 v32, v32, v33
  v_cvt_pk_bf16_f32 v33, v34, v35
  v_cvt_pk_bf16_f32 v34, v36, v37
  s_waitcnt lgkmcnt(4)
  v_mfma_f32_32x32x16_bf16 v[64:79], v[84:87], v[224:227], v[64:79]
  ds_read_b64_tr_b16 v[96:97], v10 offset:57344
  ds_read_b64_tr_b16 v[98:99], v10 offset:57856
  v_mfma_f32_16x16x32_bf16 v[104:107], v[112:115], v[84:87], v[104:107]
  v_cvt_pk_bf16_f32 v35, v38, v39
  buffer_store_dwordx4 v[32:35], v1, s[28:31], s80 offen offset:0 sc1
  v_mul_f32 v40, v23, v40
  v_mul_f32 v41, v23, v41
  v_mul_f32 v42, v23, v42
  v_mul_f32 v43, v23, v43
  v_mfma_f32_32x32x16_bf16 v[64:79], v[108:111], v[228:231], v[64:79]
  ds_read_b64_tr_b16 v[100:101], v11 offset:57344
  ds_read_b64_tr_b16 v[102:103], v11 offset:57856
  ds_read_b64 v[124:125], v20 offset:88
  v_exp_f32 v28, v40
  v_exp_f32 v29, v41
  v_exp_f32 v30, v42
  v_exp_f32 v31, v43
  v_add_f32 v28, 1.0, v28
  v_add_f32 v29, 1.0, v29
  s_waitcnt lgkmcnt(5)
  v_mfma_f32_32x32x16_bf16 v[64:79], v[88:91], v[232:235], v[64:79]
  ds_read_b64_tr_b16 v[80:81], v12 offset:57344
  ds_read_b64_tr_b16 v[82:83], v12 offset:57856
  v_add_f32 v30, 1.0, v30
  v_add_f32 v31, 1.0, v31
  v_rcp_f32 v28, v28
  v_rcp_f32 v29, v29
  v_rcp_f32 v30, v30
  v_rcp_f32 v31, v31
  v_mfma_f32_32x32x16_bf16 v[64:79], v[92:95], v[236:239], v[64:79]
  ds_read_b64_tr_b16 v[84:85], v13 offset:57344
  ds_read_b64_tr_b16 v[86:87], v13 offset:57856
  s_waitcnt lgkmcnt(4)
  v_readfirstlane_b32 s14, v124
  v_readfirstlane_b32 s15, v125
  s_nop 0
  s_and_b32 s14, s14, s15
  s_cmp_eq_u32 s14, 0x01010101
  s_cbranch_scc0 L_sl4
L_bk5:
  v_mul_f32 v40, v40, v28
  v_mul_f32 v41, v41, v29
  v_mul_f32 v42, v42, v30
  v_mul_f32 v43, v43, v31
  v_mul_f32 v44, v23, v44
  v_mul_f32 v45, v23, v45
  v_mfma_f32_32x32x16_bf16 v[64:79], v[96:99], v[240:243], v[64:79]
  ds_read_b64_tr_b16 v[108:109], v10 offset:0
  ds_read_b64_tr_b16 v[110:111], v10 offset:512
  v_mfma_f32_16x16x32_bf16 v[104:107], v[112:115], v[96:99], v[104:107]
  v_mul_f32 v46, v23, v46
  v_mul_f32 v47, v23, v47
  v_exp_f32 v28, v44
  v_exp_f32 v29, v45
  v_exp_f32 v30, v46
  v_exp_f32 v31, v47
  v_mfma_f32_32x32x16_bf16 v[64:79], v[100:103], v[244:247], v[64:79]
  ds_read_b64_tr_b16 v[88:89], v11 offset:0
  ds_read_b64_tr_b16 v[90:91], v11 offset:512
  v_add_f32 v28, 1.0, v28
  v_add_f32 v29, 1.0, v29
  v_add_f32 v30, 1.0, v30
  v_add_f32 v31, 1.0, v31
  v_rcp_f32 v28, v28
  v_rcp_f32 v29, v29
  s_waitcnt lgkmcnt(4)
  v_mfma_f32_32x32x16_bf16 v[64:79], v[80:83], v[248:251], v[64:79]
  ds_read_b64_tr_b16 v[92:93], v12 offset:0
  ds_read_b64_tr_b16 v[94:95], v12 offset:512
  v_rcp_f32 v30, v30
  v_rcp_f32 v31, v31
  v_mul_f32 v44, v44, v28
  v_mul_f32 v45, v45, v29
  v_mul_f32 v46, v46, v30
  v_mul_f32 v47, v47, v31
  v_mfma_f32_32x32x16_bf16 v[64:79], v[84:87], v[252:255], v[64:79]
  ds_read_b64_tr_b16 v[96:97], v13 offset:0
  ds_read_b64_tr_b16 v[98:99], v13 offset:512
  v_cvt_pk_bf16_f32 v36, v40, v41
  v_cvt_pk_bf16_f32 v37, v42, v43
  v_cvt_pk_bf16_f32 v38, v44, v45
  v_cvt_pk_bf16_f32 v39, v46, v47
  buffer_store_dwordx4 v[36:39], v1, s[28:31], s80 offen offset:1024 sc1
  v_mul_f32 v48, v23, v48
  s_waitcnt lgkmcnt(4)
  v_mfma_f32_32x32x16_bf16 v[64:79], v[108:111], v[128:131], v[64:79]
  ds_read_b64_tr_b16 v[100:101], v10 offset:8192
  ds_read_b64_tr_b16 v[102:103], v10 offset:8704
  v_mfma_f32_16x16x32_bf16 v[104:107], v[112:115], v[108:111], v[104:107]
  s_waitcnt vmcnt(3)
  ds_write_b8 v21, v24 offset:4
  v_mul_f32 v49, v23, v49
  v_mul_f32 v50, v23, v50
  v_mul_f32 v51, v23, v51
  v_exp_f32 v28, v48
  v_exp_f32 v29, v49
  v_exp_f32 v30, v50
  v_mfma_f32_32x32x16_bf16 v[64:79], v[88:91], v[132:135], v[64:79]
  ds_read_b64_tr_b16 v[80:81], v11 offset:8192
  ds_read_b64_tr_b16 v[82:83], v11 offset:8704
  v_exp_f32 v31, v51
  v_add_f32 v28, 1.0, v28
  v_add_f32 v29, 1.0, v29
  v_add_f32 v30, 1.0, v30
  v_add_f32 v31, 1.0, v31
  v_rcp_f32 v28, v28
  s_waitcnt lgkmcnt(5)
  v_mfma_f32_32x32x16_bf16 v[64:79], v[92:95], v[136:139], v[64:79]
  ds_read_b64_tr_b16 v[84:85], v12 offset:8192
  ds_read_b64_tr_b16 v[86:87], v12 offset:8704
  v_rcp_f32 v29, v29
  v_rcp_f32 v30, v30
  v_rcp_f32 v31, v31
  v_mul_f32 v48, v48, v28
  v_mul_f32 v49, v49, v29
  v_mul_f32 v50, v50, v30
  v_mfma_f32_32x32x16_bf16 v[64:79], v[96:99], v[140:143], v[64:79]
  ds_read_b64_tr_b16 v[108:109], v13 offset:8192
  ds_read_b64_tr_b16 v[110:111], v13 offset:8704
  v_mul_f32 v51, v51, v31
  v_mul_f32 v52, v23, v52
  v_mul_f32 v53, v23, v53
  v_mul_f32 v54, v23, v54
  v_mul_f32 v55, v23, v55
  v_exp_f32 v28, v52
  s_waitcnt lgkmcnt(4)
  v_mfma_f32_32x32x16_bf16 v[64:79], v[100:103], v[144:147], v[64:79]
  ds_read_b64_tr_b16 v[88:89], v10 offset:16384
  ds_read_b64_tr_b16 v[90:91], v10 offset:16896
  v_mfma_f32_16x16x32_bf16 v[104:107], v[112:115], v[100:103], v[104:107]
  v_exp_f32 v29, v53
  v_exp_f32 v30, v54
  v_exp_f32 v31, v55
  v_add_f32 v28, 1.0, v28
  v_add_f32 v29, 1.0, v29
  v_add_f32 v30, 1.0, v30
  v_mfma_f32_32x32x16_bf16 v[64:79], v[80:83], v[148:151], v[64:79]
  ds_read_b64_tr_b16 v[92:93], v11 offset:16384
  ds_read_b64_tr_b16 v[94:95], v11 offset:16896
  v_add_f32 v31, 1.0, v31
  v_rcp_f32 v28, v28
  v_rcp_f32 v29, v29
  v_rcp_f32 v30, v30
  v_rcp_f32 v31, v31
  v_mul_f32 v52, v52, v28
  s_waitcnt lgkmcnt(4)
  v_mfma_f32_32x32x16_bf16 v[64:79], v[84:87], v[152:155], v[64:79]
  ds_read_b64_tr_b16 v[96:97], v12 offset:16384
  ds_read_b64_tr_b16 v[98:99], v12 offset:16896
  v_mul_f32 v53, v53, v29
  v_mul_f32 v54, v54, v30
  v_mul_f32 v55, v55, v31
  s_waitcnt vmcnt(0)
  buffer_store_dword v18, v19, s[28:31], s84 offen offset:0 sc1
  v_cvt_pk_bf16_f32 v40, v48, v49
  v_cvt_pk_bf16_f32 v41, v50, v51
  v_mfma_f32_32x32x16_bf16 v[64:79], v[108:111], v[156:159], v[64:79]
  ds_read_b64_tr_b16 v[100:101], v13 offset:16384
  ds_read_b64_tr_b16 v[102:103], v13 offset:16896
  v_cvt_pk_bf16_f32 v42, v52, v53
  v_cvt_pk_bf16_f32 v43, v54, v55
  buffer_store_dwordx4 v[40:43], v1, s[28:31], s80 offen offset:2048 sc1
  v_mul_f32 v56, v23, v56
  v_mul_f32 v57, v23, v57
  v_mul_f32 v58, v23, v58
  s_waitcnt lgkmcnt(4)
  v_mfma_f32_32x32x16_bf16 v[64:79], v[88:91], v[160:163], v[64:79]
  ds_read_b64_tr_b16 v[80:81], v10 offset:24576
  ds_read_b64_tr_b16 v[82:83], v10 offset:25088
  v_mfma_f32_16x16x32_bf16 v[104:107], v[112:115], v[88:91], v[104:107]
  v_mul_f32 v59, v23, v59
  v_exp_f32 v28, v56
  v_exp_f32 v29, v57
  v_exp_f32 v30, v58
  v_exp_f32 v31, v59
  v_add_f32 v28, 1.0, v28
  v_mfma_f32_32x32x16_bf16 v[64:79], v[92:95], v[164:167], v[64:79]
  ds_read_b64_tr_b16 v[84:85], v11 offset:24576
  ds_read_b64_tr_b16 v[86:87], v11 offset:25088
  v_add_f32 v29, 1.0, v29
  v_add_f32 v30, 1.0, v30
  v_add_f32 v31, 1.0, v31
  v_rcp_f32 v28, v28
  v_rcp_f32 v29, v29
  v_rcp_f32 v30, v30
  s_waitcnt lgkmcnt(4)
  v_mfma_f32_32x32x16_bf16 v[64:79], v[96:99], v[168:171], v[64:79]
  ds_read_b64_tr_b16 v[108:109], v12 offset:24576
  ds_read_b64_tr_b16 v[110:111], v12 offset:25088
  v_rcp_f32 v31, v31
  v_mul_f32 v56, v56, v28
  v_mul_f32 v57, v57, v29
  v_mul_f32 v58, v58, v30
  v_mul_f32 v59, v59, v31
  v_mul_f32 v60, v23, v60
  v_mfma_f32_32x32x16_bf16 v[64:79], v[100:103], v[172:175], v[64:79]
  ds_read_b64_tr_b16 v[88:89], v13 offset:24576
  ds_read_b64_tr_b16 v[90:91], v13 offset:25088
  v_mul_f32 v61, v23, v61
  v_mul_f32 v62, v23, v62
  v_mul_f32 v63, v23, v63
  v_exp_f32 v28, v60
  v_exp_f32 v29, v61
  v_exp_f32 v30, v62
  s_waitcnt lgkmcnt(4)
  v_mfma_f32_32x32x16_bf16 v[64:79], v[80:83], v[176:179], v[64:79]
  v_xor_b32 v10, 64, v10
  ds_read_b64_tr_b16 v[92:93], v10 offset:32768
  ds_read_b64_tr_b16 v[94:95], v10 offset:33280
  v_mfma_f32_16x16x32_bf16 v[104:107], v[112:115], v[80:83], v[104:107]
  v_exp_f32 v31, v63
  v_add_f32 v28, 1.0, v28
  v_add_f32 v29, 1.0, v29
  v_add_f32 v30, 1.0, v30
  v_add_f32 v31, 1.0, v31
  v_rcp_f32 v28, v28
  v_mfma_f32_32x32x16_bf16 v[64:79], v[84:87], v[180:183], v[64:79]
  v_xor_b32 v11, 64, v11
  ds_read_b64_tr_b16 v[96:97], v11 offset:32768
  ds_read_b64_tr_b16 v[98:99], v11 offset:33280
  v_rcp_f32 v29, v29
  v_rcp_f32 v30, v30
  v_rcp_f32 v31, v31
  v_mul_f32 v60, v60, v28
  v_mul_f32 v61, v61, v29
  v_mul_f32 v62, v62, v30
  s_waitcnt lgkmcnt(4)
  v_mfma_f32_32x32x16_bf16 v[64:79], v[108:111], v[184:187], v[64:79]
  v_xor_b32 v12, 64, v12
  ds_read_b64_tr_b16 v[100:101], v12 offset:32768
  ds_read_b64_tr_b16 v[102:103], v12 offset:33280
  s_lshl_b32 s86, s4, 2
  s_add_u32 s86, s86, 0x26600
  v_and_b32 v124, 0x1f0, v1
  v_add_u32 v124, s86, v124
  ds_write_b32 v124, v104
  ds_write_b8 v21, v24 offset:12
  v_mul_f32 v63, v63, v31
  v_cvt_pk_bf16_f32 v44, v56, v57
  v_cvt_pk_bf16_f32 v45, v58, v59
  v_cvt_pk_bf16_f32 v46, v60, v61
  v_cvt_pk_bf16_f32 v47, v62, v63
  buffer_store_dwordx4 v[44:47], v1, s[28:31], s80 offen offset:3072 sc1
  v_mfma_f32_32x32x16_bf16 v[64:79], v[88:91], v[188:191], v[64:79]
  v_xor_b32 v13, 64, v13
  ds_read_b64_tr_b16 v[80:81], v13 offset:32768
  ds_read_b64_tr_b16 v[82:83], v13 offset:33280
  s_waitcnt lgkmcnt(6)
  v_mfma_f32_32x32x16_bf16 v[48:63], v[92:95], v[192:195], 0
  ds_read_b64_tr_b16 v[84:85], v10 offset:40960
  ds_read_b64_tr_b16 v[86:87], v10 offset:41472
  v_mfma_f32_16x16x32_bf16 v[120:123], v[112:115], v[92:95], 0
  ds_read_b32 v126, v20 offset:12
  buffer_load_dword v27, v25, s[28:31], s83 offen sc1
  v_mfma_f32_32x32x16_bf16 v[48:63], v[96:99], v[196:199], v[48:63]
  ds_read_b64_tr_b16 v[108:109], v11 offset:40960
  ds_read_b64_tr_b16 v[110:111], v11 offset:41472
  s_waitcnt lgkmcnt(5)
  v_mfma_f32_32x32x16_bf16 v[48:63], v[100:103], v[200:203], v[48:63]
  ds_read_b64_tr_b16 v[88:89], v12 offset:40960
  ds_read_b64_tr_b16 v[90:91], v12 offset:41472
  v_mfma_f32_32x32x16_bf16 v[48:63], v[80:83], v[204:207], v[48:63]
  ds_read_b64_tr_b16 v[92:93], v13 offset:40960
  ds_read_b64_tr_b16 v[94:95], v13 offset:41472
  s_waitcnt lgkmcnt(6)
  v_readfirstlane_b32 s14, v126
  s_nop 0
  s_cmp_eq_u32 s14, 0x01010101
  s_cbranch_scc0 L_sl7
L_bk8:
  v_and_b32 v124, 0x1f0, v1
  v_add_u32 v124, 0x26600, v124
  ds_read_b128 v[6:9], v124
  s_waitcnt lgkmcnt(5)
  v_mfma_f32_32x32x16_bf16 v[48:63], v[84:87], v[208:211], v[48:63]
  ds_read_b64_tr_b16 v[96:97], v10 offset:49152
  ds_read_b64_tr_b16 v[98:99], v10 offset:49664
  v_mfma_f32_16x16x32_bf16 v[120:123], v[112:115], v[84:87], v[120:123]
  v_mfma_f32_32x32x16_bf16 v[48:63], v[108:111], v[212:215], v[48:63]
  ds_read_b64_tr_b16 v[100:101], v11 offset:49152
  ds_read_b64_tr_b16 v[102:103], v11 offset:49664
  s_waitcnt lgkmcnt(4)
  v_add_f32 v6, v6, v7
  v_add_f32 v8, v8, v9
  v_mov_b32 v9, 0
  v_add_f32 v6, v6, v8
  v_cvt_pk_bf16_f32 v7, v6, 0
  v_lshlrev_b32 v8, 16, v7
  v_sub_f32 v6, v6, v8
  v_cvt_pk_bf16_f32 v6, v8, v6
  v_mfma_f32_32x32x16_bf16 v[48:63], v[88:91], v[216:219], v[48:63]
  ds_read_b64_tr_b16 v[80:81], v12 offset:49152
  ds_read_b64_tr_b16 v[82:83], v12 offset:49664
  v_mfma_f32_32x32x16_bf16 v[64:79], v[6:9], v[2:5], v[64:79]
  s_waitcnt vmcnt(1)
  buffer_store_dword v18, v19, s[28:31], s84 offen offset:16 sc1
  v_mfma_f32_32x32x16_bf16 v[48:63], v[92:95], v[220:223], v[48:63]
  ds_read_b64_tr_b16 v[84:85], v13 offset:49152
  ds_read_b64_tr_b16 v[86:87], v13 offset:49664
  s_waitcnt lgkmcnt(4)
  v_mfma_f32_32x32x16_bf16 v[48:63], v[96:99], v[224:227], v[48:63]
  ds_read_b64_tr_b16 v[108:109], v10 offset:57344
  ds_read_b64_tr_b16 v[110:111], v10 offset:57856
  v_mfma_f32_16x16x32_bf16 v[120:123], v[112:115], v[96:99], v[120:123]
  s_waitcnt vmcnt(1)
  v_cmp_eq_u32 vcc, s12, v27
  s_mov_b32 s15, s85
  s_and_b32 s14, vcc_lo, s15
  s_cmp_eq_u32 s14, s15
  s_cbranch_scc0 L_sl10
L_bk11:
  v_mul_f32 v64, v23, v64
  v_mul_f32 v65, v23, v65
  v_mul_f32 v66, v23, v66
  v_mul_f32 v67, v23, v67
  v_exp_f32 v28, v64
  v_mfma_f32_32x32x16_bf16 v[48:63], v[100:103], v[228:231], v[48:63]
  ds_read_b64_tr_b16 v[88:89], v11 offset:57344
  ds_read_b64_tr_b16 v[90:91], v11 offset:57856
  v_exp_f32 v29, v65
  v_exp_f32 v30, v66
  v_exp_f32 v31, v67
  v_add_f32 v28, 1.0, v28
  s_waitcnt lgkmcnt(4)
  v_mfma_f32_32x32x16_bf16 v[48:63], v[80:83], v[232:235], v[48:63]
  ds_read_b64_tr_b16 v[92:93], v12 offset:57344
  ds_read_b64_tr_b16 v[94:95], v12 offset:57856
  buffer_load_dwordx4 v[192:195], v1, s[28:31], s88 offen offset:0 sc1
  v_add_f32 v29, 1.0, v29
  v_add_f32 v30, 1.0, v30
  v_add_f32 v31, 1.0, v31
  v_rcp_f32 v28, v28
  v_mfma_f32_32x32x16_bf16 v[48:63], v[84:87], v[236:239], v[48:63]
  ds_read_b64_tr_b16 v[96:97], v13 offset:57344
  ds_read_b64_tr_b16 v[98:99], v13 offset:57856
  buffer_load_dwordx4 v[196:199], v1, s[28:31], s88 offen offset:1024 sc1
  v_rcp_f32 v29, v29
  v_rcp_f32 v30, v30
  v_rcp_f32 v31, v31
  v_mul_f32 v64, v64, v28
  s_waitcnt lgkmcnt(4)
  v_mfma_f32_32x32x16_bf16 v[48:63], v[108:111], v[240:243], v[48:63]
  ds_read_b64_tr_b16 v[100:101], v10 offset:0
  ds_read_b64_tr_b16 v[102:103], v10 offset:512
  v_mfma_f32_16x16x32_bf16 v[120:123], v[112:115], v[108:111], v[120:123]
  ds_write_b8 v21, v24 offset:28
  buffer_load_dwordx4 v[208:211], v1, s[28:31], s89 offen offset:0 sc1
  buffer_load_dword v27, v25, s[28:31], s83 offen sc1
  v_mul_f32 v65, v65, v29
  v_mul_f32 v66, v66, v30
  v_mul_f32 v67, v67, v31
  v_mul_f32 v68, v23, v68
  v_mfma_f32_32x32x16_bf16 v[48:63], v[88:91], v[244:247], v[48:63]
  ds_read_b64_tr_b16 v[80:81], v11 offset:0
  ds_read_b64_tr_b16 v[82:83], v11 offset:512
  buffer_load_dwordx4 v[212:215], v1, s[28:31], s89 offen offset:1024 sc1
  v_mul_f32 v69, v23, v69
  v_mul_f32 v70, v23, v70
  v_mul_f32 v71, v23, v71
  v_exp_f32 v28, v68
  s_waitcnt lgkmcnt(5)
  v_mfma_f32_32x32x16_bf16 v[48:63], v[92:95], v[248:251], v[48:63]
  ds_read_b64_tr_b16 v[84:85], v12 offset:0
  ds_read_b64_tr_b16 v[86:87], v12 offset:512
  buffer_load_dwordx4 v[224:227], v1, s[28:31], s90 offen offset:0 sc1
  v_exp_f32 v29, v69
  v_exp_f32 v30, v70
  v_exp_f32 v31, v71
  v_add_f32 v28, 1.0, v28
  v_mfma_f32_32x32x16_bf16 v[48:63], v[96:99], v[252:255], v[48:63]
  ds_read_b64_tr_b16 v[108:109], v13 offset:0
  ds_read_b64_tr_b16 v[110:111], v13 offset:512
  buffer_load_dwordx4 v[228:231], v1, s[28:31], s90 offen offset:1024 sc1
  v_add_f32 v29, 1.0, v29
  v_add_f32 v30, 1.0, v30
  v_add_f32 v31, 1.0, v31
  v_rcp_f32 v28, v28
  s_waitcnt lgkmcnt(4)
  v_mfma_f32_32x32x16_bf16 v[48:63], v[100:103], v[128:131], v[48:63]
  ds_read_b64_tr_b16 v[88:89], v10 offset:8192
  ds_read_b64_tr_b16 v[90:91], v10 offset:8704
  v_mfma_f32_16x16x32_bf16 v[120:123], v[112:115], v[100:103], v[120:123]
  v_rcp_f32 v29, v29
  v_rcp_f32 v30, v30
  v_rcp_f32 v31, v31
  v_mul_f32 v68, v68, v28
  v_mfma_f32_32x32x16_bf16 v[48:63], v[80:83], v[132:135], v[48:63]
  ds_read_b64_tr_b16 v[92:93], v11 offset:8192
  ds_read_b64_tr_b16 v[94:95], v11 offset:8704
  s_waitcnt vmcnt(3)
  v_cmp_eq_u32 vcc, s12, v27
  s_lshl_b32 s15, s85, 4
  s_and_b32 s14, vcc_lo, s15
  s_cmp_eq_u32 s14, s15
  s_cbranch_scc0 L_sl13
L_bk14:
  v_mul_f32 v69, v69, v29
  v_mul_f32 v70, v70, v30
  v_mul_f32 v71, v71, v31
  v_cvt_pk_bf16_f32 v64, v64, v65
  s_waitcnt lgkmcnt(4)
  v_mfma_f32_32x32x16_bf16 v[48:63], v[84:87], v[136:139], v[48:63]
  ds_read_b64_tr_b16 v[96:97], v12 offset:8192
  ds_read_b64_tr_b16 v[98:99], v12 offset:8704
  buffer_load_dwordx4 v[200:203], v1, s[28:31], s88 offen offset:2048 sc1
  v_cvt_pk_bf16_f32 v65, v66, v67
  v_cvt_pk_bf16_f32 v66, v68, v69
  v_cvt_pk_bf16_f32 v67, v70, v71
  buffer_store_dwordx4 v[64:67], v1, s[28:31], s81 offen offset:0 sc1
  v_mfma_f32_32x32x16_bf16 v[48:63], v[108:111], v[140:143], v[48:63]
  ds_read_b64_tr_b16 v[100:101], v13 offset:8192
  ds_read_b64_tr_b16 v[102:103], v13 offset:8704
  buffer_load_dwordx4 v[204:207], v1, s[28:31], s88 offen offset:3072 sc1
  v_mul_f32 v72, v23, v72
  v_mul_f32 v73, v23, v73
  v_mul_f32 v74, v23, v74
  v_mul_f32 v75, v23, v75
  v_exp_f32 v28, v72
  s_waitcnt lgkmcnt(4)
  v_mfma_f32_32x32x16_bf16 v[48:63], v[88:91], v[144:147], v[48:63]
  ds_read_b64_tr_b16 v[80:81], v10 offset:16384
  ds_read_b64_tr_b16 v[82:83], v10 offset:16896
  v_mfma_f32_16x16x32_bf16 v[120:123], v[112:115], v[88:91], v[120:123]
  buffer_load_dwordx4 v[216:219], v1, s[28:31], s89 offen offset:2048 sc1
  v_exp_f32 v29, v73
  v_exp_f32 v30, v74
  v_exp_f32 v31, v75
  v_add_f32 v28, 1.0, v28
  v_mfma_f32_32x32x16_bf16 v[48:63], v[92:95], v[148:151], v[48:63]
  ds_read_b64_tr_b16 v[84:85], v11 offset:16384
  ds_read_b64_tr_b16 v[86:87], v11 offset:16896
  buffer_load_dwordx4 v[220:223], v1, s[28:31], s89 offen offset:3072 sc1
  v_add_f32 v29, 1.0, v29
  v_add_f32 v30, 1.0, v30
  v_add_f32 v31, 1.0, v31
  v_rcp_f32 v28, v28
  s_waitcnt lgkmcnt(4)
  v_mfma_f32_32x32x16_bf16 v[48:63], v[96:99], v[152:155], v[48:63]
  ds_read_b64_tr_b16 v[108:109], v12 offset:16384
  ds_read_b64_tr_b16 v[110:111], v12 offset:16896
  buffer_load_dwordx4 v[232:235], v1, s[28:31], s90 offen offset:2048 sc1
  ds_read_b64 v[124:125], v20 offset:0
  v_rcp_f32 v29, v29
  v_rcp_f32 v30, v30
  v_rcp_f32 v31, v31
  v_mul_f32 v72, v72, v28
  v_mfma_f32_32x32x16_bf16 v[48:63], v[100:103], v[156:159], v[48:63]
  ds_read_b64_tr_b16 v[88:89], v13 offset:16384
  ds_read_b64_tr_b16 v[90:91], v13 offset:16896
  buffer_load_dwordx4 v[236:239], v1, s[28:31], s90 offen offset:3072 sc1
  v_mul_f32 v73, v73, v29
  v_mul_f32 v74, v74, v30
  v_mul_f32 v75, v75, v31
  v_mul_f32 v76, v23, v76
  s_waitcnt lgkmcnt(5)
  v_mfma_f32_32x32x16_bf16 v[48:63], v[80:83], v[160:163], v[48:63]
  ds_read_b64_tr_b16 v[92:93], v10 offset:24576
  ds_read_b64_tr_b16 v[94:95], v10 offset:25088
  v_mfma_f32_16x16x32_bf16 v[120:123], v[112:115], v[80:83], v[120:123]
  v_mul_f32 v77, v23, v77
  v_mul_f32 v78, v23, v78
  v_mul_f32 v79, v23, v79
  v_exp_f32 v28, v76
  v_mfma_f32_32x32x16_bf16 v[48:63], v[84:87], v[164:167], v[48:63]
  ds_read_b64_tr_b16 v[96:97], v11 offset:24576
  ds_read_b64_tr_b16 v[98:99], v11 offset:25088
  s_waitcnt lgkmcnt(6)
  v_readfirstlane_b32 s14, v124
  v_readfirstlane_b32 s15, v125
  s_nop 0
  s_and_b32 s14, s14, s15
  s_cmp_eq_u32 s14, 0x01010101
  s_cbranch_scc0 L_sl16
L_bk17:
  v_exp_f32 v29, v77
  v_exp_f32 v30, v78
  v_exp_f32 v31, v79
  v_add_f32 v28, 1.0, v28
  s_waitcnt lgkmcnt(4)
  v_mfma_f32_32x32x16_bf16 v[48:63], v[108:111], v[168:171], v[48:63]
  ds_read_b64_tr_b16 v[100:101], v12 offset:24576
  ds_read_b64_tr_b16 v[102:103], v12 offset:25088
  ds_read_b64_tr_b16 v[240:241], v116 offset:32768
  ds_read_b64_tr_b16 v[242:243], v116 offset:34816
  v_add_f32 v29, 1.0, v29
  v_add_f32 v30, 1.0, v30
  v_add_f32 v31, 1.0, v31
  v_rcp_f32 v28, v28
  v_mfma_f32_32x32x16_bf16 v[48:63], v[88:91], v[172:175], v[48:63]
  ds_read_b64_tr_b16 v[80:81], v13 offset:24576
  ds_read_b64_tr_b16 v[82:83], v13 offset:25088
  ds_read_b64_tr_b16 v[244:245], v117 offset:32768
  ds_read_b64_tr_b16 v[246:247], v117 offset:34816
  v_rcp_f32 v29, v29
  v_rcp_f32 v30, v30
  v_rcp_f32 v31, v31
  v_mul_f32 v76, v76, v28
  s_waitcnt lgkmcnt(8)
  v_mfma_f32_32x32x16_bf16 v[48:63], v[92:95], v[176:179], v[48:63]
  v_mfma_f32_16x16x32_bf16 v[120:123], v[112:115], v[92:95], v[120:123]
  ds_read_b64_tr_b16 v[248:249], v118 offset:32768
  ds_read_b64_tr_b16 v[250:251], v118 offset:34816
  v_mul_f32 v77, v77, v29
  v_mul_f32 v78, v78, v30
  v_mul_f32 v79, v79, v31
  v_cvt_pk_bf16_f32 v68, v72, v73
  v_mfma_f32_32x32x16_bf16 v[48:63], v[96:99], v[180:183], v[48:63]
  ds_read_b64_tr_b16 v[252:253], v119 offset:32768
  ds_read_b64_tr_b16 v[254:255], v119 offset:34816
  v_cvt_pk_bf16_f32 v69, v74, v75
  v_cvt_pk_bf16_f32 v70, v76, v77
  v_cvt_pk_bf16_f32 v71, v78, v79
  buffer_store_dwordx4 v[68:71], v1, s[28:31], s81 offen offset:1024 sc1
  s_waitcnt lgkmcnt(6)
  v_mfma_f32_32x32x16_bf16 v[48:63], v[100:103], v[184:187], v[48:63]
  ds_read_b64_tr_b16 v[96:97], v116 offset:36864
  ds_read_b64_tr_b16 v[98:99], v116 offset:38912
  s_lshl_b32 s86, s4, 2
  s_add_u32 s86, s86, 0x26400
  v_and_b32 v124, 0x1f0, v1
  v_add_u32 v124, s86, v124
  ds_write_b32 v124, v120
  ds_write_b8 v21, v24 offset:32
  v_mfma_f32_32x32x16_bf16 v[48:63], v[80:83], v[188:191], v[48:63]
  ds_read_b64_tr_b16 v[100:101], v117 offset:36864
  ds_read_b64_tr_b16 v[102:103], v117 offset:38912
  s_waitcnt lgkmcnt(10)
  v_mfma_f32_32x32x16_bf16 v[128:143], v[240:243], v[32:35], 0
  ds_read_b64_tr_b16 v[104:105], v118 offset:36864
  ds_read_b64_tr_b16 v[106:107], v118 offset:38912
  ds_read_b32 v126, v20 offset:32
  v_mfma_f32_32x32x16_bf16 v[144:159], v[244:247], v[32:35], 0
  ds_read_b64_tr_b16 v[108:109], v119 offset:36864
  ds_read_b64_tr_b16 v[110:111], v119 offset:38912
  s_waitcnt lgkmcnt(11)
  v_mfma_f32_32x32x16_bf16 v[160:175], v[248:251], v[32:35], 0
  v_add_u32 v116, 0xfffe8000, v116
  ds_read_b64_tr_b16 v[80:81], v116 offset:0
  ds_read_b64_tr_b16 v[82:83], v116 offset:2048
  v_mfma_f32_32x32x16_bf16 v[176:191], v[252:255], v[32:35], 0
  v_add_u32 v117, 0xfffe8000, v117
  ds_read_b64_tr_b16 v[84:85], v117 offset:0
  ds_read_b64_tr_b16 v[86:87], v117 offset:2048
  s_waitcnt lgkmcnt(6)
  v_readfirstlane_b32 s14, v126
  s_nop 0
  s_cmp_eq_u32 s14, 0x01010101
  s_cbranch_scc0 L_sl28
L_bk29:
  v_and_b32 v124, 0x1f0, v1
  v_add_u32 v124, 0x26400, v124
  ds_read_b128 v[6:9], v124
  v_mfma_f32_32x32x16_bf16 v[128:143], v[96:99], v[36:39], v[128:143]
  v_add_u32 v118, 0xfffe8000, v118
  ds_read_b64_tr_b16 v[88:89], v118 offset:0
  ds_read_b64_tr_b16 v[90:91], v118 offset:2048
  v_mfma_f32_32x32x16_bf16 v[144:159], v[100:103], v[36:39], v[144:159]
  v_add_u32 v119, 0xfffe8000, v119
  ds_read_b64_tr_b16 v[92:93], v119 offset:0
  ds_read_b64_tr_b16 v[94:95], v119 offset:2048
  s_waitcnt lgkmcnt(4)
  v_add_f32 v6, v6, v7
  v_add_f32 v8, v8, v9
  v_mov_b32 v9, 0
  v_add_f32 v6, v6, v8
  v_cvt_pk_bf16_f32 v7, v6, 0
  v_lshlrev_b32 v8, 16, v7
  v_sub_f32 v6, v6, v8
  v_cvt_pk_bf16_f32 v6, v8, v6
  v_mfma_f32_32x32x16_bf16 v[160:175], v[104:107], v[36:39], v[160:175]
  ds_read_b64_tr_b16 v[240:241], v116 offset:4096
  ds_read_b64_tr_b16 v[242:243], v116 offset:6144
  v_mfma_f32_32x32x16_bf16 v[48:63], v[6:9], v[2:5], v[48:63]
  v_mfma_f32_32x32x16_bf16 v[176:191], v[108:111], v[36:39], v[176:191]
  ds_read_b64_tr_b16 v[244:245], v117 offset:4096
  ds_read_b64_tr_b16 v[246:247], v117 offset:6144
  v_mfma_f32_32x32x16_bf16 v[128:143], v[80:83], v[40:43], v[128:143]
  ds_read_b64_tr_b16 v[248:249], v118 offset:4096
  ds_read_b64_tr_b16 v[250:251], v118 offset:6144
  s_nop 5
  v_mul_f32 v48, v23, v48
  v_mul_f32 v49, v23, v49
  v_mul_f32 v50, v23, v50
  v_mul_f32 v51, v23, v51
  v_exp_f32 v28, v48
  v_exp_f32 v29, v49
  v_exp_f32 v30, v50
  v_mfma_f32_32x32x16_bf16 v[144:159], v[84:87], v[40:43], v[144:159]
  ds_read_b64_tr_b16 v[252:253], v119 offset:4096
  ds_read_b64_tr_b16 v[254:255], v119 offset:6144
  v_exp_f32 v31, v51
  v_add_f32 v28, 1.0, v28
  v_add_f32 v29, 1.0, v29
  v_add_f32 v30, 1.0, v30
  v_add_f32 v31, 1.0, v31
  v_rcp_f32 v28, v28
  s_waitcnt lgkmcnt(8)
  v_mfma_f32_32x32x16_bf16 v[160:175], v[88:91], v[40:43], v[160:175]
  ds_read_b64_tr_b16 v[96:97], v116 offset:8192
  ds_read_b64_tr_b16 v[98:99], v116 offset:10240
  v_rcp_f32 v29, v29
  v_rcp_f32 v30, v30
  v_rcp_f32 v31, v31
  v_mul_f32 v48, v48, v28
  v_mul_f32 v49, v49, v29
  v_mul_f32 v50, v50, v30
  v_mul_f32 v51, v51, v31
  v_mfma_f32_32x32x16_bf16 v[176:191], v[92:95], v[40:43], v[176:191]
  ds_read_b64_tr_b16 v[100:101], v117 offset:8192
  ds_read_b64_tr_b16 v[102:103], v117 offset:10240
  v_mul_f32 v52, v23, v52
  v_mul_f32 v53, v23, v53
  v_mul_f32 v54, v23, v54
  v_mul_f32 v55, v23, v55
  v_exp_f32 v28, v52
  v_exp_f32 v29, v53
  s_waitcnt lgkmcnt(8)
  v_mfma_f32_32x32x16_bf16 v[128:143], v[240:243], v[44:47], v[128:143]
  ds_read_b64_tr_b16 v[104:105], v118 offset:8192
  ds_read_b64_tr_b16 v[106:107], v118 offset:10240
  v_exp_f32 v30, v54
  v_exp_f32 v31, v55
  v_add_f32 v28, 1.0, v28
  v_add_f32 v29, 1.0, v29
  v_add_f32 v30, 1.0, v30
  v_add_f32 v31, 1.0, v31
  v_rcp_f32 v28, v28
  v_mfma_f32_32x32x16_bf16 v[144:159], v[244:247], v[44:47], v[144:159]
  ds_read_b64_tr_b16 v[108:109], v119 offset:8192
  ds_read_b64_tr_b16 v[110:111], v119 offset:10240
  v_rcp_f32 v29, v29
  v_rcp_f32 v30, v30
  v_rcp_f32 v31, v31
  v_mul_f32 v52, v52, v28
  v_mul_f32 v53, v53, v29
  v_mul_f32 v54, v54, v30
  s_waitcnt lgkmcnt(8)
  v_mfma_f32_32x32x16_bf16 v[160:175], v[248:251], v[44:47], v[160:175]
  ds_read_b64_tr_b16 v[80:81], v116 offset:12288
  ds_read_b64_tr_b16 v[82:83], v116 offset:14336
  v_mul_f32 v55, v55, v31
  v_cvt_pk_bf16_f32 v48, v48, v49
  v_cvt_pk_bf16_f32 v49, v50, v51
  v_cvt_pk_bf16_f32 v50, v52, v53
  v_cvt_pk_bf16_f32 v51, v54, v55
  buffer_store_dwordx4 v[48:51], v1, s[64:67], s81 offen offset:2048 sc1
  v_mfma_f32_32x32x16_bf16 v[176:191], v[252:255], v[44:47], v[176:191]
  ds_read_b64_tr_b16 v[84:85], v117 offset:12288
  ds_read_b64_tr_b16 v[86:87], v117 offset:14336
  v_mul_f32 v56, v23, v56
  v_mul_f32 v57, v23, v57
  v_mul_f32 v58, v23, v58
  v_mul_f32 v59, v23, v59
  v_exp_f32 v28, v56
  v_exp_f32 v29, v57
  v_exp_f32 v30, v58
  s_waitcnt lgkmcnt(8)
  v_mfma_f32_32x32x16_bf16 v[128:143], v[96:99], v[64:67], v[128:143]
  ds_read_b64_tr_b16 v[88:89], v118 offset:12288
  ds_read_b64_tr_b16 v[90:91], v118 offset:14336
  s_waitcnt vmcnt(1)
  buffer_store_dword v18, v19, s[28:31], s84 offen offset:32 sc1
  v_exp_f32 v31, v59
  v_add_f32 v28, 1.0, v28
  v_add_f32 v29, 1.0, v29
  v_add_f32 v30, 1.0, v30
  v_add_f32 v31, 1.0, v31
  v_rcp_f32 v28, v28
  v_mfma_f32_32x32x16_bf16 v[144:159], v[100:103], v[64:67], v[144:159]
  ds_read_b64_tr_b16 v[92:93], v119 offset:12288
  ds_read_b64_tr_b16 v[94:95], v119 offset:14336
  v_rcp_f32 v29, v29
  v_rcp_f32 v30, v30
  v_rcp_f32 v31, v31
  v_mul_f32 v56, v56, v28
  v_mul_f32 v57, v57, v29
  v_mul_f32 v58, v58, v30
  v_mul_f32 v59, v59, v31
  s_waitcnt lgkmcnt(8)
  v_mfma_f32_32x32x16_bf16 v[160:175], v[104:107], v[64:67], v[160:175]
  ds_read_b64_tr_b16 v[240:241], v116 offset:16384
  ds_read_b64_tr_b16 v[242:243], v116 offset:18432
  v_mul_f32 v60, v23, v60
  v_mul_f32 v61, v23, v61
  v_mul_f32 v62, v23, v62
  v_mul_f32 v63, v23, v63
  v_exp_f32 v28, v60
  v_exp_f32 v29, v61
  v_mfma_f32_32x32x16_bf16 v[176:191], v[108:111], v[64:67], v[176:191]
  ds_read_b64_tr_b16 v[244:245], v117 offset:16384
  ds_read_b64_tr_b16 v[246:247], v117 offset:18432
  v_exp_f32 v30, v62
  v_exp_f32 v31, v63
  v_add_f32 v28, 1.0, v28
  v_add_f32 v29, 1.0, v29
  v_add_f32 v30, 1.0, v30
  v_add_f32 v31, 1.0, v31
  v_rcp_f32 v28, v28
  s_waitcnt lgkmcnt(8)
  v_mfma_f32_32x32x16_bf16 v[128:143], v[80:83], v[68:71], v[128:143]
  ds_read_b64_tr_b16 v[248:249], v118 offset:16384
  ds_read_b64_tr_b16 v[250:251], v118 offset:18432
  v_rcp_f32 v29, v29
  v_rcp_f32 v30, v30
  v_rcp_f32 v31, v31
  v_mul_f32 v60, v60, v28
  v_mul_f32 v61, v61, v29
  v_mul_f32 v62, v62, v30
  v_mfma_f32_32x32x16_bf16 v[144:159], v[84:87], v[68:71], v[144:159]
  ds_read_b64_tr_b16 v[252:253], v119 offset:16384
  ds_read_b64_tr_b16 v[254:255], v119 offset:18432
  v_mul_f32 v63, v63, v31
  v_cvt_pk_bf16_f32 v52, v56, v57
  v_cvt_pk_bf16_f32 v53, v58, v59
  v_cvt_pk_bf16_f32 v54, v60, v61
  v_cvt_pk_bf16_f32 v55, v62, v63
  buffer_store_dwordx4 v[52:55], v1, s[64:67], s81 offen offset:3072 sc1
  s_waitcnt lgkmcnt(8)
  v_mfma_f32_32x32x16_bf16 v[160:175], v[88:91], v[68:71], v[160:175]
  ds_read_b64_tr_b16 v[96:97], v116 offset:20480
  ds_read_b64_tr_b16 v[98:99], v116 offset:22528
  ds_read_b32 v126, v20 offset:24
  v_mfma_f32_32x32x16_bf16 v[176:191], v[92:95], v[68:71], v[176:191]
  ds_read_b64_tr_b16 v[100:101], v117 offset:20480
  ds_read_b64_tr_b16 v[102:103], v117 offset:22528
  s_waitcnt lgkmcnt(9)
  v_mfma_f32_32x32x16_bf16 v[128:143], v[240:243], v[192:195], v[128:143]
  ds_read_b64_tr_b16 v[104:105], v118 offset:20480
  ds_read_b64_tr_b16 v[106:107], v118 offset:22528
  v_mfma_f32_32x32x16_bf16 v[144:159], v[244:247], v[192:195], v[144:159]
  ds_read_b64_tr_b16 v[108:109], v119 offset:20480
  ds_read_b64_tr_b16 v[110:111], v119 offset:22528
  s_waitcnt lgkmcnt(9)
  v_mfma_f32_32x32x16_bf16 v[160:175], v[248:251], v[192:195], v[160:175]
  s_waitcnt lgkmcnt(6)
  v_readfirstlane_b32 s14, v126
  s_nop 0
  s_cmp_eq_u32 s14, 0x01010101
  s_cbranch_scc0 L_sl19
L_bk20:
  ds_read_b64_tr_b16 v[80:81], v116 offset:24576
  ds_read_b64_tr_b16 v[82:83], v116 offset:26624
  v_mfma_f32_32x32x16_bf16 v[176:191], v[252:255], v[192:195], v[176:191]
  ds_read_b64_tr_b16 v[84:85], v117 offset:24576
  ds_read_b64_tr_b16 v[86:87], v117 offset:26624
  s_waitcnt lgkmcnt(8)
  v_mfma_f32_32x32x16_bf16 v[128:143], v[96:99], v[196:199], v[128:143]
  ds_read_b64_tr_b16 v[88:89], v118 offset:24576
  ds_read_b64_tr_b16 v[90:91], v118 offset:26624
  v_mfma_f32_32x32x16_bf16 v[144:159], v[100:103], v[196:199], v[144:159]
  ds_read_b64_tr_b16 v[92:93], v119 offset:24576
  ds_read_b64_tr_b16 v[94:95], v119 offset:26624
  s_waitcnt lgkmcnt(8)
  v_mfma_f32_32x32x16_bf16 v[160:175], v[104:107], v[196:199], v[160:175]
  ds_read_b64_tr_b16 v[240:241], v116 offset:28672
  ds_read_b64_tr_b16 v[242:243], v116 offset:30720
  v_mfma_f32_32x32x16_bf16 v[176:191], v[108:111], v[196:199], v[176:191]
  ds_read_b64_tr_b16 v[244:245], v117 offset:28672
  ds_read_b64_tr_b16 v[246:247], v117 offset:30720
  s_waitcnt lgkmcnt(8)
  v_mfma_f32_32x32x16_bf16 v[128:143], v[80:83], v[208:211], v[128:143]
  ds_read_b64_tr_b16 v[248:249], v118 offset:28672
  ds_read_b64_tr_b16 v[250:251], v118 offset:30720
  v_mfma_f32_32x32x16_bf16 v[144:159], v[84:87], v[208:211], v[144:159]
  ds_read_b64_tr_b16 v[252:253], v119 offset:28672
  ds_read_b64_tr_b16 v[254:255], v119 offset:30720
  s_waitcnt lgkmcnt(8)
  v_mfma_f32_32x32x16_bf16 v[160:175], v[88:91], v[208:211], v[160:175]
  ds_read_b64_tr_b16 v[96:97], v116 offset:32768
  ds_read_b64_tr_b16 v[98:99], v116 offset:34816
  ds_write_b8 v21, v24 offset:36
  v_mfma_f32_32x32x16_bf16 v[176:191], v[92:95], v[208:211], v[176:191]
  ds_read_b64_tr_b16 v[100:101], v117 offset:32768
  ds_read_b64_tr_b16 v[102:103], v117 offset:34816
  s_waitcnt lgkmcnt(9)
  v_mfma_f32_32x32x16_bf16 v[128:143], v[240:243], v[212:215], v[128:143]
  ds_read_b64_tr_b16 v[104:105], v118 offset:32768
  ds_read_b64_tr_b16 v[106:107], v118 offset:34816
  buffer_load_dword v27, v25, s[28:31], s83 offen sc1
  v_mfma_f32_32x32x16_bf16 v[144:159], v[244:247], v[212:215], v[144:159]
  ds_read_b64_tr_b16 v[108:109], v119 offset:32768
  ds_read_b64_tr_b16 v[110:111], v119 offset:34816
  s_waitcnt lgkmcnt(9)
  v_mfma_f32_32x32x16_bf16 v[160:175], v[248:251], v[212:215], v[160:175]
  ds_read_b64_tr_b16 v[80:81], v116 offset:36864
  ds_read_b64_tr_b16 v[82:83], v116 offset:38912
  v_mfma_f32_32x32x16_bf16 v[176:191], v[252:255], v[212:215], v[176:191]
  ds_read_b64_tr_b16 v[84:85], v117 offset:36864
  ds_read_b64_tr_b16 v[86:87], v117 offset:38912
  s_waitcnt lgkmcnt(8)
  v_mfma_f32_32x32x16_bf16 v[128:143], v[96:99], v[224:227], v[128:143]
  ds_read_b64_tr_b16 v[88:89], v118 offset:36864
  ds_read_b64_tr_b16 v[90:91], v118 offset:38912
  v_mfma_f32_32x32x16_bf16 v[144:159], v[100:103], v[224:227], v[144:159]
  ds_read_b64_tr_b16 v[92:93], v119 offset:36864
  ds_read_b64_tr_b16 v[94:95], v119 offset:38912
  s_waitcnt lgkmcnt(8)
  v_mfma_f32_32x32x16_bf16 v[160:175], v[104:107], v[224:227], v[160:175]
  ds_read_b64_tr_b16 v[240:241], v116 offset:40960
  ds_read_b64_tr_b16 v[242:243], v116 offset:43008
  v_mfma_f32_32x32x16_bf16 v[176:191], v[108:111], v[224:227], v[176:191]
  ds_read_b64_tr_b16 v[244:245], v117 offset:40960
  ds_read_b64_tr_b16 v[246:247], v117 offset:43008
  s_waitcnt lgkmcnt(8)
  v_mfma_f32_32x32x16_bf16 v[128:143], v[80:83], v[228:231], v[128:143]
  ds_read_b64_tr_b16 v[248:249], v118 offset:40960
  ds_read_b64_tr_b16 v[250:251], v118 offset:43008
  s_waitcnt vmcnt(1)
  buffer_store_dword v18, v19, s[64:67], s84 offen offset:48 sc1
  s_waitcnt vmcnt(1)
  v_cmp_eq_u32 vcc, s12, v27
  s_lshl_b32 s15, s85, 8
  s_and_b32 s14, vcc_lo, s15
  s_cmp_eq_u32 s14, s15
  s_cbranch_scc0 L_sl31
L_bk32:
  v_mfma_f32_32x32x16_bf16 v[144:159], v[84:87], v[228:231], v[144:159]
  ds_read_b64_tr_b16 v[252:253], v119 offset:40960
  ds_read_b64_tr_b16 v[254:255], v119 offset:43008
  buffer_load_dwordx4 v[32:35], v26, s[28:31], s88 offen offset:0 sc1
  s_waitcnt lgkmcnt(8)
  v_mfma_f32_32x32x16_bf16 v[160:175], v[88:91], v[228:231], v[160:175]
  ds_read_b64_tr_b16 v[96:97], v116 offset:45056
  ds_read_b64_tr_b16 v[98:99], v116 offset:47104
  v_mfma_f32_32x32x16_bf16 v[176:191], v[92:95], v[228:231], v[176:191]
  ds_read_b64_tr_b16 v[100:101], v117 offset:45056
  ds_read_b64_tr_b16 v[102:103], v117 offset:47104
  buffer_load_dwordx4 v[36:39], v26, s[28:31], s88 offen offset:1024 sc1
  s_waitcnt lgkmcnt(8)
  v_mfma_f32_32x32x16_bf16 v[128:143], v[240:243], v[200:203], v[128:143]
  ds_read_b64_tr_b16 v[104:105], v118 offset:45056
  ds_read_b64_tr_b16 v[106:107], v118 offset:47104
  v_mfma_f32_32x32x16_bf16 v[144:159], v[244:247], v[200:203], v[144:159]
  ds_read_b64_tr_b16 v[108:109], v119 offset:45056
  ds_read_b64_tr_b16 v[110:111], v119 offset:47104
  buffer_load_dwordx4 v[40:43], v26, s[28:31], s89 offen offset:0 sc1
  s_waitcnt lgkmcnt(8)
  v_mfma_f32_32x32x16_bf16 v[160:175], v[248:251], v[200:203], v[160:175]
  ds_read_b64_tr_b16 v[80:81], v116 offset:49152
  ds_read_b64_tr_b16 v[82:83], v116 offset:51200
  v_mfma_f32_32x32x16_bf16 v[176:191], v[252:255], v[200:203], v[176:191]
  ds_read_b64_tr_b16 v[84:85], v117 offset:49152
  ds_read_b64_tr_b16 v[86:87], v117 offset:51200
  buffer_load_dwordx4 v[44:47], v26, s[28:31], s89 offen offset:1024 sc1
  s_waitcnt lgkmcnt(8)
  v_mfma_f32_32x32x16_bf16 v[128:143], v[96:99], v[204:207], v[128:143]
  ds_read_b64_tr_b16 v[88:89], v118 offset:49152
  ds_read_b64_tr_b16 v[90:91], v118 offset:51200
  v_mfma_f32_32x32x16_bf16 v[144:159], v[100:103], v[204:207], v[144:159]
  ds_read_b64_tr_b16 v[92:93], v119 offset:49152
  ds_read_b64_tr_b16 v[94:95], v119 offset:51200
  buffer_load_dwordx4 v[72:75], v26, s[28:31], s90 offen offset:0 sc1
  s_waitcnt lgkmcnt(8)
  v_mfma_f32_32x32x16_bf16 v[160:175], v[104:107], v[204:207], v[160:175]
  ds_read_b64_tr_b16 v[240:241], v116 offset:53248
  ds_read_b64_tr_b16 v[242:243], v116 offset:55296
  v_mfma_f32_32x32x16_bf16 v[176:191], v[108:111], v[204:207], v[176:191]
  ds_read_b64_tr_b16 v[244:245], v117 offset:53248
  ds_read_b64_tr_b16 v[246:247], v117 offset:55296
  buffer_load_dwordx4 v[76:79], v26, s[28:31], s90 offen offset:1024 sc1
  s_waitcnt lgkmcnt(8)
  v_mfma_f32_32x32x16_bf16 v[128:143], v[80:83], v[216:219], v[128:143]
  ds_read_b64_tr_b16 v[248:249], v118 offset:53248
  ds_read_b64_tr_b16 v[250:251], v118 offset:55296
  v_mfma_f32_32x32x16_bf16 v[144:159], v[84:87], v[216:219], v[144:159]
  ds_read_b64_tr_b16 v[252:253], v119 offset:53248
  ds_read_b64_tr_b16 v[254:255], v119 offset:55296
  s_waitcnt lgkmcnt(8)
  v_mfma_f32_32x32x16_bf16 v[160:175], v[88:91], v[216:219], v[160:175]
  ds_read_b64_tr_b16 v[96:97], v116 offset:57344
  ds_read_b64_tr_b16 v[98:99], v116 offset:59392
  v_mfma_f32_32x32x16_bf16 v[176:191], v[92:95], v[216:219], v[176:191]
  ds_read_b64_tr_b16 v[100:101], v117 offset:57344
  ds_read_b64_tr_b16 v[102:103], v117 offset:59392
  s_waitcnt lgkmcnt(8)
  v_mfma_f32_32x32x16_bf16 v[128:143], v[240:243], v[220:223], v[128:143]
  ds_read_b64_tr_b16 v[104:105], v118 offset:57344
  ds_read_b64_tr_b16 v[106:107], v118 offset:59392
  v_mfma_f32_32x32x16_bf16 v[144:159], v[244:247], v[220:223], v[144:159]
  ds_read_b64_tr_b16 v[108:109], v119 offset:57344
  ds_read_b64_tr_b16 v[110:111], v119 offset:59392
  s_waitcnt lgkmcnt(8)
  v_mfma_f32_32x32x16_bf16 v[160:175], v[248:251], v[220:223], v[160:175]
  ds_read_b64_tr_b16 v[80:81], v116 offset:61440
  ds_read_b64_tr_b16 v[82:83], v116 offset:63488
  ds_read_b32 v126, v20 offset:44
  v_mfma_f32_32x32x16_bf16 v[176:191], v[252:255], v[220:223], v[176:191]
  ds_read_b64_tr_b16 v[84:85], v117 offset:61440
  ds_read_b64_tr_b16 v[86:87], v117 offset:63488
  s_waitcnt lgkmcnt(9)
  v_mfma_f32_32x32x16_bf16 v[128:143], v[96:99], v[232:235], v[128:143]
  ds_read_b64_tr_b16 v[88:89], v118 offset:61440
  ds_read_b64_tr_b16 v[90:91], v118 offset:63488
  v_mfma_f32_32x32x16_bf16 v[144:159], v[100:103], v[232:235], v[144:159]
  ds_read_b64_tr_b16 v[92:93], v119 offset:61440
  ds_read_b64_tr_b16 v[94:95], v119 offset:63488
  s_waitcnt lgkmcnt(9)
  v_mfma_f32_32x32x16_bf16 v[160:175], v[104:107], v[232:235], v[160:175]
  s_waitcnt lgkmcnt(6)
  v_readfirstlane_b32 s14, v126
  s_nop 0
  s_cmp_eq_u32 s14, 0x01010101
  s_cbranch_scc0 L_sl22
L_bk23:
  v_add_u32 v116, 0x18000, v116
  ds_read_b64_tr_b16 v[240:241], v116 offset:0
  ds_read_b64_tr_b16 v[242:243], v116 offset:2048
  ds_write_b8 v21, v24 offset:40
  v_mfma_f32_32x32x16_bf16 v[176:191], v[108:111], v[232:235], v[176:191]
  v_add_u32 v117, 0x18000, v117
  ds_read_b64_tr_b16 v[244:245], v117 offset:0
  ds_read_b64_tr_b16 v[246:247], v117 offset:2048
  s_waitcnt lgkmcnt(9)
  v_mfma_f32_32x32x16_bf16 v[128:143], v[80:83], v[236:239], v[128:143]
  v_add_u32 v118, 0x18000, v118
  ds_read_b64_tr_b16 v[248:249], v118 offset:0
  ds_read_b64_tr_b16 v[250:251], v118 offset:2048
  v_mfma_f32_32x32x16_bf16 v[144:159], v[84:87], v[236:239], v[144:159]
  v_add_u32 v119, 0x18000, v119
  ds_read_b64_tr_b16 v[252:253], v119 offset:0
  ds_read_b64_tr_b16 v[254:255], v119 offset:2048
  s_waitcnt lgkmcnt(9)
  v_mfma_f32_32x32x16_bf16 v[160:175], v[88:91], v[236:239], v[160:175]
  ds_read_b64_tr_b16 v[96:97], v116 offset:4096
  ds_read_b64_tr_b16 v[98:99], v116 offset:6144
  buffer_load_dword v27, v25, s[28:31], s83 offen sc1
  v_mfma_f32_32x32x16_bf16 v[176:191], v[92:95], v[236:239], v[176:191]
  ds_read_b64_tr_b16 v[100:101], v117 offset:4096
  ds_read_b64_tr_b16 v[102:103], v117 offset:6144
  s_waitcnt lgkmcnt(8)
  s_waitcnt vmcnt(6)
  v_mfma_f32_32x32x16_bf16 v[128:143], v[240:243], v[32:35], v[128:143]
  ds_read_b64_tr_b16 v[104:105], v118 offset:4096
  ds_read_b64_tr_b16 v[106:107], v118 offset:6144
  ds_read_b32 v29, v20 offset:40
  s_lshl_b32 s86, s4, 12
  v_add_u32 v124, s86, v1
  v_add_u32 v125, 0x22000, v124
  v_mfma_f32_32x32x16_bf16 v[144:159], v[244:247], v[32:35], v[144:159]
  ds_read_b64_tr_b16 v[108:109], v119 offset:4096
  ds_read_b64_tr_b16 v[110:111], v119 offset:6144
  s_waitcnt lgkmcnt(9)
  v_mfma_f32_32x32x16_bf16 v[160:175], v[248:251], v[32:35], v[160:175]
  ds_read_b64_tr_b16 v[80:81], v116 offset:8192
  ds_read_b64_tr_b16 v[82:83], v116 offset:10240
  v_mfma_f32_32x32x16_bf16 v[176:191], v[252:255], v[32:35], v[176:191]
  ds_read_b64_tr_b16 v[84:85], v117 offset:8192
  ds_read_b64_tr_b16 v[86:87], v117 offset:10240
  s_waitcnt lgkmcnt(6)
  v_readfirstlane_b32 s14, v29
  s_nop 0
  s_cmp_eq_u32 s14, 0x01010101
  s_cbranch_scc0 L_sl37
L_bk38:
  s_waitcnt vmcnt(5)
  v_mfma_f32_32x32x16_bf16 v[128:143], v[96:99], v[36:39], v[128:143]
  ds_read_b64_tr_b16 v[88:89], v118 offset:8192
  ds_read_b64_tr_b16 v[90:91], v118 offset:10240
  v_mfma_f32_32x32x16_bf16 v[144:159], v[100:103], v[36:39], v[144:159]
  ds_read_b64_tr_b16 v[92:93], v119 offset:8192
  ds_read_b64_tr_b16 v[94:95], v119 offset:10240
  s_waitcnt lgkmcnt(8)
  v_mfma_f32_32x32x16_bf16 v[160:175], v[104:107], v[36:39], v[160:175]
  ds_read_b64_tr_b16 v[240:241], v116 offset:12288
  ds_read_b64_tr_b16 v[242:243], v116 offset:14336
  v_mfma_f32_32x32x16_bf16 v[176:191], v[108:111], v[36:39], v[176:191]
  ds_read_b64_tr_b16 v[244:245], v117 offset:12288
  ds_read_b64_tr_b16 v[246:247], v117 offset:14336
  s_waitcnt lgkmcnt(8)
  s_waitcnt vmcnt(4)
  v_mfma_f32_32x32x16_bf16 v[128:143], v[80:83], v[40:43], v[128:143]
  ds_read_b64_tr_b16 v[248:249], v118 offset:12288
  ds_read_b64_tr_b16 v[250:251], v118 offset:14336
  s_waitcnt vmcnt(0)
  v_cmp_eq_u32 vcc, s12, v27
  s_mov_b32 s15, 0x3000
  s_and_b32 s14, vcc_lo, s15
  s_cmp_eq_u32 s14, s15
  s_cbranch_scc0 L_sl34
L_bk35:
  v_mfma_f32_32x32x16_bf16 v[144:159], v[84:87], v[40:43], v[144:159]
  ds_read_b64_tr_b16 v[252:253], v119 offset:12288
  ds_read_b64_tr_b16 v[254:255], v119 offset:14336
  buffer_load_dwordx4 v[48:51], v26, s[28:31], s79 offen offset:2048 sc1
  s_waitcnt lgkmcnt(8)
  v_mfma_f32_32x32x16_bf16 v[160:175], v[88:91], v[40:43], v[160:175]
  ds_read_b64_tr_b16 v[96:97], v116 offset:16384
  ds_read_b64_tr_b16 v[98:99], v116 offset:18432
  v_mfma_f32_32x32x16_bf16 v[176:191], v[92:95], v[40:43], v[176:191]
  ds_read_b64_tr_b16 v[100:101], v117 offset:16384
  ds_read_b64_tr_b16 v[102:103], v117 offset:18432
  buffer_load_dwordx4 v[52:55], v26, s[28:31], s79 offen offset:3072 sc1
  s_waitcnt lgkmcnt(8)
  v_mfma_f32_32x32x16_bf16 v[128:143], v[240:243], v[44:47], v[128:143]
  ds_read_b64_tr_b16 v[104:105], v118 offset:16384
  ds_read_b64_tr_b16 v[106:107], v118 offset:18432
  v_mfma_f32_32x32x16_bf16 v[144:159], v[244:247], v[44:47], v[144:159]
  ds_read_b64_tr_b16 v[108:109], v119 offset:16384
  ds_read_b64_tr_b16 v[110:111], v119 offset:18432
  buffer_load_dwordx4 v[56:59], v26, s[28:31], s91 offen offset:2048 sc1
  s_waitcnt lgkmcnt(8)
  v_mfma_f32_32x32x16_bf16 v[160:175], v[248:251], v[44:47], v[160:175]
  ds_read_b64_tr_b16 v[80:81], v116 offset:20480
  ds_read_b64_tr_b16 v[82:83], v116 offset:22528
  v_mfma_f32_32x32x16_bf16 v[176:191], v[252:255], v[44:47], v[176:191]
  ds_read_b64_tr_b16 v[84:85], v117 offset:20480
  ds_read_b64_tr_b16 v[86:87], v117 offset:22528
  buffer_load_dwordx4 v[60:63], v26, s[28:31], s91 offen offset:3072 sc1
  s_waitcnt lgkmcnt(8)
  v_mfma_f32_32x32x16_bf16 v[128:143], v[96:99], v[72:75], v[128:143]
  ds_read_b64_tr_b16 v[88:89], v118 offset:20480
  ds_read_b64_tr_b16 v[90:91], v118 offset:22528
  ds_read_b32 v126, v20 offset:48
  v_mfma_f32_32x32x16_bf16 v[144:159], v[100:103], v[72:75], v[144:159]
  ds_read_b64_tr_b16 v[92:93], v119 offset:20480
  ds_read_b64_tr_b16 v[94:95], v119 offset:22528
  s_waitcnt lgkmcnt(9)
  v_mfma_f32_32x32x16_bf16 v[160:175], v[104:107], v[72:75], v[160:175]
  ds_read_b64_tr_b16 v[240:241], v116 offset:24576
  ds_read_b64_tr_b16 v[242:243], v116 offset:26624
  v_mfma_f32_32x32x16_bf16 v[176:191], v[108:111], v[72:75], v[176:191]
  ds_read_b64_tr_b16 v[244:245], v116 offset:28672
  ds_read_b64_tr_b16 v[246:247], v116 offset:30720
  s_waitcnt lgkmcnt(9)
  v_mfma_f32_32x32x16_bf16 v[128:143], v[80:83], v[76:79], v[128:143]
  s_waitcnt lgkmcnt(6)
  v_readfirstlane_b32 s14, v126
  s_nop 0
  s_cmp_eq_u32 s14, 0x01010101
  s_cbranch_scc0 L_sl25
L_bk26:
  ds_read_b64_tr_b16 v[248:249], v116 offset:32768
  ds_read_b64_tr_b16 v[250:251], v116 offset:34816
  v_mfma_f32_32x32x16_bf16 v[144:159], v[84:87], v[76:79], v[144:159]
  ds_read_b64_tr_b16 v[252:253], v116 offset:36864
  ds_read_b64_tr_b16 v[254:255], v116 offset:38912
  s_waitcnt lgkmcnt(8)
  v_mfma_f32_32x32x16_bf16 v[160:175], v[88:91], v[76:79], v[160:175]
  ds_read_b64_tr_b16 v[96:97], v117 offset:24576
  ds_read_b64_tr_b16 v[98:99], v117 offset:26624
  v_mfma_f32_32x32x16_bf16 v[176:191], v[92:95], v[76:79], v[176:191]
  ds_read_b64_tr_b16 v[100:101], v117 offset:28672
  ds_read_b64_tr_b16 v[102:103], v117 offset:30720
  s_waitcnt lgkmcnt(8)
  s_waitcnt vmcnt(3)
  v_mfma_f32_32x32x16_bf16 v[128:143], v[240:243], v[48:51], v[128:143]
  ds_read_b64_tr_b16 v[104:105], v117 offset:32768
  ds_read_b64_tr_b16 v[106:107], v117 offset:34816
  s_waitcnt vmcnt(2)
  v_mfma_f32_32x32x16_bf16 v[128:143], v[244:247], v[52:55], v[128:143]
  ds_read_b64_tr_b16 v[108:109], v117 offset:36864
  ds_read_b64_tr_b16 v[110:111], v117 offset:38912
  s_waitcnt lgkmcnt(8)
  s_waitcnt vmcnt(1)
  v_mfma_f32_32x32x16_bf16 v[128:143], v[248:251], v[56:59], v[128:143]
  ds_read_b64_tr_b16 v[80:81], v118 offset:24576
  ds_read_b64_tr_b16 v[82:83], v118 offset:26624
  s_waitcnt vmcnt(0)
  v_mfma_f32_32x32x16_bf16 v[128:143], v[252:255], v[60:63], v[128:143]
  ds_read_b64_tr_b16 v[84:85], v118 offset:28672
  ds_read_b64_tr_b16 v[86:87], v118 offset:30720
  s_waitcnt lgkmcnt(8)
  v_mfma_f32_32x32x16_bf16 v[144:159], v[96:99], v[48:51], v[144:159]
  ds_read_b64_tr_b16 v[88:89], v118 offset:32768
  ds_read_b64_tr_b16 v[90:91], v118 offset:34816
  v_mfma_f32_32x32x16_bf16 v[144:159], v[100:103], v[52:55], v[144:159]
  ds_read_b64_tr_b16 v[92:93], v118 offset:36864
  ds_read_b64_tr_b16 v[94:95], v118 offset:38912
  s_nop 2
  ds_write_b128 v124, v[128:131] offset:32768
  ds_write_b128 v124, v[132:135] offset:33792
  ds_write_b128 v124, v[136:139] offset:34816
  ds_write_b128 v124, v[140:143] offset:35840
  ds_write_b8 v21, v24 offset:68
  s_waitcnt lgkmcnt(13)
  v_mfma_f32_32x32x16_bf16 v[144:159], v[104:107], v[56:59], v[144:159]
  ds_read_b64_tr_b16 v[240:241], v119 offset:24576
  ds_read_b64_tr_b16 v[242:243], v119 offset:26624
  v_mfma_f32_32x32x16_bf16 v[144:159], v[108:111], v[60:63], v[144:159]
  ds_read_b64_tr_b16 v[244:245], v119 offset:28672
  ds_read_b64_tr_b16 v[246:247], v119 offset:30720
  s_waitcnt lgkmcnt(13)
  v_mfma_f32_32x32x16_bf16 v[160:175], v[80:83], v[48:51], v[160:175]
  ds_read_b64_tr_b16 v[248:249], v119 offset:32768
  ds_read_b64_tr_b16 v[250:251], v119 offset:34816
  v_mfma_f32_32x32x16_bf16 v[160:175], v[84:87], v[52:55], v[160:175]
  ds_read_b64_tr_b16 v[252:253], v119 offset:36864
  ds_read_b64_tr_b16 v[254:255], v119 offset:38912
  s_nop 2
  ds_write_b128 v124, v[144:147] offset:49152
  ds_write_b128 v124, v[148:151] offset:50176
  ds_write_b128 v124, v[152:155] offset:51200
  ds_write_b128 v124, v[156:159] offset:52224
  ds_write_b8 v21, v24 offset:72
  ds_read_b32 v28, v20 offset:60
  s_waitcnt lgkmcnt(15)
  v_mfma_f32_32x32x16_bf16 v[160:175], v[88:91], v[56:59], v[160:175]
  v_mfma_f32_32x32x16_bf16 v[160:175], v[92:95], v[60:63], v[160:175]
  s_waitcnt lgkmcnt(10)
  v_mfma_f32_32x32x16_bf16 v[176:191], v[240:243], v[48:51], v[176:191]
  v_mfma_f32_32x32x16_bf16 v[176:191], v[244:247], v[52:55], v[176:191]
  s_waitcnt lgkmcnt(0)
  v_readfirstlane_b32 s14, v28
  s_nop 0
  s_bitcmp1_b32 s14, s101
  s_cbranch_scc0 L_sl40
L_bk41:
  s_nop 3
  ds_write_b128 v125, v[160:163] offset:0
  ds_write_b128 v125, v[164:167] offset:1024
  ds_write_b128 v125, v[168:171] offset:2048
  ds_write_b128 v125, v[172:175] offset:3072
  ds_write_b8 v21, v24 offset:76
  ds_read_b32 v28, v20 offset:64
  v_mfma_f32_32x32x16_bf16 v[176:191], v[248:251], v[56:59], v[176:191]
  v_mfma_f32_32x32x16_bf16 v[176:191], v[252:255], v[60:63], v[176:191]
  s_waitcnt lgkmcnt(0)
  v_readfirstlane_b32 s14, v28
  s_nop 0
  s_bitcmp1_b32 s14, s101
  s_cbranch_scc0 L_sl43
L_bk44:
  s_nop 6
  ds_write_b128 v124, v[176:179] offset:32768
  ds_write_b128 v124, v[180:183] offset:33792
  ds_write_b128 v124, v[184:187] offset:34816
  ds_write_b128 v124, v[188:191] offset:35840
  ds_write_b8 v21, v24 offset:80
  s_endpgm
L_Yslow:
  s_waitcnt lgkmcnt(0)
  v_readfirstlane_b32 s14, v74
  v_readfirstlane_b32 s15, v75
  s_nop 0
  s_and_b32 s14, s14, s15
  s_cmp_eq_u32 s14, 0x01010101
  s_cbranch_scc0 L_sl63
L_bk64:
  ds_read_b128 v[72:75], v148
  ds_read_b128 v[76:79], v148 offset:16
  ds_read_b32 v5, v20 offset:28
  s_waitcnt lgkmcnt(2)
  v_add_f32 v72, v72, v74
  v_add_f32 v73, v73, v75
  s_waitcnt lgkmcnt(1)
  v_add_f32 v76, v76, v78
  v_add_f32 v77, v77, v79
  v_add_f32 v72, v72, v76
  v_add_f32 v73, v73, v77
  v_fmac_f32 v120, v28, v72
  s_waitcnt lgkmcnt(0)
  v_readfirstlane_b32 s14, v5
  s_nop 0
  s_cmp_eq_u32 s14, 0x01010101
  s_cbranch_scc0 L_sl60
L_bk61:
  s_add_u32 m0, s71, 98304
  s_xor_b32 s86, s9, 1
  s_lshl_b32 s87, s86, 17
  s_add_u32 s87, s87, 0x10000
  s_lshl_b32 s74, s86, 15
  s_add_u32 s74, s74, 0x40000
  s_cmp_ge_u32 s86, 2
  s_cselect_b32 s87, s74, s87
  s_add_u32 s87, s87, s70
  buffer_load_dwordx4 v144, s[32:35], s87 offen lds
  v_fmac_f32 v121, v28, v73
  v_fma_f32 v120, -v29, v73, v120
  v_fmac_f32 v121, v29, v72
  v_mul_f32 v72, v30, v120
  v_mul_f32 v73, v30, v121
  v_fma_f32 v72, -v31, v121, v72
  v_fmac_f32 v73, v31, v120
  s_add_u32 m0, s71, 102400
  s_add_u32 s87, s87, 0x4000
  buffer_load_dwordx4 v144, s[32:35], s87 offen lds
  v_fmac_f32 v32, v15, v72
  v_fmac_f32 v48, v15, v73
  v_fmac_f32 v32, v17, v73
  v_fmac_f32 v48, v16, v72
  v_fmac_f32 v33, v15, v32
  v_fmac_f32 v49, v15, v48
  v_fmac_f32 v33, v17, v48
  v_fmac_f32 v49, v16, v32
  s_add_u32 m0, s71, 106496
  s_xor_b32 s86, s9, 2
  s_lshl_b32 s87, s86, 17
  s_add_u32 s87, s87, 0x10000
  s_lshl_b32 s74, s86, 15
  s_add_u32 s74, s74, 0x40000
  s_cmp_ge_u32 s86, 2
  s_cselect_b32 s87, s74, s87
  s_add_u32 s87, s87, s70
  buffer_load_dwordx4 v144, s[32:35], s87 offen lds
  v_cvt_pk_bf16_f32 v128, v32, v33
  v_cvt_pk_bf16_f32 v136, -v48, -v49
  v_fmac_f32 v34, v15, v33
  v_fmac_f32 v50, v15, v49
  v_fmac_f32 v34, v17, v49
  v_fmac_f32 v50, v16, v33
  v_fmac_f32 v35, v15, v34
  v_fmac_f32 v51, v15, v50
  s_add_u32 m0, s71, 110592
  s_add_u32 s87, s87, 0x4000
  buffer_load_dwordx4 v144, s[32:35], s87 offen lds
  v_fmac_f32 v35, v17, v50
  v_fmac_f32 v51, v16, v34
  v_cvt_pk_bf16_f32 v129, v34, v35
  v_cvt_pk_bf16_f32 v137, -v50, -v51
  v_fmac_f32 v36, v15, v35
  v_fmac_f32 v52, v15, v51
  v_fmac_f32 v36, v17, v51
  v_fmac_f32 v52, v16, v35
  s_add_u32 m0, s71, 114688
  s_xor_b32 s86, s9, 3
  s_lshl_b32 s87, s86, 17
  s_add_u32 s87, s87, 0x10000
  s_lshl_b32 s74, s86, 15
  s_add_u32 s74, s74, 0x40000
  s_cmp_ge_u32 s86, 2
  s_cselect_b32 s87, s74, s87
  s_add_u32 s87, s87, s70
  buffer_load_dwordx4 v144, s[32:35], s87 offen lds
  v_fmac_f32 v37, v15, v36
  v_fmac_f32 v53, v15, v52
  v_fmac_f32 v37, v17, v52
  v_fmac_f32 v53, v16, v36
  v_cvt_pk_bf16_f32 v130, v36, v37
  v_cvt_pk_bf16_f32 v138, -v52, -v53
  v_fmac_f32 v38, v15, v37
  s_add_u32 m0, s71, 118784
  s_add_u32 s87, s87, 0x4000
  buffer_load_dwordx4 v144, s[32:35], s87 offen lds
  v_fmac_f32 v54, v15, v53
  v_fmac_f32 v38, v17, v53
  v_fmac_f32 v54, v16, v37
  v_fmac_f32 v39, v15, v38
  v_fmac_f32 v55, v15, v54
  v_fmac_f32 v39, v17, v54
  v_fmac_f32 v55, v16, v38
  v_cvt_pk_bf16_f32 v131, v38, v39
  s_add_u32 m0, s71, 122880
  s_add_u32 s87, s70, 0x18000
  buffer_load_dwordx4 v144, s[32:35], s87 offen lds
  v_cvt_pk_bf16_f32 v139, -v54, -v55
  ds_write_b128 v150, v[128:131]
  ds_write_b128 v150, v[136:139] offset:2048
  v_fmac_f32 v40, v15, v39
  v_fmac_f32 v56, v15, v55
  v_fmac_f32 v40, v17, v55
  v_fmac_f32 v56, v16, v39
  v_fmac_f32 v41, v15, v40
  s_add_u32 m0, s71, 126976
  s_add_u32 s87, s70, 0x1c000
  buffer_load_dwordx4 v144, s[32:35], s87 offen lds
  v_fmac_f32 v57, v15, v56
  v_fmac_f32 v41, v17, v56
  v_fmac_f32 v57, v16, v40
  v_cvt_pk_bf16_f32 v132, v40, v41
  v_cvt_pk_bf16_f32 v140, -v56, -v57
  v_fmac_f32 v42, v15, v41
  v_fmac_f32 v58, v15, v57
  v_fmac_f32 v42, v17, v57
  v_fmac_f32 v58, v16, v41
  v_fmac_f32 v43, v15, v42
  v_fmac_f32 v59, v15, v58
  v_fmac_f32 v43, v17, v58
  v_fmac_f32 v59, v16, v42
  v_cvt_pk_bf16_f32 v133, v42, v43
  v_cvt_pk_bf16_f32 v141, -v58, -v59
  v_fmac_f32 v44, v15, v43
  v_fmac_f32 v60, v15, v59
  v_fmac_f32 v44, v17, v59
  v_fmac_f32 v60, v16, v43
  v_fmac_f32 v45, v15, v44
  v_fmac_f32 v61, v15, v60
  v_fmac_f32 v45, v17, v60
  v_fmac_f32 v61, v16, v44
  v_cvt_pk_bf16_f32 v134, v44, v45
  v_cvt_pk_bf16_f32 v142, -v60, -v61
  v_fmac_f32 v46, v15, v45
  v_fmac_f32 v62, v15, v61
  v_fmac_f32 v46, v17, v61
  v_fmac_f32 v62, v16, v45
  v_fmac_f32 v47, v15, v46
  v_fmac_f32 v63, v15, v62
  v_fmac_f32 v47, v17, v62
  v_fmac_f32 v63, v16, v46
  v_cvt_pk_bf16_f32 v135, v46, v47
  v_cvt_pk_bf16_f32 v143, -v62, -v63
  ds_read_b32 v126, v20 offset:32
  ds_write_b128 v151, v[132:135]
  ds_write_b128 v151, v[140:143] offset:2048
  ds_read_b64_tr_b16 v[104:105], v152 offset:0
  ds_read_b64_tr_b16 v[106:107], v153 offset:0
  ds_read_b64_tr_b16 v[108:109], v152 offset:1024
  ds_read_b64_tr_b16 v[110:111], v153 offset:1024
  ds_read_b64_tr_b16 v[112:113], v152 offset:2048
  ds_read_b64_tr_b16 v[114:115], v153 offset:2048
  ds_read_b64_tr_b16 v[116:117], v152 offset:3072
  ds_read_b64_tr_b16 v[118:119], v153 offset:3072
  ds_write_b8 v21, v122 offset:60
  s_add_u32 s82, s80, 0x800000
  s_add_u32 s95, s80, 0x1000000
  s_xor_b32 s51, s95, 0x20000
  s_xor_b32 s88, s82, 8192
  s_xor_b32 s89, s82, 16384
  s_xor_b32 s90, s82, 24576
  s_waitcnt lgkmcnt(11)
  v_readfirstlane_b32 s14, v126
  s_nop 0
  s_cmp_eq_u32 s14, 0x01010101
  s_cbranch_scc0 L_sl69
L_bk70:
  s_add_u32 m0, s76, 65536
  s_add_u32 s87, s91, 0
  buffer_load_dwordx4 v154, s[36:39], s87 offen lds
  s_add_u32 m0, s76, 66560
  s_add_u32 s87, s91, 0
  buffer_load_dwordx4 v155, s[36:39], s87 offen lds
  s_add_u32 m0, s76, 67584
  s_add_u32 s87, s91, 16384
  buffer_load_dwordx4 v154, s[36:39], s87 offen lds
  s_add_u32 m0, s76, 68608
  s_add_u32 s87, s91, 16384
  buffer_load_dwordx4 v155, s[36:39], s87 offen lds
  s_add_u32 m0, s76, 81920
  s_add_u32 s87, s91, 0
  buffer_load_dwordx4 v154, s[40:43], s87 offen lds
  s_add_u32 m0, s76, 82944
  s_add_u32 s87, s91, 0
  buffer_load_dwordx4 v155, s[40:43], s87 offen lds
  s_add_u32 m0, s76, 83968
  s_add_u32 s87, s91, 16384
  buffer_load_dwordx4 v154, s[40:43], s87 offen lds
  s_add_u32 m0, s76, 84992
  s_add_u32 s87, s91, 16384
  buffer_load_dwordx4 v155, s[40:43], s87 offen lds
  s_waitcnt lgkmcnt(7)
  buffer_store_dwordx4 v[104:107], v1, s[28:31], s82 offen offset:0 sc1
  s_waitcnt lgkmcnt(5)
  buffer_store_dwordx4 v[108:111], v1, s[28:31], s82 offen offset:1024 sc1
  s_waitcnt lgkmcnt(3)
  buffer_store_dwordx4 v[112:115], v1, s[28:31], s82 offen offset:2048 sc1
  s_waitcnt lgkmcnt(1)
  buffer_store_dwordx4 v[116:119], v1, s[28:31], s82 offen offset:3072 sc1
  ds_read_b32 v5, v20 offset:36
  s_waitcnt vmcnt(0)
  buffer_store_dword v18, v19, s[28:31], s84 offen offset:64 sc1
  ds_write_b8 v21, v122 offset:44
  ds_write_b8 v21, v122 offset:52
  ds_read_b32 v4, v20 offset:52
  s_waitcnt lgkmcnt(3)
  v_readfirstlane_b32 s14, v5
  s_nop 0
  s_cmp_eq_u32 s14, 0x01010101
  s_cbranch_scc0 L_sl72
L_bk73:
  s_add_u32 m0, s71, 131072
  s_add_u32 s87, s70, 0x38000
  buffer_load_dwordx4 v144, s[32:35], s87 offen lds
  s_add_u32 m0, s71, 135168
  s_add_u32 s87, s70, 0x3c000
  buffer_load_dwordx4 v144, s[32:35], s87 offen lds
  s_waitcnt lgkmcnt(0)
  v_readfirstlane_b32 s14, v4
  s_nop 0
  s_cmp_eq_u32 s14, 0x01010101
  s_cbranch_scc0 L_sl75
L_bk76:
  ds_read_b128 v[80:83], v172 offset:0
  ds_read_b128 v[84:87], v8 offset:0
  ds_read_b128 v[88:91], v174 offset:0
  ds_read_b128 v[92:95], v176 offset:0
  ds_read_b128 v[96:99], v172 offset:16384
  s_waitcnt lgkmcnt(4)
  v_mfma_f32_32x32x16_bf16 v[192:207], v[80:83], v[104:107], 0
  ds_read_b128 v[100:103], v8 offset:16384
  s_add_u32 m0, s76, 0
  s_add_u32 s87, s92, 0
  buffer_load_dwordx4 v154, s[36:39], s87 offen lds
  s_add_u32 m0, s76, 1024
  s_add_u32 s87, s92, 0
  buffer_load_dwordx4 v155, s[36:39], s87 offen lds
  s_waitcnt lgkmcnt(4)
  v_mfma_f32_32x32x16_bf16 v[208:223], v[84:87], v[104:107], 0
  ds_read_b128 v[80:83], v174 offset:16384
  s_add_u32 m0, s76, 2048
  s_add_u32 s87, s92, 16384
  buffer_load_dwordx4 v154, s[36:39], s87 offen lds
  s_add_u32 m0, s76, 3072
  s_add_u32 s87, s92, 16384
  buffer_load_dwordx4 v155, s[36:39], s87 offen lds
  s_waitcnt lgkmcnt(4)
  v_mfma_f32_32x32x16_bf16 v[224:239], v[88:91], v[104:107], 0
  ds_read_b128 v[84:87], v176 offset:16384
  s_add_u32 m0, s76, 16384
  s_add_u32 s87, s92, 0
  buffer_load_dwordx4 v154, s[40:43], s87 offen lds
  s_add_u32 m0, s76, 17408
  s_add_u32 s87, s92, 0
  buffer_load_dwordx4 v155, s[40:43], s87 offen lds
  s_waitcnt lgkmcnt(4)
  v_mfma_f32_32x32x16_bf16 v[240:255], v[92:95], v[104:107], 0
  ds_read_b128 v[88:91], v173 offset:0
  s_add_u32 m0, s76, 18432
  s_add_u32 s87, s92, 16384
  buffer_load_dwordx4 v154, s[40:43], s87 offen lds
  s_add_u32 m0, s76, 19456
  s_add_u32 s87, s92, 16384
  buffer_load_dwordx4 v155, s[40:43], s87 offen lds
  s_waitcnt lgkmcnt(4)
  v_mfma_f32_32x32x16_bf16 v[192:207], v[96:99], v[112:115], v[192:207]
  ds_read_b128 v[92:95], v9 offset:0
  buffer_load_dword v157, v156, s[28:31], s83 offen sc1
  s_waitcnt lgkmcnt(4)
  v_mfma_f32_32x32x16_bf16 v[208:223], v[100:103], v[112:115], v[208:223]
  ds_read_b128 v[96:99], v175 offset:0
  s_waitcnt lgkmcnt(4)
  v_mfma_f32_32x32x16_bf16 v[224:239], v[80:83], v[112:115], v[224:239]
  ds_read_b128 v[100:103], v177 offset:0
  s_waitcnt vmcnt(9)
  ds_write_b8 v21, v122 offset:48
  s_waitcnt lgkmcnt(5)
  v_mfma_f32_32x32x16_bf16 v[240:255], v[84:87], v[112:115], v[240:255]
  ds_read_b128 v[80:83], v173 offset:16384
  s_waitcnt lgkmcnt(5)
  v_mfma_f32_32x32x16_bf16 v[192:207], v[88:91], v[108:111], v[192:207]
  ds_read_b128 v[84:87], v9 offset:16384
  s_waitcnt lgkmcnt(5)
  v_mfma_f32_32x32x16_bf16 v[208:223], v[92:95], v[108:111], v[208:223]
  ds_read_b128 v[88:91], v175 offset:16384
  s_waitcnt lgkmcnt(5)
  v_mfma_f32_32x32x16_bf16 v[224:239], v[96:99], v[108:111], v[224:239]
  ds_read_b128 v[92:95], v177 offset:16384
  s_waitcnt vmcnt(0)
  v_cmp_eq_u32 vcc, s12, v157
  s_lshl_b32 s15, s85, 16
  s_and_b32 s14, vcc_lo, s15
  s_cmp_eq_u32 s14, s15
  s_cbranch_scc0 L_sl84
L_bk85:
  ds_write_b8 v21, v122 offset:56
  buffer_load_dwordx4 v[32:35], v1, s[28:31], s88 offen offset:0 sc1
  buffer_load_dwordx4 v[36:39], v1, s[28:31], s88 offen offset:1024 sc1
  buffer_load_dwordx4 v[48:51], v1, s[28:31], s89 offen offset:0 sc1
  buffer_load_dwordx4 v[52:55], v1, s[28:31], s89 offen offset:1024 sc1
  buffer_load_dwordx4 v[64:67], v1, s[28:31], s90 offen offset:0 sc1
  buffer_load_dwordx4 v[68:71], v1, s[28:31], s90 offen offset:1024 sc1
  buffer_load_dwordx4 v[40:43], v1, s[28:31], s88 offen offset:2048 sc1
  buffer_load_dwordx4 v[44:47], v1, s[28:31], s88 offen offset:3072 sc1
  buffer_load_dwordx4 v[56:59], v1, s[28:31], s89 offen offset:2048 sc1
  buffer_load_dwordx4 v[60:63], v1, s[28:31], s89 offen offset:3072 sc1
  buffer_load_dwordx4 v[72:75], v1, s[28:31], s90 offen offset:2048 sc1
  buffer_load_dwordx4 v[76:79], v1, s[28:31], s90 offen offset:3072 sc1
  ds_read_b32 v4, v20 offset:56
  s_waitcnt lgkmcnt(7)
  v_mfma_f32_32x32x16_bf16 v[240:255], v[100:103], v[108:111], v[240:255]
  ds_read_b128 v[96:99], v178 offset:0
  s_waitcnt lgkmcnt(6)
  v_mfma_f32_32x32x16_bf16 v[192:207], v[80:83], v[116:119], v[192:207]
  ds_read_b128 v[100:103], v179 offset:0
  s_waitcnt lgkmcnt(6)
  v_mfma_f32_32x32x16_bf16 v[208:223], v[84:87], v[116:119], v[208:223]
  s_waitcnt lgkmcnt(2)
  v_readfirstlane_b32 s14, v4
  s_nop 0
  s_cmp_eq_u32 s14, 0x01010101
  s_cbranch_scc0 L_sl81
L_bk82:
  ds_read_b128 v[80:83], v180 offset:0
  v_mfma_f32_32x32x16_bf16 v[224:239], v[88:91], v[116:119], v[224:239]
  ds_read_b128 v[84:87], v181 offset:0
  v_mfma_f32_32x32x16_bf16 v[240:255], v[92:95], v[116:119], v[240:255]
  ds_read_b128 v[88:91], v182 offset:0
  s_waitcnt vmcnt(11) lgkmcnt(4)
  v_mfma_f32_32x32x16_bf16 v[192:207], v[96:99], v[32:35], v[192:207]
  ds_read_b128 v[92:95], v183 offset:0
  s_waitcnt vmcnt(10) lgkmcnt(4)
  v_mfma_f32_32x32x16_bf16 v[192:207], v[100:103], v[36:39], v[192:207]
  ds_read_b128 v[96:99], v178 offset:16384
  s_waitcnt vmcnt(9) lgkmcnt(4)
  v_mfma_f32_32x32x16_bf16 v[192:207], v[80:83], v[48:51], v[192:207]
  ds_read_b128 v[100:103], v179 offset:16384
  s_waitcnt vmcnt(8) lgkmcnt(4)
  v_mfma_f32_32x32x16_bf16 v[192:207], v[84:87], v[52:55], v[192:207]
  ds_read_b128 v[80:83], v180 offset:16384
  s_waitcnt vmcnt(7) lgkmcnt(4)
  v_mfma_f32_32x32x16_bf16 v[192:207], v[88:91], v[64:67], v[192:207]
  ds_read_b128 v[84:87], v181 offset:16384
  s_waitcnt vmcnt(6) lgkmcnt(4)
  v_mfma_f32_32x32x16_bf16 v[192:207], v[92:95], v[68:71], v[192:207]
  ds_read_b128 v[88:91], v182 offset:16384
  s_waitcnt vmcnt(5) lgkmcnt(4)
  v_mfma_f32_32x32x16_bf16 v[192:207], v[96:99], v[40:43], v[192:207]
  ds_read_b128 v[92:95], v183 offset:16384
  ds_read_b32 v5, v20 offset:68
  s_waitcnt vmcnt(4) lgkmcnt(5)
  v_mfma_f32_32x32x16_bf16 v[192:207], v[100:103], v[44:47], v[192:207]
  v_xor_b32 v178, 0x1000, v178
  ds_read_b128 v[96:99], v178 offset:0
  s_waitcnt vmcnt(3) lgkmcnt(5)
  v_mfma_f32_32x32x16_bf16 v[192:207], v[80:83], v[56:59], v[192:207]
  v_xor_b32 v179, 0x1000, v179
  ds_read_b128 v[100:103], v179 offset:0
  s_waitcnt vmcnt(2) lgkmcnt(5)
  v_mfma_f32_32x32x16_bf16 v[192:207], v[84:87], v[60:63], v[192:207]
  v_xor_b32 v180, 0x1000, v180
  ds_read_b128 v[80:83], v180 offset:0
  s_waitcnt lgkmcnt(3)
  v_readfirstlane_b32 s14, v5
  s_nop 0
  s_bitcmp1_b32 s14, s101
  s_cbranch_scc0 L_sl90
L_bk91:
  ds_read_b128 v[128:131], v166 offset:32768
  ds_read_b128 v[132:135], v166 offset:33792
  ds_read_b128 v[136:139], v166 offset:34816
  ds_read_b128 v[140:143], v166 offset:35840
  ds_write_b8 v21, v122 offset:64
  s_waitcnt vmcnt(1)
  v_mfma_f32_32x32x16_bf16 v[192:207], v[88:91], v[72:75], v[192:207]
  v_xor_b32 v181, 0x1000, v181
  ds_read_b128 v[84:87], v181 offset:0
  s_waitcnt vmcnt(0)
  v_mfma_f32_32x32x16_bf16 v[192:207], v[92:95], v[76:79], v[192:207]
  v_xor_b32 v182, 0x1000, v182
  ds_read_b128 v[88:91], v182 offset:0
  s_waitcnt lgkmcnt(9)
  v_mfma_f32_32x32x16_bf16 v[208:223], v[96:99], v[32:35], v[208:223]
  v_xor_b32 v183, 0x1000, v183
  ds_read_b128 v[92:95], v183 offset:0
  s_waitcnt lgkmcnt(9)
  v_mfma_f32_32x32x16_bf16 v[208:223], v[100:103], v[36:39], v[208:223]
  ds_read_b128 v[96:99], v178 offset:16384
  s_waitcnt lgkmcnt(8)
  s_nop 1
  v_add_f32 v128, v128, v192
  v_add_f32 v129, v129, v193
  v_cvt_pk_bf16_f32 v104, v128, v129
  v_add_f32 v130, v130, v194
  v_add_f32 v131, v131, v195
  v_cvt_pk_bf16_f32 v105, v130, v131
  v_mfma_f32_32x32x16_bf16 v[208:223], v[80:83], v[48:51], v[208:223]
  ds_read_b128 v[100:103], v179 offset:16384
  s_waitcnt lgkmcnt(8)
  v_add_f32 v132, v132, v196
  v_add_f32 v133, v133, v197
  v_cvt_pk_bf16_f32 v106, v132, v133
  v_add_f32 v134, v134, v198
  v_add_f32 v135, v135, v199
  v_cvt_pk_bf16_f32 v107, v134, v135
  s_waitcnt lgkmcnt(4)
  v_mfma_f32_32x32x16_bf16 v[208:223], v[84:87], v[52:55], v[208:223]
  ds_read_b128 v[80:83], v180 offset:16384
  v_add_f32 v136, v136, v200
  v_add_f32 v137, v137, v201
  v_cvt_pk_bf16_f32 v108, v136, v137
  v_add_f32 v138, v138, v202
  v_add_f32 v139, v139, v203
  s_waitcnt lgkmcnt(4)
  v_mfma_f32_32x32x16_bf16 v[208:223], v[88:91], v[64:67], v[208:223]
  ds_read_b128 v[84:87], v181 offset:16384
  v_cvt_pk_bf16_f32 v109, v138, v139
  v_add_f32 v140, v140, v204
  v_add_f32 v141, v141, v205
  v_cvt_pk_bf16_f32 v110, v140, v141
  v_add_f32 v142, v142, v206
  v_add_f32 v143, v143, v207
  s_waitcnt lgkmcnt(4)
  v_mfma_f32_32x32x16_bf16 v[208:223], v[92:95], v[68:71], v[208:223]
  ds_read_b128 v[88:91], v182 offset:16384
  v_cvt_pk_bf16_f32 v111, v142, v143
  v_add3_u32 v112, v104, v105, v106
  v_add3_u32 v113, v107, v108, v109
  v_add3_u32 v112, v112, v110, v111
  v_add_u32 v112, v112, v113
  s_nop 1
  v_add_u32_dpp v112, v112, v112 quad_perm:[1,0,3,2] row_mask:0xf bank_mask:0xf
  s_waitcnt lgkmcnt(4)
  v_mfma_f32_32x32x16_bf16 v[208:223], v[96:99], v[40:43], v[208:223]
  ds_read_b128 v[92:95], v183 offset:16384
  ds_read_b32 v5, v20 offset:72
  v_add_u32_dpp v112, v112, v112 quad_perm:[2,3,0,1] row_mask:0xf bank_mask:0xf
  s_nop 1
  v_add_u32_dpp v112, v112, v112 row_half_mirror row_mask:0xf bank_mask:0xf
  s_nop 1
  v_add_u32_dpp v112, v112, v112 row_mirror row_mask:0xf bank_mask:0xf
  s_nop 1
  v_add_u32_dpp v112, v112, v112 row_bcast:15 row_mask:0xa bank_mask:0xf
  s_nop 1
  v_add_u32_dpp v112, v112, v112 row_bcast:31 row_mask:0xc bank_mask:0xf
  s_waitcnt lgkmcnt(5)
  v_mfma_f32_32x32x16_bf16 v[208:223], v[100:103], v[44:47], v[208:223]
  v_xor_b32 v178, 0x3000, v178
  ds_read_b128 v[96:99], v178 offset:0
  s_waitcnt lgkmcnt(5)
  v_mfma_f32_32x32x16_bf16 v[208:223], v[80:83], v[56:59], v[208:223]
  v_xor_b32 v179, 0x3000, v179
  ds_read_b128 v[100:103], v179 offset:0
  s_waitcnt lgkmcnt(5)
  v_mfma_f32_32x32x16_bf16 v[208:223], v[84:87], v[60:63], v[208:223]
  v_xor_b32 v180, 0x3000, v180
  ds_read_b128 v[80:83], v180 offset:0
  s_waitcnt lgkmcnt(3)
  v_readfirstlane_b32 s14, v5
  s_nop 0
  s_bitcmp1_b32 s14, s101
  s_cbranch_scc0 L_sl93
L_bk94:
  ds_read_b128 v[128:131], v166 offset:49152
  ds_read_b128 v[132:135], v166 offset:50176
  ds_read_b128 v[136:139], v166 offset:51200
  ds_read_b128 v[140:143], v166 offset:52224
  v_mfma_f32_32x32x16_bf16 v[208:223], v[88:91], v[72:75], v[208:223]
  v_xor_b32 v181, 0x3000, v181
  ds_read_b128 v[84:87], v181 offset:0
  v_mfma_f32_32x32x16_bf16 v[208:223], v[92:95], v[76:79], v[208:223]
  v_xor_b32 v182, 0x3000, v182
  ds_read_b128 v[88:91], v182 offset:0
  buffer_store_dwordx4 v[104:107], v1, s[28:31], s95 offen offset:0 sc1
  buffer_store_dwordx4 v[108:111], v1, s[28:31], s95 offen offset:1024 sc1
  v_readlane_b32 s14, v112, 63
  s_nop 0
  s_add_u32 s14, s14, s12
  s_add_u32 s14, s14, 0x3c6ef372
  v_mov_b32 v112, s14
  buffer_store_dword v112, v19, s[28:31], s94 offen offset:112 sc1
  s_waitcnt lgkmcnt(8)
  v_mfma_f32_32x32x16_bf16 v[224:239], v[96:99], v[32:35], v[224:239]
  v_xor_b32 v183, 0x3000, v183
  ds_read_b128 v[92:95], v183 offset:0
  s_waitcnt lgkmcnt(8)
  v_mfma_f32_32x32x16_bf16 v[224:239], v[100:103], v[36:39], v[224:239]
  ds_read_b128 v[96:99], v178 offset:16384
  s_waitcnt lgkmcnt(7)
  v_add_f32 v208, v208, v128
  v_add_f32 v209, v209, v129
  v_add_f32 v210, v210, v130
  v_add_f32 v211, v211, v131
  v_mfma_f32_32x32x16_bf16 v[224:239], v[80:83], v[48:51], v[224:239]
  ds_read_b128 v[100:103], v179 offset:16384
  s_waitcnt lgkmcnt(7)
  v_add_f32 v212, v212, v132
  v_add_f32 v213, v213, v133
  v_add_f32 v214, v214, v134
  v_add_f32 v215, v215, v135
  s_waitcnt lgkmcnt(4)
  v_mfma_f32_32x32x16_bf16 v[224:239], v[84:87], v[52:55], v[224:239]
  ds_read_b128 v[80:83], v180 offset:16384
  v_add_f32 v216, v216, v136
  v_add_f32 v217, v217, v137
  v_add_f32 v218, v218, v138
  v_add_f32 v219, v219, v139
  s_waitcnt lgkmcnt(4)
  v_mfma_f32_32x32x16_bf16 v[224:239], v[88:91], v[64:67], v[224:239]
  ds_read_b128 v[84:87], v181 offset:16384
  v_add_f32 v220, v220, v140
  v_add_f32 v221, v221, v141
  v_add_f32 v222, v222, v142
  v_add_f32 v223, v223, v143
  s_waitcnt lgkmcnt(4)
  v_mfma_f32_32x32x16_bf16 v[224:239], v[92:95], v[68:71], v[224:239]
  ds_read_b128 v[88:91], v182 offset:16384
  s_waitcnt lgkmcnt(4)
  v_mfma_f32_32x32x16_bf16 v[224:239], v[96:99], v[40:43], v[224:239]
  ds_read_b128 v[92:95], v183 offset:16384
  ds_read_b32 v5, v20 offset:76
  s_waitcnt lgkmcnt(5)
  v_mfma_f32_32x32x16_bf16 v[224:239], v[100:103], v[44:47], v[224:239]
  v_xor_b32 v178, 0x1000, v178
  ds_read_b128 v[96:99], v178 offset:0
  s_waitcnt lgkmcnt(5)
  v_mfma_f32_32x32x16_bf16 v[224:239], v[80:83], v[56:59], v[224:239]
  v_xor_b32 v179, 0x1000, v179
  ds_read_b128 v[100:103], v179 offset:0
  s_waitcnt lgkmcnt(5)
  v_mfma_f32_32x32x16_bf16 v[224:239], v[84:87], v[60:63], v[224:239]
  v_xor_b32 v180, 0x1000, v180
  ds_read_b128 v[80:83], v180 offset:0
  s_waitcnt lgkmcnt(3)
  v_readfirstlane_b32 s14, v5
  s_nop 0
  s_bitcmp1_b32 s14, s101
  s_cbranch_scc0 L_sl96
L_bk97:
  ds_read_b128 v[128:131], v167 offset:0
  ds_read_b128 v[132:135], v167 offset:1024
  ds_read_b128 v[136:139], v167 offset:2048
  ds_read_b128 v[140:143], v167 offset:3072
  v_mfma_f32_32x32x16_bf16 v[224:239], v[88:91], v[72:75], v[224:239]
  v_xor_b32 v181, 0x1000, v181
  ds_read_b128 v[84:87], v181 offset:0
  buffer_load_dwordx4 v[144:147], v1, s[28:31], s51 offen offset:0 sc1
  buffer_load_dwordx4 v[148:151], v1, s[28:31], s51 offen offset:1024 sc1
  buffer_load_dword v152, v19, s[28:31], s84 offen offset:112 sc1
  v_mfma_f32_32x32x16_bf16 v[224:239], v[92:95], v[76:79], v[224:239]
  v_xor_b32 v182, 0x1000, v182
  ds_read_b128 v[88:91], v182 offset:0
  s_waitcnt lgkmcnt(8)
  v_mfma_f32_32x32x16_bf16 v[240:255], v[96:99], v[32:35], v[240:255]
  v_xor_b32 v183, 0x1000, v183
  ds_read_b128 v[92:95], v183 offset:0
  s_waitcnt lgkmcnt(8)
  v_mfma_f32_32x32x16_bf16 v[240:255], v[100:103], v[36:39], v[240:255]
  ds_read_b128 v[96:99], v178 offset:16384
  s_waitcnt lgkmcnt(7)
  s_nop 1
  v_add_f32 v128, v128, v224
  v_add_f32 v129, v129, v225
  v_cvt_pk_bf16_f32 v104, v128, v129
  v_add_f32 v130, v130, v226
  v_add_f32 v131, v131, v227
  v_cvt_pk_bf16_f32 v105, v130, v131
  s_waitcnt lgkmcnt(6)
  v_add_f32 v132, v132, v228
  v_mfma_f32_32x32x16_bf16 v[240:255], v[80:83], v[48:51], v[240:255]
  ds_read_b128 v[100:103], v179 offset:16384
  v_add_f32 v133, v133, v229
  v_cvt_pk_bf16_f32 v106, v132, v133
  v_add_f32 v134, v134, v230
  v_add_f32 v135, v135, v231
  v_cvt_pk_bf16_f32 v107, v134, v135
  s_waitcnt lgkmcnt(6)
  v_add_f32 v136, v136, v232
  s_waitcnt lgkmcnt(4)
  v_mfma_f32_32x32x16_bf16 v[240:255], v[84:87], v[52:55], v[240:255]
  ds_read_b128 v[80:83], v180 offset:16384
  v_add_f32 v137, v137, v233
  v_cvt_pk_bf16_f32 v108, v136, v137
  v_add_f32 v138, v138, v234
  v_add_f32 v139, v139, v235
  v_cvt_pk_bf16_f32 v109, v138, v139
  v_add_f32 v140, v140, v236
  s_waitcnt lgkmcnt(4)
  v_mfma_f32_32x32x16_bf16 v[240:255], v[88:91], v[64:67], v[240:255]
  ds_read_b128 v[84:87], v181 offset:16384
  v_add_f32 v141, v141, v237
  v_cvt_pk_bf16_f32 v110, v140, v141
  v_add_f32 v142, v142, v238
  v_add_f32 v143, v143, v239
  v_cvt_pk_bf16_f32 v111, v142, v143
  v_add3_u32 v112, v104, v105, v106
  v_add3_u32 v113, v107, v108, v109
  s_waitcnt lgkmcnt(4)
  v_mfma_f32_32x32x16_bf16 v[240:255], v[92:95], v[68:71], v[240:255]
  ds_read_b128 v[88:91], v182 offset:16384
  v_add3_u32 v112, v112, v110, v111
  v_add_u32 v112, v112, v113
  s_nop 1
  v_add_u32_dpp v112, v112, v112 quad_perm:[1,0,3,2] row_mask:0xf bank_mask:0xf
  s_nop 1
  v_add_u32_dpp v112, v112, v112 quad_perm:[2,3,0,1] row_mask:0xf bank_mask:0xf
  s_nop 1
  v_add_u32_dpp v112, v112, v112 row_half_mirror row_mask:0xf bank_mask:0xf
  s_nop 1
  v_add_u32_dpp v112, v112, v112 row_mirror row_mask:0xf bank_mask:0xf
  s_waitcnt lgkmcnt(4)
  v_mfma_f32_32x32x16_bf16 v[240:255], v[96:99], v[40:43], v[240:255]
  ds_read_b128 v[92:95], v183 offset:16384
  ds_read_b32 v5, v20 offset:80
  v_add_u32_dpp v112, v112, v112 row_bcast:15 row_mask:0xa bank_mask:0xf
  s_nop 1
  v_add_u32_dpp v112, v112, v112 row_bcast:31 row_mask:0xc bank_mask:0xf
  buffer_store_dwordx4 v[104:107], v1, s[28:31], s95 offen offset:2048 sc1
  buffer_store_dwordx4 v[108:111], v1, s[28:31], s95 offen offset:3072 sc1
  v_readlane_b32 s14, v112, 63
  s_nop 0
  s_add_u32 s14, s14, s12
  s_add_u32 s14, s14, 0x7f4a1d35
  v_mov_b32 v112, s14
  buffer_store_dword v112, v19, s[28:31], s94 offen offset:80 sc1
  s_waitcnt lgkmcnt(5)
  v_mfma_f32_32x32x16_bf16 v[240:255], v[100:103], v[44:47], v[240:255]
  s_waitcnt lgkmcnt(4)
  v_mfma_f32_32x32x16_bf16 v[240:255], v[80:83], v[56:59], v[240:255]
  s_waitcnt vmcnt(5)
  v_add3_u32 v114, v144, v145, v146
  s_waitcnt vmcnt(4)
  v_add3_u32 v115, v147, v148, v149
  v_add3_u32 v114, v114, v150, v151
  v_add_u32 v114, v114, v115
  s_nop 1
  v_add_u32_dpp v114, v114, v114 quad_perm:[1,0,3,2] row_mask:0xf bank_mask:0xf
  s_nop 1
  v_add_u32_dpp v114, v114, v114 quad_perm:[2,3,0,1] row_mask:0xf bank_mask:0xf
  s_nop 1
  v_add_u32_dpp v114, v114, v114 row_half_mirror row_mask:0xf bank_mask:0xf
  s_nop 1
  v_add_u32_dpp v114, v114, v114 row_mirror row_mask:0xf bank_mask:0xf
  s_nop 1
  v_add_u32_dpp v114, v114, v114 row_bcast:15 row_mask:0xa bank_mask:0xf
  s_nop 1
  v_add_u32_dpp v114, v114, v114 row_bcast:31 row_mask:0xc bank_mask:0xf
  s_nop 0
  v_readlane_b32 s14, v114, 63
  s_waitcnt vmcnt(3)
  v_readfirstlane_b32 s15, v152
  s_nop 0
  s_sub_u32 s15, s15, s14
  s_sub_u32 s15, s15, s12
  s_cmp_eq_u32 s15, 0x3c6ef372
  s_cbranch_scc0 L_sl102
L_bk103:
  v_lshlrev_b32 v114, 16, v144
  v_and_b32 v144, 0xffff0000, v144
  v_add_f32 v208, v208, v114
  v_add_f32 v209, v209, v144
  v_lshlrev_b32 v114, 16, v145
  v_and_b32 v145, 0xffff0000, v145
  v_add_f32 v210, v210, v114
  v_add_f32 v211, v211, v145
  v_lshlrev_b32 v114, 16, v146
  v_and_b32 v146, 0xffff0000, v146
  v_add_f32 v212, v212, v114
  v_add_f32 v213, v213, v146
  v_lshlrev_b32 v114, 16, v147
  v_and_b32 v147, 0xffff0000, v147
  v_add_f32 v214, v214, v114
  v_add_f32 v215, v215, v147
  v_lshlrev_b32 v114, 16, v148
  v_and_b32 v148, 0xffff0000, v148
  v_add_f32 v216, v216, v114
  v_add_f32 v217, v217, v148
  v_lshlrev_b32 v114, 16, v149
  v_and_b32 v149, 0xffff0000, v149
  v_add_f32 v218, v218, v114
  v_add_f32 v219, v219, v149
  v_lshlrev_b32 v114, 16, v150
  v_and_b32 v150, 0xffff0000, v150
  v_add_f32 v220, v220, v114
  v_add_f32 v221, v221, v150
  v_lshlrev_b32 v114, 16, v151
  v_and_b32 v151, 0xffff0000, v151
  v_add_f32 v222, v222, v114
  v_add_f32 v223, v223, v151
  v_cvt_pk_bf16_f32 v32, v208, v209
  v_cvt_pk_bf16_f32 v33, v210, v211
  v_cvt_pk_bf16_f32 v34, v212, v213
  v_cvt_pk_bf16_f32 v35, v214, v215
  v_cvt_pk_bf16_f32 v36, v216, v217
  v_cvt_pk_bf16_f32 v37, v218, v219
  v_cvt_pk_bf16_f32 v38, v220, v221
  v_cvt_pk_bf16_f32 v39, v222, v223
  buffer_store_dwordx4 v[32:35], v1, s[28:31], s93 offen offset:0 sc1
  buffer_store_dwordx4 v[36:39], v1, s[28:31], s93 offen offset:1024 sc1
  v_add3_u32 v114, v32, v33, v34
  v_add3_u32 v115, v35, v36, v37
  v_add3_u32 v114, v114, v38, v39
  v_add_u32 v114, v114, v115
  s_nop 1
  v_add_u32_dpp v114, v114, v114 quad_perm:[1,0,3,2] row_mask:0xf bank_mask:0xf
  s_nop 1
  v_add_u32_dpp v114, v114, v114 quad_perm:[2,3,0,1] row_mask:0xf bank_mask:0xf
  s_nop 1
  v_add_u32_dpp v114, v114, v114 row_half_mirror row_mask:0xf bank_mask:0xf
  s_nop 1
  v_add_u32_dpp v114, v114, v114 row_mirror row_mask:0xf bank_mask:0xf
  s_nop 1
  v_add_u32_dpp v114, v114, v114 row_bcast:15 row_mask:0xa bank_mask:0xf
  s_nop 1
  v_add_u32_dpp v114, v114, v114 row_bcast:31 row_mask:0xc bank_mask:0xf
  s_nop 0
  v_readlane_b32 s14, v114, 63
  s_nop 0
  s_add_u32 s14, s14, s12
  s_add_u32 s14, s14, 0x1b873593
  v_mov_b32 v114, s14
  buffer_store_dword v114, v19, s[28:31], s93 offen offset:2048 sc1
  s_waitcnt lgkmcnt(3)
  v_mfma_f32_32x32x16_bf16 v[240:255], v[84:87], v[60:63], v[240:255]
  s_waitcnt lgkmcnt(0)
  v_readfirstlane_b32 s14, v5
  s_nop 0
  s_bitcmp1_b32 s14, s101
  s_cbranch_scc0 L_sl99
L_bk100:
  ds_read_b128 v[128:131], v166 offset:32768
  ds_read_b128 v[132:135], v166 offset:33792
  ds_read_b128 v[136:139], v166 offset:34816
  ds_read_b128 v[140:143], v166 offset:35840
  v_mfma_f32_32x32x16_bf16 v[240:255], v[88:91], v[72:75], v[240:255]
  v_mfma_f32_32x32x16_bf16 v[240:255], v[92:95], v[76:79], v[240:255]
  buffer_load_dwordx4 v[48:51], v1, s[28:31], s51 offen offset:2048 sc1
  buffer_load_dwordx4 v[52:55], v1, s[28:31], s51 offen offset:3072 sc1
  buffer_load_dword v56, v19, s[28:31], s84 offen offset:80 sc1
  buffer_load_dwordx4 v[64:67], v1, s[28:31], s48 offen offset:0 sc1
  buffer_load_dwordx4 v[68:71], v1, s[28:31], s48 offen offset:1024 sc1
  buffer_load_dword v72, v19, s[28:31], s48 offen offset:2048 sc1
  s_waitcnt lgkmcnt(3)
  s_nop 4
  v_add_f32 v240, v240, v128
  v_add_f32 v241, v241, v129
  v_add_f32 v242, v242, v130
  v_add_f32 v243, v243, v131
  s_waitcnt lgkmcnt(2)
  v_add_f32 v244, v244, v132
  v_add_f32 v245, v245, v133
  v_add_f32 v246, v246, v134
  v_add_f32 v247, v247, v135
  s_waitcnt lgkmcnt(1)
  v_add_f32 v248, v248, v136
  v_add_f32 v249, v249, v137
  v_add_f32 v250, v250, v138
  v_add_f32 v251, v251, v139
  s_waitcnt lgkmcnt(0)
  v_add_f32 v252, v252, v140
  v_add_f32 v253, v253, v141
  v_add_f32 v254, v254, v142
  v_add_f32 v255, v255, v143
  v_fma_f32 v240, v240, v23, v184
  v_fma_f32 v241, v241, v23, v185
  v_fma_f32 v242, v242, v23, v186
  v_fma_f32 v243, v243, v23, v187
  v_fma_f32 v244, v244, v23, v188
  v_fma_f32 v245, v245, v23, v189
  v_fma_f32 v246, v246, v23, v190
  v_fma_f32 v247, v247, v23, v191
  v_fma_f32 v248, v248, v23, v10
  v_fma_f32 v249, v249, v23, v11
  v_fma_f32 v250, v250, v23, v12
  v_fma_f32 v251, v251, v23, v13
  v_fma_f32 v252, v252, v23, v124
  v_fma_f32 v253, v253, v23, v125
  v_fma_f32 v254, v254, v23, v2
  v_fma_f32 v255, v255, v23, v3
  s_waitcnt vmcnt(5)
  v_add3_u32 v112, v48, v49, v50
  s_waitcnt vmcnt(4)
  v_add3_u32 v113, v51, v52, v53
  v_add3_u32 v112, v112, v54, v55
  v_add_u32 v112, v112, v113
  s_nop 1
  v_add_u32_dpp v112, v112, v112 quad_perm:[1,0,3,2] row_mask:0xf bank_mask:0xf
  s_nop 1
  v_add_u32_dpp v112, v112, v112 quad_perm:[2,3,0,1] row_mask:0xf bank_mask:0xf
  s_nop 1
  v_add_u32_dpp v112, v112, v112 row_half_mirror row_mask:0xf bank_mask:0xf
  s_nop 1
  v_add_u32_dpp v112, v112, v112 row_mirror row_mask:0xf bank_mask:0xf
  s_nop 1
  v_add_u32_dpp v112, v112, v112 row_bcast:15 row_mask:0xa bank_mask:0xf
  s_nop 1
  v_add_u32_dpp v112, v112, v112 row_bcast:31 row_mask:0xc bank_mask:0xf
  s_nop 0
  v_readlane_b32 s14, v112, 63
  s_waitcnt vmcnt(3)
  v_readfirstlane_b32 s15, v56
  s_nop 0
  s_sub_u32 s15, s15, s14
  s_sub_u32 s15, s15, s12
  s_cmp_eq_u32 s15, 0x7f4a1d35
  s_cbranch_scc0 L_sl105
L_bk106:
  v_lshlrev_b32 v128, 16, v48
  v_and_b32 v48, 0xffff0000, v48
  v_fmac_f32 v240, v23, v128
  v_fmac_f32 v241, v23, v48
  v_lshlrev_b32 v128, 16, v49
  v_and_b32 v49, 0xffff0000, v49
  v_fmac_f32 v242, v23, v128
  v_fmac_f32 v243, v23, v49
  v_lshlrev_b32 v128, 16, v50
  v_and_b32 v50, 0xffff0000, v50
  v_fmac_f32 v244, v23, v128
  v_fmac_f32 v245, v23, v50
  v_lshlrev_b32 v128, 16, v51
  v_and_b32 v51, 0xffff0000, v51
  v_fmac_f32 v246, v23, v128
  v_fmac_f32 v247, v23, v51
  v_lshlrev_b32 v128, 16, v52
  v_and_b32 v52, 0xffff0000, v52
  v_fmac_f32 v248, v23, v128
  v_fmac_f32 v249, v23, v52
  v_lshlrev_b32 v128, 16, v53
  v_and_b32 v53, 0xffff0000, v53
  v_fmac_f32 v250, v23, v128
  v_fmac_f32 v251, v23, v53
  v_lshlrev_b32 v128, 16, v54
  v_and_b32 v54, 0xffff0000, v54
  v_fmac_f32 v252, v23, v128
  v_fmac_f32 v253, v23, v54
  v_lshlrev_b32 v128, 16, v55
  v_and_b32 v55, 0xffff0000, v55
  v_fmac_f32 v254, v23, v128
  v_fmac_f32 v255, v23, v55
  s_waitcnt vmcnt(2)
  v_add3_u32 v112, v64, v65, v66
  s_waitcnt vmcnt(1)
  v_add3_u32 v113, v67, v68, v69
  v_add3_u32 v112, v112, v70, v71
  v_add_u32 v112, v112, v113
  s_nop 1
  v_add_u32_dpp v112, v112, v112 quad_perm:[1,0,3,2] row_mask:0xf bank_mask:0xf
  s_nop 1
  v_add_u32_dpp v112, v112, v112 quad_perm:[2,3,0,1] row_mask:0xf bank_mask:0xf
  s_nop 1
  v_add_u32_dpp v112, v112, v112 row_half_mirror row_mask:0xf bank_mask:0xf
  s_nop 1
  v_add_u32_dpp v112, v112, v112 row_mirror row_mask:0xf bank_mask:0xf
  s_nop 1
  v_add_u32_dpp v112, v112, v112 row_bcast:15 row_mask:0xa bank_mask:0xf
  s_nop 1
  v_add_u32_dpp v112, v112, v112 row_bcast:31 row_mask:0xc bank_mask:0xf
  s_nop 0
  v_readlane_b32 s14, v112, 63
  s_waitcnt vmcnt(0)
  v_readfirstlane_b32 s15, v72
  s_nop 0
  s_sub_u32 s15, s15, s14
  s_sub_u32 s15, s15, s12
  s_cmp_eq_u32 s15, 0x1b873593
  s_cbranch_scc0 L_sl108
L_bk109:
  v_lshlrev_b32 v128, 16, v64
  v_and_b32 v64, 0xffff0000, v64
  v_fmac_f32 v240, v23, v128
  v_fmac_f32 v241, v23, v64
  v_lshlrev_b32 v128, 16, v65
  v_and_b32 v65, 0xffff0000, v65
  v_fmac_f32 v242, v23, v128
  v_fmac_f32 v243, v23, v65
  v_lshlrev_b32 v128, 16, v66
  v_and_b32 v66, 0xffff0000, v66
  v_fmac_f32 v244, v23, v128
  v_fmac_f32 v245, v23, v66
  v_lshlrev_b32 v128, 16, v67
  v_and_b32 v67, 0xffff0000, v67
  v_fmac_f32 v246, v23, v128
  v_fmac_f32 v247, v23, v67
  v_lshlrev_b32 v128, 16, v68
  v_and_b32 v68, 0xffff0000, v68
  v_fmac_f32 v248, v23, v128
  v_fmac_f32 v249, v23, v68
  v_lshlrev_b32 v128, 16, v69
  v_and_b32 v69, 0xffff0000, v69
  v_fmac_f32 v250, v23, v128
  v_fmac_f32 v251, v23, v69
  v_lshlrev_b32 v128, 16, v70
  v_and_b32 v70, 0xffff0000, v70
  v_fmac_f32 v252, v23, v128
  v_fmac_f32 v253, v23, v70
  v_lshlrev_b32 v128, 16, v71
  v_and_b32 v71, 0xffff0000, v71
  v_fmac_f32 v254, v23, v128
  v_fmac_f32 v255, v23, v71
  v_permlane16_swap_b32 v240, v244
  v_permlane16_swap_b32 v241, v245
  v_permlane16_swap_b32 v242, v246
  v_permlane16_swap_b32 v243, v247
  buffer_store_dwordx4 v[240:243], v164, s[44:47], 0 offen offset:0
  buffer_store_dwordx4 v[244:247], v165, s[44:47], 0 offen offset:0
  v_permlane16_swap_b32 v248, v252
  v_permlane16_swap_b32 v249, v253
  v_permlane16_swap_b32 v250, v254
  v_permlane16_swap_b32 v251, v255
  buffer_store_dwordx4 v[248:251], v164, s[44:47], 0 offen offset:64
  buffer_store_dwordx4 v[252:255], v165, s[44:47], 0 offen offset:64
  s_lshl_b32 s14, s5, 4
  s_add_u32 s14, s14, s10
  s_lshl_b32 s14, s14, 2
  s_add_u32 s14, s14, s4
  s_cmp_eq_u32 s14, 960
  s_cbranch_scc0 L_ne111
  s_add_u32 s100, s100, 1
  v_mov_b32 v128, s100
  buffer_store_dword v128, v19, s[28:31], 0 offen sc1
L_ne111:
  s_endpgm
L_end:
  s_endpgm
L_sl4:
  s_sub_u32 s13, s13, 1
  s_cbranch_scc1 L_gv6
  ds_read_b64 v[124:125], v20 offset:88
  s_waitcnt lgkmcnt(0)
  s_nop 1
  v_readfirstlane_b32 s14, v124
  s_nop 1
  v_readfirstlane_b32 s15, v125
  s_nop 1
  s_and_b32 s14, s14, s15
  s_nop 1
  s_cmp_eq_u32 s14, 0x01010101
  s_nop 1
  s_cbranch_scc0 L_sl4
  s_branch L_bk5
L_gv6:
  s_mov_b32 s13, 0
  s_branch L_bk5
L_sl7:
  s_sub_u32 s13, s13, 1
  s_cbranch_scc1 L_gv9
  ds_read_b32 v126, v20 offset:12
  s_waitcnt lgkmcnt(0)
  s_nop 1
  v_readfirstlane_b32 s14, v126
  s_nop 1
  s_cmp_eq_u32 s14, 0x01010101
  s_nop 1
  s_cbranch_scc0 L_sl7
  s_branch L_bk8
L_gv9:
  s_mov_b32 s13, 0
  s_branch L_bk8
L_sl10:
  s_sub_u32 s13, s13, 1
  s_cbranch_scc1 L_gv12
  buffer_load_dword v27, v25, s[28:31], s83 offen sc1
  s_waitcnt vmcnt(0)
  s_nop 1
  v_cmp_eq_u32 vcc, s12, v27
  s_nop 1
  s_mov_b32 s15, s85
  s_nop 1
  s_and_b32 s14, vcc_lo, s15
  s_nop 1
  s_cmp_eq_u32 s14, s15
  s_nop 1
  s_cbranch_scc0 L_sl10
  s_branch L_bk11
L_gv12:
  s_mov_b32 s13, 0
  s_branch L_bk11
L_sl13:
  s_sub_u32 s13, s13, 1
  s_cbranch_scc1 L_gv15
  buffer_load_dword v27, v25, s[28:31], s83 offen sc1
  s_waitcnt vmcnt(0)
  s_nop 1
  v_cmp_eq_u32 vcc, s12, v27
  s_nop 1
  s_lshl_b32 s15, s85, 4
  s_nop 1
  s_and_b32 s14, vcc_lo, s15
  s_nop 1
  s_cmp_eq_u32 s14, s15
  s_nop 1
  s_cbranch_scc0 L_sl13
  s_branch L_bk14
L_gv15:
  s_mov_b32 s13, 0
  s_branch L_bk14
L_sl16:
  s_sub_u32 s13, s13, 1
  s_cbranch_scc1 L_gv18
  ds_read_b64 v[124:125], v20 offset:0
  s_waitcnt lgkmcnt(0)
  s_nop 1
  v_readfirstlane_b32 s14, v124
  s_nop 1
  v_readfirstlane_b32 s15, v125
  s_nop 1
  s_and_b32 s14, s14, s15
  s_nop 1
  s_cmp_eq_u32 s14, 0x01010101
  s_nop 1
  s_cbranch_scc0 L_sl16
  s_branch L_bk17
L_gv18:
  s_mov_b32 s13, 0
  s_branch L_bk17
L_sl19:
  s_sub_u32 s13, s13, 1
  s_cbranch_scc1 L_gv21
  ds_read_b32 v126, v20 offset:24
  s_waitcnt lgkmcnt(0)
  s_nop 1
  v_readfirstlane_b32 s14, v126
  s_nop 1
  s_cmp_eq_u32 s14, 0x01010101
  s_nop 1
  s_cbranch_scc0 L_sl19
  s_branch L_bk20
L_gv21:
  s_mov_b32 s13, 0
  s_branch L_bk20
L_sl22:
  s_sub_u32 s13, s13, 1
  s_cbranch_scc1 L_gv24
  ds_read_b32 v126, v20 offset:44
  s_waitcnt lgkmcnt(0)
  s_nop 1
  v_readfirstlane_b32 s14, v126
  s_nop 1
  s_cmp_eq_u32 s14, 0x01010101
  s_nop 1
  s_cbranch_scc0 L_sl22
  s_branch L_bk23
L_gv24:
  s_mov_b32 s13, 0
  s_branch L_bk23
L_sl25:
  s_sub_u32 s13, s13, 1
  s_cbranch_scc1 L_gv27
  ds_read_b32 v126, v20 offset:48
  s_waitcnt lgkmcnt(0)
  s_nop 1
  v_readfirstlane_b32 s14, v126
  s_nop 1
  s_cmp_eq_u32 s14, 0x01010101
  s_nop 1
  s_cbranch_scc0 L_sl25
  s_branch L_bk26
L_gv27:
  s_mov_b32 s13, 0
  s_branch L_bk26
L_sl28:
  s_sub_u32 s13, s13, 1
  s_cbranch_scc1 L_gv30
  ds_read_b32 v126, v20 offset:32
  s_waitcnt lgkmcnt(0)
  s_nop 1
  v_readfirstlane_b32 s14, v126
  s_nop 1
  s_cmp_eq_u32 s14, 0x01010101
  s_nop 1
  s_cbranch_scc0 L_sl28
  s_branch L_bk29
L_gv30:
  s_mov_b32 s13, 0
  s_branch L_bk29
L_sl31:
  s_sub_u32 s13, s13, 1
  s_cbranch_scc1 L_gv33
  buffer_load_dword v27, v25, s[28:31], s83 offen sc1
  s_waitcnt vmcnt(0)
  s_nop 1
  v_cmp_eq_u32 vcc, s12, v27
  s_nop 1
  s_lshl_b32 s15, s85, 8
  s_nop 1
  s_and_b32 s14, vcc_lo, s15
  s_nop 1
  s_cmp_eq_u32 s14, s15
  s_nop 1
  s_cbranch_scc0 L_sl31
  s_branch L_bk32
L_gv33:
  s_mov_b32 s13, 0
  s_branch L_bk32
L_sl34:
  s_sub_u32 s13, s13, 1
  s_cbranch_scc1 L_gv36
  buffer_load_dword v27, v25, s[28:31], s83 offen sc1
  s_waitcnt vmcnt(0)
  s_nop 1
  v_cmp_eq_u32 vcc, s12, v27
  s_nop 1
  s_mov_b32 s15, 0x3000
  s_nop 1
  s_and_b32 s14, vcc_lo, s15
  s_nop 1
  s_cmp_eq_u32 s14, s15
  s_nop 1
  s_cbranch_scc0 L_sl34
  s_branch L_bk35
L_gv36:
  s_mov_b32 s13, 0
  s_branch L_bk35
L_sl37:
  s_sub_u32 s13, s13, 1
  s_cbranch_scc1 L_gv39
  ds_read_b32 v29, v20 offset:40
  s_waitcnt lgkmcnt(0)
  s_nop 1
  v_readfirstlane_b32 s14, v29
  s_nop 1
  s_cmp_eq_u32 s14, 0x01010101
  s_nop 1
  s_cbranch_scc0 L_sl37
  s_branch L_bk38
L_gv39:
  s_mov_b32 s13, 0
  s_branch L_bk38
L_sl40:
  s_sub_u32 s13, s13, 1
  s_cbranch_scc1 L_gv42
  ds_read_b32 v28, v20 offset:60
  s_waitcnt lgkmcnt(0)
  s_nop 1
  v_readfirstlane_b32 s14, v28
  s_nop 1
  s_bitcmp1_b32 s14, s101
  s_nop 1
  s_cbranch_scc0 L_sl40
  s_branch L_bk41
L_gv42:
  s_mov_b32 s13, 0
  s_branch L_bk41
L_sl43:
  s_sub_u32 s13, s13, 1
  s_cbranch_scc1 L_gv45
  ds_read_b32 v28, v20 offset:64
  s_waitcnt lgkmcnt(0)
  s_nop 1
  v_readfirstlane_b32 s14, v28
  s_nop 1
  s_bitcmp1_b32 s14, s101
  s_nop 1
  s_cbranch_scc0 L_sl43
  s_branch L_bk44
L_gv45:
  s_mov_b32 s13, 0
  s_branch L_bk44
L_sl60:
  s_sub_u32 s13, s13, 1
  s_cbranch_scc1 L_gv62
  ds_read_b32 v5, v20 offset:28
  s_waitcnt lgkmcnt(0)
  s_nop 1
  v_readfirstlane_b32 s14, v5
  s_nop 1
  s_cmp_eq_u32 s14, 0x01010101
  s_nop 1
  s_cbranch_scc0 L_sl60
  s_branch L_bk61
L_gv62:
  s_mov_b32 s13, 0
  s_branch L_bk61
L_sl63:
  s_sub_u32 s13, s13, 1
  s_cbranch_scc1 L_gv65
  ds_read_b64 v[74:75], v20 offset:8
  s_waitcnt lgkmcnt(0)
  s_nop 1
  v_readfirstlane_b32 s14, v74
  s_nop 1
  v_readfirstlane_b32 s15, v75
  s_nop 1
  s_and_b32 s14, s14, s15
  s_nop 1
  s_cmp_eq_u32 s14, 0x01010101
  s_nop 1
  s_cbranch_scc0 L_sl63
  s_branch L_bk64
L_gv65:
  s_mov_b32 s13, 0
  s_branch L_bk64
L_sl69:
  s_sub_u32 s13, s13, 1
  s_cbranch_scc1 L_gv71
  ds_read_b32 v126, v20 offset:32
  s_waitcnt lgkmcnt(0)
  s_nop 1
  v_readfirstlane_b32 s14, v126
  s_nop 1
  s_cmp_eq_u32 s14, 0x01010101
  s_nop 1
  s_cbranch_scc0 L_sl69
  s_branch L_bk70
L_gv71:
  s_mov_b32 s13, 0
  s_branch L_bk70
L_sl72:
  s_sub_u32 s13, s13, 1
  s_cbranch_scc1 L_gv74
  ds_read_b32 v5, v20 offset:36
  s_waitcnt lgkmcnt(0)
  s_nop 1
  v_readfirstlane_b32 s14, v5
  s_nop 1
  s_cmp_eq_u32 s14, 0x01010101
  s_nop 1
  s_cbranch_scc0 L_sl72
  s_branch L_bk73
L_gv74:
  s_mov_b32 s13, 0
  s_branch L_bk73
L_sl75:
  s_sub_u32 s13, s13, 1
  s_cbranch_scc1 L_gv77
  ds_read_b32 v4, v20 offset:52
  s_waitcnt lgkmcnt(0)
  s_nop 1
  v_readfirstlane_b32 s14, v4
  s_nop 1
  s_cmp_eq_u32 s14, 0x01010101
  s_nop 1
  s_cbranch_scc0 L_sl75
  s_branch L_bk76
L_gv77:
  s_mov_b32 s13, 0
  s_branch L_bk76
L_sl81:
  s_sub_u32 s13, s13, 1
  s_cbranch_scc1 L_gv83
  ds_read_b32 v4, v20 offset:56
  s_waitcnt lgkmcnt(0)
  s_nop 1
  v_readfirstlane_b32 s14, v4
  s_nop 1
  s_cmp_eq_u32 s14, 0x01010101
  s_nop 1
  s_cbranch_scc0 L_sl81
  s_branch L_bk82
L_gv83:
  s_mov_b32 s13, 0
  s_branch L_bk82
L_sl84:
  s_sub_u32 s13, s13, 1
  s_cbranch_scc1 L_gv86
  buffer_load_dword v157, v156, s[28:31], s83 offen sc1
  s_waitcnt vmcnt(0)
  s_nop 1
  v_cmp_eq_u32 vcc, s12, v157
  s_nop 1
  s_lshl_b32 s15, s85, 16
  s_nop 1
  s_and_b32 s14, vcc_lo, s15
  s_nop 1
  s_cmp_eq_u32 s14, s15
  s_nop 1
  s_cbranch_scc0 L_sl84
  s_branch L_bk85
L_gv86:
  s_mov_b32 s13, 0
  s_branch L_bk85
L_sl90:
  s_sub_u32 s13, s13, 1
  s_cbranch_scc1 L_gv92
  ds_read_b32 v5, v20 offset:68
  s_waitcnt lgkmcnt(0)
  s_nop 1
  v_readfirstlane_b32 s14, v5
  s_nop 1
  s_bitcmp1_b32 s14, s101
  s_nop 1
  s_cbranch_scc0 L_sl90
  s_branch L_bk91
L_gv92:
  s_mov_b32 s13, 0
  s_branch L_bk91
L_sl93:
  s_sub_u32 s13, s13, 1
  s_cbranch_scc1 L_gv95
  ds_read_b32 v5, v20 offset:72
  s_waitcnt lgkmcnt(0)
  s_nop 1
  v_readfirstlane_b32 s14, v5
  s_nop 1
  s_bitcmp1_b32 s14, s101
  s_nop 1
  s_cbranch_scc0 L_sl93
  s_branch L_bk94
L_gv95:
  s_mov_b32 s13, 0
  s_branch L_bk94
L_sl96:
  s_sub_u32 s13, s13, 1
  s_cbranch_scc1 L_gv98
  ds_read_b32 v5, v20 offset:76
  s_waitcnt lgkmcnt(0)
  s_nop 1
  v_readfirstlane_b32 s14, v5
  s_nop 1
  s_bitcmp1_b32 s14, s101
  s_nop 1
  s_cbranch_scc0 L_sl96
  s_branch L_bk97
L_gv98:
  s_mov_b32 s13, 0
  s_branch L_bk97
L_sl99:
  s_sub_u32 s13, s13, 1
  s_cbranch_scc1 L_gv101
  ds_read_b32 v5, v20 offset:80
  s_waitcnt lgkmcnt(0)
  s_nop 1
  v_readfirstlane_b32 s14, v5
  s_nop 1
  s_bitcmp1_b32 s14, s101
  s_nop 1
  s_cbranch_scc0 L_sl99
  s_branch L_bk100
L_gv101:
  s_mov_b32 s13, 0
  s_branch L_bk100
L_sl102:
  s_sub_u32 s13, s13, 1
  s_cbranch_scc1 L_gv104
  buffer_load_dwordx4 v[144:147], v1, s[28:31], s51 offen offset:0 sc1
  buffer_load_dwordx4 v[148:151], v1, s[28:31], s51 offen offset:1024 sc1
  buffer_load_dword v152, v19, s[28:31], s84 offen offset:112 sc1
  s_waitcnt vmcnt(0)
  s_nop 1
  v_add3_u32 v114, v144, v145, v146
  s_nop 1
  v_add3_u32 v115, v147, v148, v149
  s_nop 1
  v_add3_u32 v114, v114, v150, v151
  s_nop 1
  v_add_u32 v114, v114, v115
  s_nop 1
  v_add_u32_dpp v114, v114, v114 quad_perm:[1,0,3,2] row_mask:0xf bank_mask:0xf
  s_nop 1
  v_add_u32_dpp v114, v114, v114 quad_perm:[2,3,0,1] row_mask:0xf bank_mask:0xf
  s_nop 1
  v_add_u32_dpp v114, v114, v114 row_half_mirror row_mask:0xf bank_mask:0xf
  s_nop 1
  v_add_u32_dpp v114, v114, v114 row_mirror row_mask:0xf bank_mask:0xf
  s_nop 1
  v_add_u32_dpp v114, v114, v114 row_bcast:15 row_mask:0xa bank_mask:0xf
  s_nop 1
  v_add_u32_dpp v114, v114, v114 row_bcast:31 row_mask:0xc bank_mask:0xf
  s_nop 1
  v_readlane_b32 s14, v114, 63
  s_nop 1
  v_readfirstlane_b32 s15, v152
  s_nop 1
  s_sub_u32 s15, s15, s14
  s_nop 1
  s_sub_u32 s15, s15, s12
  s_nop 1
  s_cmp_eq_u32 s15, 0x3c6ef372
  s_nop 1
  s_cbranch_scc0 L_sl102
  s_branch L_bk103
L_gv104:
  s_mov_b32 s13, 0
  s_branch L_bk103
L_sl105:
  s_sub_u32 s13, s13, 1
  s_cbranch_scc1 L_gv107
  buffer_load_dwordx4 v[48:51], v1, s[28:31], s51 offen offset:2048 sc1
  buffer_load_dwordx4 v[52:55], v1, s[28:31], s51 offen offset:3072 sc1
  buffer_load_dword v56, v19, s[28:31], s84 offen offset:80 sc1
  s_waitcnt vmcnt(0)
  s_nop 1
  v_add3_u32 v112, v48, v49, v50
  s_nop 1
  v_add3_u32 v113, v51, v52, v53
  s_nop 1
  v_add3_u32 v112, v112, v54, v55
  s_nop 1
  v_add_u32 v112, v112, v113
  s_nop 1
  v_add_u32_dpp v112, v112, v112 quad_perm:[1,0,3,2] row_mask:0xf bank_mask:0xf
  s_nop 1
  v_add_u32_dpp v112, v112, v112 quad_perm:[2,3,0,1] row_mask:0xf bank_mask:0xf
  s_nop 1
  v_add_u32_dpp v112, v112, v112 row_half_mirror row_mask:0xf bank_mask:0xf
  s_nop 1
  v_add_u32_dpp v112, v112, v112 row_mirror row_mask:0xf bank_mask:0xf
  s_nop 1
  v_add_u32_dpp v112, v112, v112 row_bcast:15 row_mask:0xa bank_mask:0xf
  s_nop 1
  v_add_u32_dpp v112, v112, v112 row_bcast:31 row_mask:0xc bank_mask:0xf
  s_nop 1
  v_readlane_b32 s14, v112, 63
  s_nop 1
  v_readfirstlane_b32 s15, v56
  s_nop 1
  s_sub_u32 s15, s15, s14
  s_nop 1
  s_sub_u32 s15, s15, s12
  s_nop 1
  s_cmp_eq_u32 s15, 0x7f4a1d35
  s_nop 1
  s_cbranch_scc0 L_sl105
  s_branch L_bk106
L_gv107:
  s_mov_b32 s13, 0
  s_branch L_bk106
L_sl108:
  s_sub_u32 s13, s13, 1
  s_cbranch_scc1 L_gv110
  buffer_load_dwordx4 v[64:67], v1, s[28:31], s48 offen offset:0 sc1
  buffer_load_dwordx4 v[68:71], v1, s[28:31], s48 offen offset:1024 sc1
  buffer_load_dword v72, v19, s[28:31], s48 offen offset:2048 sc1
  s_waitcnt vmcnt(0)
  s_nop 1
  v_add3_u32 v112, v64, v65, v66
  s_nop 1
  v_add3_u32 v113, v67, v68, v69
  s_nop 1
  v_add3_u32 v112, v112, v70, v71
  s_nop 1
  v_add_u32 v112, v112, v113
  s_nop 1
  v_add_u32_dpp v112, v112, v112 quad_perm:[1,0,3,2] row_mask:0xf bank_mask:0xf
  s_nop 1
  v_add_u32_dpp v112, v112, v112 quad_perm:[2,3,0,1] row_mask:0xf bank_mask:0xf
  s_nop 1
  v_add_u32_dpp v112, v112, v112 row_half_mirror row_mask:0xf bank_mask:0xf
  s_nop 1
  v_add_u32_dpp v112, v112, v112 row_mirror row_mask:0xf bank_mask:0xf
  s_nop 1
  v_add_u32_dpp v112, v112, v112 row_bcast:15 row_mask:0xa bank_mask:0xf
  s_nop 1
  v_add_u32_dpp v112, v112, v112 row_bcast:31 row_mask:0xc bank_mask:0xf
  s_nop 1
  v_readlane_b32 s14, v112, 63
  s_nop 1
  v_readfirstlane_b32 s15, v72
  s_nop 1
  s_sub_u32 s15, s15, s14
  s_nop 1
  s_sub_u32 s15, s15, s12
  s_nop 1
  s_cmp_eq_u32 s15, 0x1b873593
  s_nop 1
  s_cbranch_scc0 L_sl108
  s_branch L_bk109
L_gv110:
  s_mov_b32 s13, 0
  s_branch L_bk109
L_sl114:
  s_mov_b32 s13, 0
  s_branch L_bk113
L_sl117:
  s_mov_b32 s13, 0
  s_branch L_bk116
L_sl120:
  s_mov_b32 s13, 0
  s_branch L_bk119
L_sl123:
  s_mov_b32 s13, 0
  s_branch L_bk122
L_sl126:
  s_mov_b32 s13, 0
  s_branch L_bk125
L_sl129:
  s_mov_b32 s13, 0
  s_branch L_bk128
L_sl132:
  s_mov_b32 s13, 0
  s_branch L_bk131
L_sl135:
  s_mov_b32 s13, 0
  s_branch L_bk134
L_sl138:
  s_mov_b32 s13, 0
  s_branch L_bk137
L_sl141:
  s_mov_b32 s13, 0
  s_branch L_bk140
L_sl144:
  s_mov_b32 s13, 0
  s_branch L_bk143
L_sl147:
  s_mov_b32 s13, 0
  s_branch L_bk146
L_sl150:
  s_mov_b32 s13, 0
  s_branch L_bk149
L_sl153:
  s_mov_b32 s13, 0
  s_branch L_bk152
L_sl156:
  s_mov_b32 s13, 0
  s_branch L_bk155
L_sl159:
  s_mov_b32 s13, 0
  s_branch L_bk158
L_sl162:
  s_mov_b32 s13, 0
  s_branch L_bk161
L_sl170:
  s_mov_b32 s13, 0
  s_branch L_bk169
L_sl173:
  s_mov_b32 s13, 0
  s_branch L_bk172
L_sl176:
  s_mov_b32 s13, 0
  s_branch L_bk175
L_sl179:
  s_mov_b32 s13, 0
  s_branch L_bk178
L_sl182:
  s_mov_b32 s13, 0
  s_branch L_bk181
L_sl185:
  s_mov_b32 s13, 0
  s_branch L_bk184
L_sl188:
  s_mov_b32 s13, 0
  s_branch L_bk187
L_sl194:
  s_mov_b32 s13, 0
  s_branch L_bk193
L_sl197:
  s_mov_b32 s13, 0
  s_branch L_bk196
L_sl200:
  s_mov_b32 s13, 0
  s_branch L_bk199
L_sl203:
  s_mov_b32 s13, 0
  s_branch L_bk202
L_sl206:
  s_mov_b32 s13, 0
  s_branch L_bk205
L_sl209:
  s_mov_b32 s13, 0
  s_branch L_bk208
L_sl212:
  s_mov_b32 s13, 0
  s_branch L_bk211
L_sl215:
  s_mov_b32 s13, 0
  s_branch L_bk214
L_sl218:
  s_mov_b32 s13, 0
  s_branch L_bk217
L_sl221:
  s_mov_b32 s13, 0
  s_branch L_bk220
.section .rodata,"a"
.p2align 6
.amdhsa_kernel parallel_sum__ssm_conv_s5__dense_activation_silu__prompt_kernel
  .amdhsa_next_free_vgpr 256
  .amdhsa_next_free_sgpr 102
  .amdhsa_accum_offset 256
  .amdhsa_group_segment_fixed_size 0
  .amdhsa_kernarg_size 120
  .amdhsa_user_sgpr_count 2
  .amdhsa_user_sgpr_kernarg_segment_ptr 1
  .amdhsa_system_sgpr_workgroup_id_x 1
.end_amdhsa_kernel
```
